```python
import torch

def _softmax(x, axis=-1):
    return torch.softmax(x, dim=axis)
def _gelu(x):
    return torch.nn.functional.gelu(x, approximate="tanh")
def _silu(x):
    return torch.nn.functional.silu(x)
def _sigmoid(x):
    return torch.sigmoid(x)
def _layernorm(x, axis=-1, eps=1e-5):
    m = x.mean(dim=axis, keepdim=True)
    v = x.var(dim=axis, keepdim=True, unbiased=False)
    return (x - m) / torch.sqrt(v + eps)
def _scatter_add(tgt, idx, src, axis=0):
    return tgt.clone().index_add_(axis, idx, src)
def _segment_sum(src, seg, n):
    out = torch.zeros((n,) + src.shape[1:], dtype=src.dtype)
    return out.index_add_(0, seg, src)
def _pad(x, pw):
    flat = tuple(v for pair in reversed(pw) for v in pair)
    return torch.nn.functional.pad(x, flat)

kernel_name = 'concat_heads__grouped_kv_mqa__mha_block__prompt'

def setup_inputs():

    _w = (lambda a: (lambda t: t.to(torch.bfloat16) if t.is_floating_point() else t)(torch.as_tensor(a)))
    def _A_setup():
        B, S, D, H = 1, 2048, 1024, 32
        Dh = D // H
        return {
            "x": _w((lambda *s: torch.randn(*s, dtype=torch.bfloat16) * 0.05)(B, S, D)),
            "wq": _w((lambda *s: torch.randn(*s, dtype=torch.bfloat16) * 0.8)(D, H * Dh)),
            "wk": _w((lambda *s: torch.randn(*s, dtype=torch.bfloat16) * 0.8)(D, Dh)),
            "wv": _w((lambda *s: torch.randn(*s, dtype=torch.bfloat16) * 0.1)(D, Dh)),
            "wo": _w((lambda *s: torch.randn(*s, dtype=torch.bfloat16) * 0.1)(H * Dh, D)),
        }
    _A_in = _A_setup()

    def _B_setup():
        B, S, D, H = 1, 2048, 1024, 32
        return {
            "x": _w((lambda *s: torch.randn(*s, dtype=torch.bfloat16) * 0.2)(B, S, D)),
            "wqkv": _w((lambda *s: torch.randn(*s, dtype=torch.bfloat16) * 0.2)(D, 3 * D)),
            "wo": _w((lambda *s: torch.randn(*s, dtype=torch.bfloat16) * 0.05)(D, D)),
        }
    _B_in = _B_setup()

    return {
        "A_x": _A_in["x"],
        "A_wq": _A_in["wq"],
        "A_wk": _A_in["wk"],
        "A_wv": _A_in["wv"],
        "A_wo": _A_in["wo"],
        "B_x": _B_in["x"],
        "B_wqkv": _B_in["wqkv"],
        "B_wo": _B_in["wo"],
    }

def reference(A_x, A_wq, A_wk, A_wv, A_wo, B_x, B_wqkv, B_wo):
    def _A_ref(x, wq, wk, wv, wo):
        B, S, D = x.shape
        H = 32
        Dh = D // H
        q = (lambda x, *d: x.permute(*d))((x @ wq).reshape(B, S, H, Dh), 0, 2, 1, 3)
        k = x @ wk
        v = x @ wv
        scores = torch.einsum("bhqd,bkd->bhqk", q, k) * (Dh ** -0.5)
        p = _softmax(scores, axis=-1)
        o = torch.einsum("bhqk,bkd->bhqd", p, v)
        return (lambda x, *d: x.permute(*d))(o, 0, 2, 1, 3).reshape(B, S, H * Dh) @ wo

    def _B_ref(x, wqkv, wo):
        B, S, D = x.shape
        H = 32
        Dh = D // H
        qkv = (lambda x, *d: x.permute(*d))((x @ wqkv).reshape(B, S, 3, H, Dh), 2, 0, 3, 1, 4)
        q, k, v = qkv[0], qkv[1], qkv[2]
        scores = torch.einsum("bhqd,bhkd->bhqk", q, k) * (Dh ** -0.5)
        p = _softmax(scores, axis=-1)
        o = torch.einsum("bhqk,bhkd->bhqd", p, v)
        return (lambda x, *d: x.permute(*d))(o, 0, 2, 1, 3).reshape(B, S, D) @ wo

    a = _A_ref(A_x, A_wq, A_wk, A_wv, A_wo)
    b = _B_ref(B_x, B_wqkv, B_wo)
    return torch.concatenate([a, b], axis=-1)
```

```asm
; @launch kernel=fused_kernel grid=(256,1,1) block=(576,1,1) lds=147456
.amdgcn_target "amdgcn-amd-amdhsa--gfx950"

.text
.globl fused_kernel
.p2align 8
.type fused_kernel,@function
fused_kernel:

    s_cmp_ge_u32 s2, 256
    s_cbranch_scc1 L_end
    s_load_dwordx16 s[64:79], s[0:1], 0
    s_load_dwordx4 s[80:83], s[0:1], 64
    s_load_dwordx2 s[4:5], s[0:1], 80
    v_lshrrev_b32 v1, 6, v0
    v_and_b32 v2, 63, v0
    s_and_b32 s31, s2, 7
    v_readfirstlane_b32 s24, v1
    s_lshr_b32 s32, s2, 3
    s_lshr_b32 s26, s31, 1
    s_and_b32 s26, s26, 1
    s_lshl_b32 s26, s26, 3
    s_and_b32 s27, s32, 7
    s_add_u32 s34, s26, s27
    s_lshr_b32 s35, s32, 3
    s_xor_b32 s35, s35, 0
    s_lshr_b32 s36, s31, 1
    s_lshr_b32 s26, s31, 2
    s_lshl_b32 s26, s26, 1
    s_and_b32 s27, s31, 1
    s_or_b32 s36, s26, s27
    s_xor_b32 s36, s36, 3
    s_cmp_eq_u32 s36, 3
    s_movk_i32 s39, 6144
    s_cselect_b32 s39, 2048, s39
    s_lshr_b32 s26, s35, 1
    s_cmp_eq_u32 s36, 3
    s_cselect_b32 s37, s26, 0
    s_and_b32 s38, s35, 1
    s_lshl_b32 s26, s31, 2
    s_lshr_b32 s27, s32, 3
    s_add_u32 s26, s26, s27
    s_lshr_b32 s84, s26, 4
    s_and_b32 s85, s26, 15
    s_and_b32 s86, s32, 7
    s_and_b32 s26, s31, 3
    s_lshl_b32 s26, s26, 2
    s_and_b32 s27, s32, 3
    s_add_u32 s87, s26, s27
    s_lshr_b32 s88, s32, 2
    s_cmp_ge_u32 s24, 8
    s_cbranch_scc1 L_helper
    s_cmp_ge_u32 s24, 4
    s_cbranch_scc1 L_compute
    v_lshrrev_b32 v8, 4, v2
    s_and_b32 s26, s24, 1
    s_lshl_b32 s26, s26, 2
    v_or_b32 v8, s26, v8
    v_and_b32 v9, 7, v2
    v_xor_b32 v8, v8, v9
    v_lshlrev_b32 v8, 4, v8
    v_lshrrev_b32 v9, 3, v2
    v_lshlrev_b32 v9, 11, v9
    v_add_u32 v4, v8, v9
    v_lshrrev_b32 v8, 4, v2
    s_lshr_b32 s26, s24, 1
    s_lshl_b32 s26, s26, 2
    v_or_b32 v9, s26, v8
    v_and_b32 v10, 15, v2
    v_lshrrev_b32 v10, 1, v10
    v_xor_b32 v9, v9, v10
    v_lshrrev_b32 v11, 2, v9
    v_lshlrev_b32 v11, 7, v11
    v_and_b32 v11, 128, v11
    v_lshlrev_b32 v9, 5, v9
    v_add_u32 v9, v9, v11
    v_and_b32 v10, 1, v2
    v_lshlrev_b32 v10, 4, v10
    v_add_u32 v9, v9, v10
    v_mul_lo_u32 v8, v8, s39
    v_add_u32 v5, v8, v9
    v_lshlrev_b32 v7, 4, v2
    s_mov_b32 s33, 0
    v_lshrrev_b32 v8, 2, v2
    s_lshl_b32 s26, s24, 4
    v_add_u32 v8, s26, v8
    v_lshlrev_b32 v8, 6, v8
    v_lshrrev_b32 v9, 1, v2
    v_lshrrev_b32 v10, 5, v2
    v_xor_b32 v9, v9, v10
    v_and_b32 v9, 1, v9
    v_lshlrev_b32 v9, 5, v9
    v_add_u32 v8, v8, v9
    v_and_b32 v9, 1, v2
    v_lshlrev_b32 v9, 4, v9
    v_add_u32 v6, v8, v9
    s_lshl_b32 s48, s24, 10
    s_lshl_b32 s49, s24, 12
    s_lshl_b32 s50, s24, 11
    s_add_u32 s26, s24, 0
    s_lshl_b32 s27, s37, 2
    s_add_u32 s27, s27, s26
    s_and_b32 s27, s27, 7
    s_and_b32 s26, s26, 8
    s_or_b32 s26, s26, s27
    s_lshl_b32 s40, s26, 14
    s_add_u32 s26, s24, 4
    s_lshl_b32 s27, s37, 2
    s_add_u32 s27, s27, s26
    s_and_b32 s27, s27, 7
    s_and_b32 s26, s26, 8
    s_or_b32 s26, s26, s27
    s_lshl_b32 s41, s26, 14
    s_add_u32 s26, s24, 8
    s_lshl_b32 s27, s37, 2
    s_add_u32 s27, s27, s26
    s_and_b32 s27, s27, 7
    s_and_b32 s26, s26, 8
    s_or_b32 s26, s26, s27
    s_lshl_b32 s42, s26, 14
    s_add_u32 s26, s24, 12
    s_lshl_b32 s27, s37, 2
    s_add_u32 s27, s27, s26
    s_and_b32 s27, s27, 7
    s_and_b32 s26, s26, 8
    s_or_b32 s26, s26, s27
    s_lshl_b32 s43, s26, 14
    s_add_u32 s26, s24, 0
    s_lshl_b32 s26, s26, 2
    s_mul_i32 s44, s26, s39
    s_add_u32 s26, s24, 4
    s_lshl_b32 s26, s26, 2
    s_mul_i32 s45, s26, s39
    s_add_u32 s26, s24, 8
    s_lshl_b32 s26, s26, 2
    s_mul_i32 s46, s26, s39
    s_add_u32 s26, s24, 12
    s_lshl_b32 s26, s26, 2
    s_mul_i32 s47, s26, s39
    s_mov_b32 s89, 0
    s_lshr_b32 s26, s32, 3
    s_add_u32 s26, s26, s32
    s_and_b32 s26, s26, 1
    s_lshl_b32 s51, s26, 3
    s_and_b32 s26, s31, 3
    s_lshl_b32 s26, s26, 1
    s_add_u32 s51, s51, s26
    s_waitcnt lgkmcnt(0)
    s_cmp_eq_u32 s36, 3
    s_cselect_b32 s26, s64, s74
    s_cselect_b32 s27, s65, s75
    s_lshl_b32 s28, s34, 18
    s_add_u32 s8, s26, s28
    s_addc_u32 s9, s27, 0
    s_and_b32 s9, s9, 0xffff
    s_mov_b32 s10, 262144
    s_mov_b32 s11, 0x20000
    s_cmp_eq_u32 s36, 3
    s_cselect_b32 s26, s66, s76
    s_cselect_b32 s27, s67, s77
    s_cselect_b32 s28, 0, s36
    s_lshl_b32 s28, s28, 11
    s_lshr_b32 s29, s35, 1
    s_xor_b32 s29, s29, s33
    s_lshl_b32 s29, s29, 2
    s_and_b32 s30, s35, 1
    s_add_u32 s29, s29, s30
    s_lshl_b32 s30, s33, 3
    s_add_u32 s29, s29, s30
    s_lshl_b32 s29, s29, 7
    s_add_u32 s28, s28, s29
    s_lshl_b32 s29, s39, 10
    s_sub_u32 s29, s29, s28
    s_add_u32 s12, s26, s28
    s_addc_u32 s13, s27, 0
    s_and_b32 s13, s13, 0xffff
    s_mov_b32 s14, s29
    s_mov_b32 s15, 0x20000
    s_cmp_eq_u32 s38, 0
    s_cselect_b32 s26, s68, s70
    s_cselect_b32 s27, s69, s71
    s_mov_b32 s16, s26
    s_and_b32 s17, s27, 0xffff
    s_mov_b32 s18, 65536
    s_mov_b32 s19, 0x20000
    s_cmp_eq_u32 s36, 3
    s_cbranch_scc1 L_ld_A
    s_add_u32 s29, s89, s51
    s_and_b32 s29, s29, 15
    s_and_b32 s90, s89, 3
    s_lshl_b32 s90, s90, 14
    s_lshl_b32 s28, s29, 7
    s_add_u32 s26, s90, s48
    s_mov_b32 m0, s26
    s_add_u32 s27, s40, s28
    s_add_u32 s26, s26, 4096
    buffer_load_dwordx4 v4, s[8:11], s27 offen lds
    s_mov_b32 m0, s26
    s_add_u32 s27, s41, s28
    s_add_u32 s26, s26, 4096
    buffer_load_dwordx4 v4, s[8:11], s27 offen lds
    s_mov_b32 m0, s26
    s_add_u32 s27, s42, s28
    s_add_u32 s26, s26, 4096
    buffer_load_dwordx4 v4, s[8:11], s27 offen lds
    s_mov_b32 m0, s26
    s_add_u32 s27, s43, s28
    s_add_u32 s26, s26, 4096
    buffer_load_dwordx4 v4, s[8:11], s27 offen lds
    s_lshl_b32 s28, s29, 6
    s_mul_i32 s28, s28, s39
    s_add_u32 s26, s90, s48
    s_add_u32 s26, s26, 65536
    s_mov_b32 m0, s26
    s_add_u32 s27, s44, s28
    s_add_u32 s26, s26, 4096
    buffer_load_dwordx4 v5, s[12:15], s27 offen lds
    s_mov_b32 m0, s26
    s_add_u32 s27, s45, s28
    s_add_u32 s26, s26, 4096
    buffer_load_dwordx4 v5, s[12:15], s27 offen lds
    s_mov_b32 m0, s26
    s_add_u32 s27, s46, s28
    s_add_u32 s26, s26, 4096
    buffer_load_dwordx4 v5, s[12:15], s27 offen lds
    s_mov_b32 m0, s26
    s_add_u32 s27, s47, s28
    s_add_u32 s26, s26, 4096
    buffer_load_dwordx4 v5, s[12:15], s27 offen lds
    s_add_u32 s89, s89, 1
    s_add_u32 s29, s89, s51
    s_and_b32 s29, s29, 15
    s_and_b32 s90, s89, 3
    s_lshl_b32 s90, s90, 14
    s_lshl_b32 s28, s29, 7
    s_add_u32 s26, s90, s48
    s_mov_b32 m0, s26
    s_add_u32 s27, s40, s28
    s_add_u32 s26, s26, 4096
    buffer_load_dwordx4 v4, s[8:11], s27 offen lds
    s_mov_b32 m0, s26
    s_add_u32 s27, s41, s28
    s_add_u32 s26, s26, 4096
    buffer_load_dwordx4 v4, s[8:11], s27 offen lds
    s_mov_b32 m0, s26
    s_add_u32 s27, s42, s28
    s_add_u32 s26, s26, 4096
    buffer_load_dwordx4 v4, s[8:11], s27 offen lds
    s_mov_b32 m0, s26
    s_add_u32 s27, s43, s28
    s_add_u32 s26, s26, 4096
    buffer_load_dwordx4 v4, s[8:11], s27 offen lds
    s_lshl_b32 s28, s29, 6
    s_mul_i32 s28, s28, s39
    s_add_u32 s26, s90, s48
    s_add_u32 s26, s26, 65536
    s_mov_b32 m0, s26
    s_add_u32 s27, s44, s28
    s_add_u32 s26, s26, 4096
    buffer_load_dwordx4 v5, s[12:15], s27 offen lds
    s_mov_b32 m0, s26
    s_add_u32 s27, s45, s28
    s_add_u32 s26, s26, 4096
    buffer_load_dwordx4 v5, s[12:15], s27 offen lds
    s_mov_b32 m0, s26
    s_add_u32 s27, s46, s28
    s_add_u32 s26, s26, 4096
    buffer_load_dwordx4 v5, s[12:15], s27 offen lds
    s_mov_b32 m0, s26
    s_add_u32 s27, s47, s28
    s_add_u32 s26, s26, 4096
    buffer_load_dwordx4 v5, s[12:15], s27 offen lds
    s_add_u32 s89, s89, 1
    s_add_u32 s29, s89, s51
    s_and_b32 s29, s29, 15
    s_and_b32 s90, s89, 3
    s_lshl_b32 s90, s90, 14
    s_lshl_b32 s28, s29, 7
    s_add_u32 s26, s90, s48
    s_mov_b32 m0, s26
    s_add_u32 s27, s40, s28
    s_add_u32 s26, s26, 4096
    buffer_load_dwordx4 v4, s[8:11], s27 offen lds
    s_mov_b32 m0, s26
    s_add_u32 s27, s41, s28
    s_add_u32 s26, s26, 4096
    buffer_load_dwordx4 v4, s[8:11], s27 offen lds
    s_mov_b32 m0, s26
    s_add_u32 s27, s42, s28
    s_add_u32 s26, s26, 4096
    buffer_load_dwordx4 v4, s[8:11], s27 offen lds
    s_mov_b32 m0, s26
    s_add_u32 s27, s43, s28
    s_add_u32 s26, s26, 4096
    buffer_load_dwordx4 v4, s[8:11], s27 offen lds
    s_lshl_b32 s28, s29, 6
    s_mul_i32 s28, s28, s39
    s_add_u32 s26, s90, s48
    s_add_u32 s26, s26, 65536
    s_mov_b32 m0, s26
    s_add_u32 s27, s44, s28
    s_add_u32 s26, s26, 4096
    buffer_load_dwordx4 v5, s[12:15], s27 offen lds
    s_mov_b32 m0, s26
    s_add_u32 s27, s45, s28
    s_add_u32 s26, s26, 4096
    buffer_load_dwordx4 v5, s[12:15], s27 offen lds
    s_mov_b32 m0, s26
    s_add_u32 s27, s46, s28
    s_add_u32 s26, s26, 4096
    buffer_load_dwordx4 v5, s[12:15], s27 offen lds
    s_mov_b32 m0, s26
    s_add_u32 s27, s47, s28
    s_add_u32 s26, s26, 4096
    buffer_load_dwordx4 v5, s[12:15], s27 offen lds
    s_add_u32 s89, s89, 1
    s_add_u32 s29, s89, s51
    s_and_b32 s29, s29, 15
    s_and_b32 s90, s89, 3
    s_lshl_b32 s90, s90, 14
    s_lshl_b32 s28, s29, 7
    s_add_u32 s26, s90, s48
    s_mov_b32 m0, s26
    s_add_u32 s27, s40, s28
    s_add_u32 s26, s26, 4096
L_ldB_0:
    s_waitcnt vmcnt(16)
    s_barrier
    buffer_load_dwordx4 v4, s[8:11], s27 offen lds
    s_mov_b32 m0, s26
    s_add_u32 s27, s41, s28
    s_add_u32 s26, s26, 4096
    buffer_load_dwordx4 v4, s[8:11], s27 offen lds
    s_mov_b32 m0, s26
    s_add_u32 s27, s42, s28
    s_add_u32 s26, s26, 4096
    buffer_load_dwordx4 v4, s[8:11], s27 offen lds
    s_mov_b32 m0, s26
    s_add_u32 s27, s43, s28
    s_add_u32 s26, s26, 4096
    buffer_load_dwordx4 v4, s[8:11], s27 offen lds
    s_lshl_b32 s28, s29, 6
    s_mul_i32 s28, s28, s39
    s_add_u32 s26, s90, s48
    s_add_u32 s26, s26, 65536
    s_mov_b32 m0, s26
    s_add_u32 s27, s44, s28
    s_add_u32 s26, s26, 4096
    buffer_load_dwordx4 v5, s[12:15], s27 offen lds
    s_mov_b32 m0, s26
    s_add_u32 s27, s45, s28
    s_add_u32 s26, s26, 4096
    buffer_load_dwordx4 v5, s[12:15], s27 offen lds
    s_mov_b32 m0, s26
    s_add_u32 s27, s46, s28
    s_add_u32 s26, s26, 4096
    buffer_load_dwordx4 v5, s[12:15], s27 offen lds
    s_mov_b32 m0, s26
    s_add_u32 s27, s47, s28
    s_add_u32 s26, s26, 4096
    buffer_load_dwordx4 v5, s[12:15], s27 offen lds
    s_add_u32 s89, s89, 1
    s_add_u32 s29, s89, s51
    s_and_b32 s29, s29, 15
    s_and_b32 s90, s89, 3
    s_lshl_b32 s90, s90, 14
    s_lshl_b32 s28, s29, 7
    s_add_u32 s26, s90, s48
    s_mov_b32 m0, s26
    s_add_u32 s27, s40, s28
    s_add_u32 s26, s26, 4096
    s_cmp_lt_u32 s89, 16
    s_cbranch_scc1 L_ldB_0
    s_mov_b32 s33, 1
    s_cmp_eq_u32 s36, 3
    s_cselect_b32 s26, s64, s74
    s_cselect_b32 s27, s65, s75
    s_lshl_b32 s28, s34, 18
    s_add_u32 s8, s26, s28
    s_addc_u32 s9, s27, 0
    s_and_b32 s9, s9, 0xffff
    s_mov_b32 s10, 262144
    s_mov_b32 s11, 0x20000
    s_cmp_eq_u32 s36, 3
    s_cselect_b32 s26, s66, s76
    s_cselect_b32 s27, s67, s77
    s_cselect_b32 s28, 0, s36
    s_lshl_b32 s28, s28, 11
    s_lshr_b32 s29, s35, 1
    s_xor_b32 s29, s29, s33
    s_lshl_b32 s29, s29, 2
    s_and_b32 s30, s35, 1
    s_add_u32 s29, s29, s30
    s_lshl_b32 s30, s33, 3
    s_add_u32 s29, s29, s30
    s_lshl_b32 s29, s29, 7
    s_add_u32 s28, s28, s29
    s_lshl_b32 s29, s39, 10
    s_sub_u32 s29, s29, s28
    s_add_u32 s12, s26, s28
    s_addc_u32 s13, s27, 0
    s_and_b32 s13, s13, 0xffff
    s_mov_b32 s14, s29
    s_mov_b32 s15, 0x20000
    s_add_u32 s26, s24, 0
    s_lshl_b32 s40, s26, 14
    s_add_u32 s26, s24, 4
    s_lshl_b32 s41, s26, 14
    s_add_u32 s26, s24, 8
    s_lshl_b32 s42, s26, 14
    s_add_u32 s26, s24, 12
    s_lshl_b32 s43, s26, 14
    s_and_b32 s26, s32, 7
    s_lshl_b32 s51, s26, 1
    s_add_u32 s29, s89, s51
    s_and_b32 s29, s29, 15
    s_and_b32 s90, s89, 3
    s_lshl_b32 s90, s90, 14
    s_lshl_b32 s28, s29, 7
    s_add_u32 s26, s90, s48
    s_mov_b32 m0, s26
    s_add_u32 s27, s40, s28
    s_add_u32 s26, s26, 4096
    s_waitcnt vmcnt(16)
    s_barrier
    buffer_load_dwordx4 v4, s[8:11], s27 offen lds
    s_mov_b32 m0, s26
    s_add_u32 s27, s41, s28
    s_add_u32 s26, s26, 4096
    buffer_load_dwordx4 v4, s[8:11], s27 offen lds
    s_mov_b32 m0, s26
    s_add_u32 s27, s42, s28
    s_add_u32 s26, s26, 4096
    buffer_load_dwordx4 v4, s[8:11], s27 offen lds
    s_mov_b32 m0, s26
    s_add_u32 s27, s43, s28
    s_add_u32 s26, s26, 4096
    buffer_load_dwordx4 v4, s[8:11], s27 offen lds
    s_lshl_b32 s28, s29, 6
    s_mul_i32 s28, s28, s39
    s_add_u32 s26, s90, s48
    s_add_u32 s26, s26, 65536
    s_mov_b32 m0, s26
    s_add_u32 s27, s44, s28
    s_add_u32 s26, s26, 4096
    buffer_load_dwordx4 v5, s[12:15], s27 offen lds
    s_mov_b32 m0, s26
    s_add_u32 s27, s45, s28
    s_add_u32 s26, s26, 4096
    buffer_load_dwordx4 v5, s[12:15], s27 offen lds
    s_mov_b32 m0, s26
    s_add_u32 s27, s46, s28
    s_add_u32 s26, s26, 4096
    buffer_load_dwordx4 v5, s[12:15], s27 offen lds
    s_mov_b32 m0, s26
    s_add_u32 s27, s47, s28
    s_add_u32 s26, s26, 4096
    buffer_load_dwordx4 v5, s[12:15], s27 offen lds
    s_add_u32 s89, s89, 1
    s_add_u32 s29, s89, s51
    s_and_b32 s29, s29, 15
    s_and_b32 s90, s89, 3
    s_lshl_b32 s90, s90, 14
    s_lshl_b32 s28, s29, 7
    s_add_u32 s26, s90, s48
    s_mov_b32 m0, s26
    s_add_u32 s27, s40, s28
    s_add_u32 s26, s26, 4096
    s_waitcnt vmcnt(16)
    s_barrier
    buffer_load_dwordx4 v4, s[8:11], s27 offen lds
    s_mov_b32 m0, s26
    s_add_u32 s27, s41, s28
    s_add_u32 s26, s26, 4096
    buffer_load_dwordx4 v4, s[8:11], s27 offen lds
    s_mov_b32 m0, s26
    s_add_u32 s27, s42, s28
    s_add_u32 s26, s26, 4096
    buffer_load_dwordx4 v4, s[8:11], s27 offen lds
    s_mov_b32 m0, s26
    s_add_u32 s27, s43, s28
    s_add_u32 s26, s26, 4096
    buffer_load_dwordx4 v4, s[8:11], s27 offen lds
    s_lshl_b32 s28, s29, 6
    s_mul_i32 s28, s28, s39
    s_add_u32 s26, s90, s48
    s_add_u32 s26, s26, 65536
    s_mov_b32 m0, s26
    s_add_u32 s27, s44, s28
    s_add_u32 s26, s26, 4096
    buffer_load_dwordx4 v5, s[12:15], s27 offen lds
    s_mov_b32 m0, s26
    s_add_u32 s27, s45, s28
    s_add_u32 s26, s26, 4096
    buffer_load_dwordx4 v5, s[12:15], s27 offen lds
    s_mov_b32 m0, s26
    s_add_u32 s27, s46, s28
    s_add_u32 s26, s26, 4096
    buffer_load_dwordx4 v5, s[12:15], s27 offen lds
    s_mov_b32 m0, s26
    s_add_u32 s27, s47, s28
    s_add_u32 s26, s26, 4096
    buffer_load_dwordx4 v5, s[12:15], s27 offen lds
    s_add_u32 s89, s89, 1
    s_waitcnt vmcnt(16)
    s_barrier
    s_add_u32 s29, s89, s51
    s_and_b32 s29, s29, 15
    s_and_b32 s90, s89, 3
    s_lshl_b32 s90, s90, 14
    s_lshl_b32 s28, s29, 7
    s_add_u32 s26, s90, s48
    s_mov_b32 m0, s26
    s_add_u32 s27, s40, s28
    s_add_u32 s26, s26, 4096
L_ldB_1:
    s_waitcnt vmcnt(8)
    s_barrier
    buffer_load_dwordx4 v4, s[8:11], s27 offen lds
    s_mov_b32 m0, s26
    s_add_u32 s27, s41, s28
    s_add_u32 s26, s26, 4096
    buffer_load_dwordx4 v4, s[8:11], s27 offen lds
    s_mov_b32 m0, s26
    s_add_u32 s27, s42, s28
    s_add_u32 s26, s26, 4096
    buffer_load_dwordx4 v4, s[8:11], s27 offen lds
    s_mov_b32 m0, s26
    s_add_u32 s27, s43, s28
    s_add_u32 s26, s26, 4096
    buffer_load_dwordx4 v4, s[8:11], s27 offen lds
    s_lshl_b32 s28, s29, 6
    s_mul_i32 s28, s28, s39
    s_add_u32 s26, s90, s48
    s_add_u32 s26, s26, 65536
    s_mov_b32 m0, s26
    s_add_u32 s27, s44, s28
    s_add_u32 s26, s26, 4096
    buffer_load_dwordx4 v5, s[12:15], s27 offen lds
    s_mov_b32 m0, s26
    s_add_u32 s27, s45, s28
    s_add_u32 s26, s26, 4096
    buffer_load_dwordx4 v5, s[12:15], s27 offen lds
    s_mov_b32 m0, s26
    s_add_u32 s27, s46, s28
    s_add_u32 s26, s26, 4096
    buffer_load_dwordx4 v5, s[12:15], s27 offen lds
    s_mov_b32 m0, s26
    s_add_u32 s27, s47, s28
    s_add_u32 s26, s26, 4096
    buffer_load_dwordx4 v5, s[12:15], s27 offen lds
    s_add_u32 s89, s89, 1
    s_add_u32 s29, s89, s51
    s_and_b32 s29, s29, 15
    s_and_b32 s90, s89, 3
    s_lshl_b32 s90, s90, 14
    s_lshl_b32 s28, s29, 7
    s_add_u32 s26, s90, s48
    s_mov_b32 m0, s26
    s_add_u32 s27, s40, s28
    s_add_u32 s26, s26, 4096
    s_cmp_lt_u32 s89, 32
    s_cbranch_scc1 L_ldB_1
    s_mov_b32 s33, 0
    s_lshl_b32 s26, s33, 4
    s_add_u32 s26, s26, s85
    s_lshl_b32 s26, s26, 18
    s_add_u32 s26, s26, 8388608
    s_cmp_eq_u32 s84, 0
    s_cselect_b32 s26, 16777216, s26
    s_add_u32 s8, s4, s26
    s_addc_u32 s9, s5, 0
    s_and_b32 s9, s9, 0xffff
    s_mov_b32 s10, 262144
    s_mov_b32 s11, 0x20000
    s_lshl_b32 s26, s84, 5
    s_add_u32 s26, s26, s85
    s_add_u32 s26, s26, 0
    s_lshl_b32 s26, s26, 17
    s_lshl_b32 s27, s86, 14
    s_add_u32 s26, s26, s27
    s_add_u32 s16, s4, s26
    s_addc_u32 s17, s5, 0
    s_and_b32 s17, s17, 0xffff
    s_mov_b32 s18, 16384
    s_mov_b32 s19, 0x20000
    s_and_b32 s90, s89, 3
    s_lshl_b32 s90, s90, 14
    s_and_b32 s28, s89, 7
    s_lshl_b32 s28, s28, 15
    s_add_u32 s28, s28, s49
    s_add_u32 s26, s90, s49
    s_mov_b32 m0, s26
    s_add_u32 s26, s26, 65536
    s_waitcnt vmcnt(8)
    s_barrier
    buffer_load_dwordx4 v7, s[8:11], s28 offen offset:0 lds
    buffer_load_dwordx4 v7, s[8:11], s28 offen offset:1024 lds
    buffer_load_dwordx4 v7, s[8:11], s28 offen offset:2048 lds
    buffer_load_dwordx4 v7, s[8:11], s28 offen offset:3072 lds
    s_mov_b32 m0, s26
    s_add_u32 s28, s28, 16384
    buffer_load_dwordx4 v7, s[8:11], s28 offen offset:0 lds
    buffer_load_dwordx4 v7, s[8:11], s28 offen offset:1024 lds
    buffer_load_dwordx4 v7, s[8:11], s28 offen offset:2048 lds
    buffer_load_dwordx4 v7, s[8:11], s28 offen offset:3072 lds
    s_add_u32 s89, s89, 1
    s_add_u32 s26, s49, 131072
    s_mov_b32 m0, s26
    s_nop 0
    buffer_load_dwordx4 v7, s[16:19], s49 offen offset:0 lds
    buffer_load_dwordx4 v7, s[16:19], s49 offen offset:1024 lds
    buffer_load_dwordx4 v7, s[16:19], s49 offen offset:2048 lds
    buffer_load_dwordx4 v7, s[16:19], s49 offen offset:3072 lds
    s_and_b32 s90, s89, 3
    s_lshl_b32 s90, s90, 14
    s_and_b32 s28, s89, 7
    s_lshl_b32 s28, s28, 15
    s_add_u32 s28, s28, s49
    s_add_u32 s26, s90, s49
    s_mov_b32 m0, s26
    s_add_u32 s26, s26, 65536
    s_waitcnt vmcnt(12)
    s_barrier
    buffer_load_dwordx4 v7, s[8:11], s28 offen offset:0 lds
    buffer_load_dwordx4 v7, s[8:11], s28 offen offset:1024 lds
    buffer_load_dwordx4 v7, s[8:11], s28 offen offset:2048 lds
    buffer_load_dwordx4 v7, s[8:11], s28 offen offset:3072 lds
    s_mov_b32 m0, s26
    s_add_u32 s28, s28, 16384
    buffer_load_dwordx4 v7, s[8:11], s28 offen offset:0 lds
    buffer_load_dwordx4 v7, s[8:11], s28 offen offset:1024 lds
    buffer_load_dwordx4 v7, s[8:11], s28 offen offset:2048 lds
    buffer_load_dwordx4 v7, s[8:11], s28 offen offset:3072 lds
    s_add_u32 s89, s89, 1
    s_waitcnt vmcnt(8)
    s_barrier
    s_and_b32 s90, s89, 3
    s_lshl_b32 s90, s90, 14
    s_and_b32 s28, s89, 7
    s_lshl_b32 s28, s28, 15
    s_add_u32 s28, s28, s49
    s_add_u32 s26, s90, s49
    s_mov_b32 m0, s26
    s_add_u32 s26, s26, 65536
    s_waitcnt vmcnt(0)
    s_barrier
    buffer_load_dwordx4 v7, s[8:11], s28 offen offset:0 lds
    buffer_load_dwordx4 v7, s[8:11], s28 offen offset:1024 lds
    buffer_load_dwordx4 v7, s[8:11], s28 offen offset:2048 lds
    buffer_load_dwordx4 v7, s[8:11], s28 offen offset:3072 lds
    s_mov_b32 m0, s26
    s_add_u32 s28, s28, 16384
    buffer_load_dwordx4 v7, s[8:11], s28 offen offset:0 lds
    buffer_load_dwordx4 v7, s[8:11], s28 offen offset:1024 lds
    buffer_load_dwordx4 v7, s[8:11], s28 offen offset:2048 lds
    buffer_load_dwordx4 v7, s[8:11], s28 offen offset:3072 lds
    s_add_u32 s89, s89, 1
    s_and_b32 s90, s89, 3
    s_lshl_b32 s90, s90, 14
    s_and_b32 s28, s89, 7
    s_lshl_b32 s28, s28, 15
    s_add_u32 s28, s28, s49
    s_add_u32 s26, s90, s49
    s_mov_b32 m0, s26
    s_add_u32 s26, s26, 65536
    buffer_load_dwordx4 v7, s[8:11], s28 offen offset:0 lds
    buffer_load_dwordx4 v7, s[8:11], s28 offen offset:1024 lds
    buffer_load_dwordx4 v7, s[8:11], s28 offen offset:2048 lds
    buffer_load_dwordx4 v7, s[8:11], s28 offen offset:3072 lds
    s_mov_b32 m0, s26
    s_add_u32 s28, s28, 16384
    buffer_load_dwordx4 v7, s[8:11], s28 offen offset:0 lds
    buffer_load_dwordx4 v7, s[8:11], s28 offen offset:1024 lds
    buffer_load_dwordx4 v7, s[8:11], s28 offen offset:2048 lds
    buffer_load_dwordx4 v7, s[8:11], s28 offen offset:3072 lds
    s_add_u32 s89, s89, 1
    s_and_b32 s90, s89, 3
    s_lshl_b32 s90, s90, 14
    s_and_b32 s28, s89, 7
    s_lshl_b32 s28, s28, 15
    s_add_u32 s28, s28, s49
    s_add_u32 s26, s90, s49
    s_mov_b32 m0, s26
    s_add_u32 s26, s26, 65536
L_ldB_2:
    s_waitcnt vmcnt(8)
    s_barrier
    buffer_load_dwordx4 v7, s[8:11], s28 offen offset:0 lds
    buffer_load_dwordx4 v7, s[8:11], s28 offen offset:1024 lds
    buffer_load_dwordx4 v7, s[8:11], s28 offen offset:2048 lds
    buffer_load_dwordx4 v7, s[8:11], s28 offen offset:3072 lds
    s_mov_b32 m0, s26
    s_add_u32 s28, s28, 16384
    buffer_load_dwordx4 v7, s[8:11], s28 offen offset:0 lds
    buffer_load_dwordx4 v7, s[8:11], s28 offen offset:1024 lds
    buffer_load_dwordx4 v7, s[8:11], s28 offen offset:2048 lds
    buffer_load_dwordx4 v7, s[8:11], s28 offen offset:3072 lds
    s_add_u32 s89, s89, 1
    s_and_b32 s90, s89, 3
    s_lshl_b32 s90, s90, 14
    s_and_b32 s28, s89, 7
    s_lshl_b32 s28, s28, 15
    s_add_u32 s28, s28, s49
    s_add_u32 s26, s90, s49
    s_mov_b32 m0, s26
    s_add_u32 s26, s26, 65536
    s_cmp_lt_u32 s89, 40
    s_cbranch_scc1 L_ldB_2
    s_mov_b32 s33, 1
    s_lshl_b32 s26, s33, 4
    s_add_u32 s26, s26, s85
    s_lshl_b32 s26, s26, 18
    s_add_u32 s26, s26, 8388608
    s_cmp_eq_u32 s84, 0
    s_cselect_b32 s26, 16777216, s26
    s_add_u32 s8, s4, s26
    s_addc_u32 s9, s5, 0
    s_and_b32 s9, s9, 0xffff
    s_mov_b32 s10, 262144
    s_mov_b32 s11, 0x20000
    s_lshl_b32 s26, s84, 5
    s_add_u32 s26, s26, s85
    s_add_u32 s26, s26, 16
    s_lshl_b32 s26, s26, 17
    s_lshl_b32 s27, s86, 14
    s_add_u32 s26, s26, s27
    s_add_u32 s16, s4, s26
    s_addc_u32 s17, s5, 0
    s_and_b32 s17, s17, 0xffff
    s_mov_b32 s18, 16384
    s_mov_b32 s19, 0x20000
    s_and_b32 s90, s89, 3
    s_lshl_b32 s90, s90, 14
    s_and_b32 s28, s89, 7
    s_lshl_b32 s28, s28, 15
    s_add_u32 s28, s28, s49
    s_add_u32 s26, s90, s49
    s_mov_b32 m0, s26
    s_add_u32 s26, s26, 65536
    s_waitcnt vmcnt(8)
    s_barrier
    buffer_load_dwordx4 v7, s[8:11], s28 offen offset:0 lds
    buffer_load_dwordx4 v7, s[8:11], s28 offen offset:1024 lds
    buffer_load_dwordx4 v7, s[8:11], s28 offen offset:2048 lds
    buffer_load_dwordx4 v7, s[8:11], s28 offen offset:3072 lds
    s_mov_b32 m0, s26
    s_add_u32 s28, s28, 16384
    buffer_load_dwordx4 v7, s[8:11], s28 offen offset:0 lds
    buffer_load_dwordx4 v7, s[8:11], s28 offen offset:1024 lds
    buffer_load_dwordx4 v7, s[8:11], s28 offen offset:2048 lds
    buffer_load_dwordx4 v7, s[8:11], s28 offen offset:3072 lds
    s_add_u32 s89, s89, 1
    s_add_u32 s26, s49, 131072
    s_mov_b32 m0, s26
    s_nop 0
    buffer_load_dwordx4 v7, s[16:19], s49 offen offset:0 lds
    buffer_load_dwordx4 v7, s[16:19], s49 offen offset:1024 lds
    buffer_load_dwordx4 v7, s[16:19], s49 offen offset:2048 lds
    buffer_load_dwordx4 v7, s[16:19], s49 offen offset:3072 lds
    s_and_b32 s90, s89, 3
    s_lshl_b32 s90, s90, 14
    s_and_b32 s28, s89, 7
    s_lshl_b32 s28, s28, 15
    s_add_u32 s28, s28, s49
    s_add_u32 s26, s90, s49
    s_mov_b32 m0, s26
    s_add_u32 s26, s26, 65536
    s_waitcnt vmcnt(12)
    s_barrier
    buffer_load_dwordx4 v7, s[8:11], s28 offen offset:0 lds
    buffer_load_dwordx4 v7, s[8:11], s28 offen offset:1024 lds
    buffer_load_dwordx4 v7, s[8:11], s28 offen offset:2048 lds
    buffer_load_dwordx4 v7, s[8:11], s28 offen offset:3072 lds
    s_mov_b32 m0, s26
    s_add_u32 s28, s28, 16384
    buffer_load_dwordx4 v7, s[8:11], s28 offen offset:0 lds
    buffer_load_dwordx4 v7, s[8:11], s28 offen offset:1024 lds
    buffer_load_dwordx4 v7, s[8:11], s28 offen offset:2048 lds
    buffer_load_dwordx4 v7, s[8:11], s28 offen offset:3072 lds
    s_add_u32 s89, s89, 1
    s_and_b32 s90, s89, 3
    s_lshl_b32 s90, s90, 14
    s_and_b32 s28, s89, 7
    s_lshl_b32 s28, s28, 15
    s_add_u32 s28, s28, s49
    s_add_u32 s26, s90, s49
    s_mov_b32 m0, s26
    s_add_u32 s26, s26, 65536
L_ldB_3:
    s_waitcnt vmcnt(8)
    s_barrier
    buffer_load_dwordx4 v7, s[8:11], s28 offen offset:0 lds
    buffer_load_dwordx4 v7, s[8:11], s28 offen offset:1024 lds
    buffer_load_dwordx4 v7, s[8:11], s28 offen offset:2048 lds
    buffer_load_dwordx4 v7, s[8:11], s28 offen offset:3072 lds
    s_mov_b32 m0, s26
    s_add_u32 s28, s28, 16384
    buffer_load_dwordx4 v7, s[8:11], s28 offen offset:0 lds
    buffer_load_dwordx4 v7, s[8:11], s28 offen offset:1024 lds
    buffer_load_dwordx4 v7, s[8:11], s28 offen offset:2048 lds
    buffer_load_dwordx4 v7, s[8:11], s28 offen offset:3072 lds
    s_add_u32 s89, s89, 1
    s_and_b32 s90, s89, 3
    s_lshl_b32 s90, s90, 14
    s_and_b32 s28, s89, 7
    s_lshl_b32 s28, s28, 15
    s_add_u32 s28, s28, s49
    s_add_u32 s26, s90, s49
    s_mov_b32 m0, s26
    s_add_u32 s26, s26, 65536
    s_cmp_lt_u32 s89, 48
    s_cbranch_scc1 L_ldB_3
    s_cmp_eq_u32 s84, 0
    s_cselect_b32 s52, 2, 0
    s_lshl_b32 s26, s84, 22
    s_lshl_b32 s27, s87, 18
    s_add_u32 s26, s26, s27
    s_add_u32 s26, s26, 17825792
    s_add_u32 s8, s4, s26
    s_addc_u32 s9, s5, 0
    s_and_b32 s9, s9, 0xffff
    s_mov_b32 s10, 262144
    s_mov_b32 s11, 0x20000
    s_cmp_eq_u32 s84, 0
    s_cselect_b32 s27, s72, s78
    s_cselect_b32 s28, s73, s79
    s_lshl_b32 s26, s88, 8
    s_sub_u32 s29, 2097152, s26
    s_add_u32 s12, s27, s26
    s_addc_u32 s13, s28, 0
    s_and_b32 s13, s13, 0xffff
    s_mov_b32 s14, s29
    s_mov_b32 s15, 0x20000
    s_lshl_b32 s26, s24, 15
    v_add_u32 v4, s26, v7
    v_lshrrev_b32 v8, 4, v2
    s_and_b32 s26, s24, 1
    s_lshl_b32 s26, s26, 2
    v_or_b32 v9, s26, v8
    v_and_b32 v10, 15, v2
    v_lshrrev_b32 v10, 1, v10
    v_xor_b32 v9, v9, v10
    v_lshlrev_b32 v9, 5, v9
    v_and_b32 v10, 1, v2
    v_lshlrev_b32 v10, 4, v10
    v_add_u32 v9, v9, v10
    s_lshl_b32 s26, s24, 2
    v_add_u32 v8, s26, v8
    v_lshlrev_b32 v8, 11, v8
    v_add_u32 v5, v8, v9
    s_and_b32 s90, s89, 3
    s_lshl_b32 s90, s90, 14
    s_and_b32 s29, s89, 15
    s_and_b32 s26, s89, 2
    s_lshl_b32 s26, s26, 1
    s_and_b32 s27, s89, 4
    s_lshr_b32 s27, s27, 1
    s_or_b32 s26, s26, s27
    s_and_b32 s29, s29, 9
    s_or_b32 s29, s29, s26
    s_lshl_b32 s27, s29, 11
    s_add_u32 s26, s90, s50
    s_mov_b32 m0, s26
    s_add_u32 s26, s26, 8192
    s_waitcnt vmcnt(8)
    s_barrier
    buffer_load_dwordx4 v4, s[8:11], s27 offen lds
    buffer_load_dwordx4 v4, s[8:11], s27 offen offset:1024 lds
    s_mov_b32 m0, s26
    s_add_u32 s27, s27, 0x20000
    buffer_load_dwordx4 v4, s[8:11], s27 offen lds
    buffer_load_dwordx4 v4, s[8:11], s27 offen offset:1024 lds
    s_lshl_b32 s27, s29, 17
    s_add_u32 s26, s90, s48
    s_add_u32 s26, s26, 65536
    s_mov_b32 m0, s26
    s_add_u32 s26, s26, 4096
    buffer_load_dwordx4 v5, s[12:15], s27 offen lds
    s_add_u32 s27, s27, 32768
    s_mov_b32 m0, s26
    s_add_u32 s26, s26, 4096
    buffer_load_dwordx4 v5, s[12:15], s27 offen lds
    s_add_u32 s27, s27, 32768
    s_mov_b32 m0, s26
    s_add_u32 s26, s26, 4096
    buffer_load_dwordx4 v5, s[12:15], s27 offen lds
    s_add_u32 s27, s27, 32768
    s_mov_b32 m0, s26
    s_add_u32 s26, s26, 4096
    buffer_load_dwordx4 v5, s[12:15], s27 offen lds
    s_add_u32 s27, s27, 32768
    s_add_u32 s89, s89, 1
    s_and_b32 s90, s89, 3
    s_lshl_b32 s90, s90, 14
    s_and_b32 s29, s89, 15
    s_and_b32 s26, s89, 2
    s_lshl_b32 s26, s26, 1
    s_and_b32 s27, s89, 4
    s_lshr_b32 s27, s27, 1
    s_or_b32 s26, s26, s27
    s_and_b32 s29, s29, 9
    s_or_b32 s29, s29, s26
    s_lshl_b32 s27, s29, 11
    s_add_u32 s26, s90, s50
    s_mov_b32 m0, s26
    s_add_u32 s26, s26, 8192
L_ldB_4:
    s_waitcnt vmcnt(8)
    s_barrier
    buffer_load_dwordx4 v4, s[8:11], s27 offen lds
    buffer_load_dwordx4 v4, s[8:11], s27 offen offset:1024 lds
    s_mov_b32 m0, s26
    s_add_u32 s27, s27, 0x20000
    buffer_load_dwordx4 v4, s[8:11], s27 offen lds
    buffer_load_dwordx4 v4, s[8:11], s27 offen offset:1024 lds
    s_lshl_b32 s27, s29, 17
    s_add_u32 s26, s90, s48
    s_add_u32 s26, s26, 65536
    s_mov_b32 m0, s26
    s_add_u32 s26, s26, 4096
    buffer_load_dwordx4 v5, s[12:15], s27 offen lds
    s_add_u32 s27, s27, 32768
    s_mov_b32 m0, s26
    s_add_u32 s26, s26, 4096
    buffer_load_dwordx4 v5, s[12:15], s27 offen lds
    s_add_u32 s27, s27, 32768
    s_mov_b32 m0, s26
    s_add_u32 s26, s26, 4096
    buffer_load_dwordx4 v5, s[12:15], s27 offen lds
    s_add_u32 s27, s27, 32768
    s_mov_b32 m0, s26
    s_add_u32 s26, s26, 4096
    buffer_load_dwordx4 v5, s[12:15], s27 offen lds
    s_add_u32 s27, s27, 32768
    s_add_u32 s89, s89, 1
    s_and_b32 s90, s89, 3
    s_lshl_b32 s90, s90, 14
    s_and_b32 s29, s89, 15
    s_and_b32 s26, s89, 2
    s_lshl_b32 s26, s26, 1
    s_and_b32 s27, s89, 4
    s_lshr_b32 s27, s27, 1
    s_or_b32 s26, s26, s27
    s_and_b32 s29, s29, 9
    s_or_b32 s29, s29, s26
    s_lshl_b32 s27, s29, 11
    s_add_u32 s26, s90, s50
    s_mov_b32 m0, s26
    s_add_u32 s26, s26, 8192
    s_cmp_lt_u32 s89, 52
    s_cbranch_scc1 L_ldB_4
    s_and_b32 s90, s89, 3
    s_lshl_b32 s90, s90, 14
    s_and_b32 s29, s89, 15
    s_and_b32 s26, s89, 2
    s_lshl_b32 s26, s26, 1
    s_and_b32 s27, s89, 4
    s_lshr_b32 s27, s27, 1
    s_or_b32 s26, s26, s27
    s_and_b32 s29, s29, 9
    s_or_b32 s29, s29, s26
    s_lshl_b32 s27, s29, 11
    s_add_u32 s26, s90, s50
    s_mov_b32 m0, s26
    s_add_u32 s26, s26, 8192
    s_waitcnt vmcnt(8)
    s_barrier
    buffer_load_dwordx4 v4, s[8:11], s27 offen lds
    buffer_load_dwordx4 v4, s[8:11], s27 offen offset:1024 lds
    s_mov_b32 m0, s26
    s_add_u32 s27, s27, 0x20000
    buffer_load_dwordx4 v4, s[8:11], s27 offen lds
    buffer_load_dwordx4 v4, s[8:11], s27 offen offset:1024 lds
    s_lshl_b32 s27, s29, 17
    s_add_u32 s26, s90, s48
    s_add_u32 s26, s26, 65536
    s_mov_b32 m0, s26
    s_add_u32 s26, s26, 4096
    buffer_load_dwordx4 v5, s[12:15], s27 offen lds
    s_add_u32 s27, s27, 32768
    s_mov_b32 m0, s26
    s_add_u32 s26, s26, 4096
    buffer_load_dwordx4 v5, s[12:15], s27 offen lds
    s_add_u32 s27, s27, 32768
    s_mov_b32 m0, s26
    s_add_u32 s26, s26, 4096
    buffer_load_dwordx4 v5, s[12:15], s27 offen lds
    s_add_u32 s27, s27, 32768
    s_mov_b32 m0, s26
    s_add_u32 s26, s26, 4096
    buffer_load_dwordx4 v5, s[12:15], s27 offen lds
    s_add_u32 s27, s27, 32768
    s_add_u32 s89, s89, 1
    s_and_b32 s90, s89, 3
    s_lshl_b32 s90, s90, 14
    s_and_b32 s29, s89, 15
    s_and_b32 s26, s89, 2
    s_lshl_b32 s26, s26, 1
    s_and_b32 s27, s89, 4
    s_lshr_b32 s27, s27, 1
    s_or_b32 s26, s26, s27
    s_and_b32 s29, s29, 9
    s_or_b32 s29, s29, s26
    s_lshl_b32 s27, s29, 11
    s_add_u32 s26, s90, s50
    s_mov_b32 m0, s26
    s_add_u32 s26, s26, 8192
    buffer_load_dwordx4 v4, s[8:11], s27 offen lds
    buffer_load_dwordx4 v4, s[8:11], s27 offen offset:1024 lds
    s_mov_b32 m0, s26
    s_add_u32 s27, s27, 0x20000
    buffer_load_dwordx4 v4, s[8:11], s27 offen lds
    buffer_load_dwordx4 v4, s[8:11], s27 offen offset:1024 lds
    s_lshl_b32 s27, s29, 17
    s_add_u32 s26, s90, s48
    s_add_u32 s26, s26, 65536
    s_mov_b32 m0, s26
    s_add_u32 s26, s26, 4096
    buffer_load_dwordx4 v5, s[12:15], s27 offen lds
    s_add_u32 s27, s27, 32768
    s_mov_b32 m0, s26
    s_add_u32 s26, s26, 4096
    buffer_load_dwordx4 v5, s[12:15], s27 offen lds
    s_add_u32 s27, s27, 32768
    s_mov_b32 m0, s26
    s_add_u32 s26, s26, 4096
    buffer_load_dwordx4 v5, s[12:15], s27 offen lds
    s_add_u32 s27, s27, 32768
    s_mov_b32 m0, s26
    s_add_u32 s26, s26, 4096
    buffer_load_dwordx4 v5, s[12:15], s27 offen lds
    s_add_u32 s27, s27, 32768
    s_add_u32 s89, s89, 1
    s_and_b32 s90, s89, 3
    s_lshl_b32 s90, s90, 14
    s_and_b32 s29, s89, 15
    s_and_b32 s26, s89, 2
    s_lshl_b32 s26, s26, 1
    s_and_b32 s27, s89, 4
    s_lshr_b32 s27, s27, 1
    s_or_b32 s26, s26, s27
    s_and_b32 s29, s29, 9
    s_or_b32 s29, s29, s26
    s_lshl_b32 s27, s29, 11
    s_add_u32 s26, s90, s50
    s_mov_b32 m0, s26
    s_add_u32 s26, s26, 8192
L_ldB_5:
    s_waitcnt vmcnt(16)
    s_barrier
    buffer_load_dwordx4 v4, s[8:11], s27 offen lds
    buffer_load_dwordx4 v4, s[8:11], s27 offen offset:1024 lds
    s_mov_b32 m0, s26
    s_add_u32 s27, s27, 0x20000
    buffer_load_dwordx4 v4, s[8:11], s27 offen lds
    buffer_load_dwordx4 v4, s[8:11], s27 offen offset:1024 lds
    s_lshl_b32 s27, s29, 17
    s_add_u32 s26, s90, s48
    s_add_u32 s26, s26, 65536
    s_mov_b32 m0, s26
    s_add_u32 s26, s26, 4096
    buffer_load_dwordx4 v5, s[12:15], s27 offen lds
    s_add_u32 s27, s27, 32768
    s_mov_b32 m0, s26
    s_add_u32 s26, s26, 4096
    buffer_load_dwordx4 v5, s[12:15], s27 offen lds
    s_add_u32 s27, s27, 32768
    s_mov_b32 m0, s26
    s_add_u32 s26, s26, 4096
    buffer_load_dwordx4 v5, s[12:15], s27 offen lds
    s_add_u32 s27, s27, 32768
    s_mov_b32 m0, s26
    s_add_u32 s26, s26, 4096
    buffer_load_dwordx4 v5, s[12:15], s27 offen lds
    s_add_u32 s27, s27, 32768
    s_add_u32 s89, s89, 1
    s_and_b32 s90, s89, 3
    s_lshl_b32 s90, s90, 14
    s_and_b32 s29, s89, 15
    s_and_b32 s26, s89, 2
    s_lshl_b32 s26, s26, 1
    s_and_b32 s27, s89, 4
    s_lshr_b32 s27, s27, 1
    s_or_b32 s26, s26, s27
    s_and_b32 s29, s29, 9
    s_or_b32 s29, s29, s26
    s_lshl_b32 s27, s29, 11
    s_add_u32 s26, s90, s50
    s_mov_b32 m0, s26
    s_add_u32 s26, s26, 8192
    s_cmp_lt_u32 s89, 64
    s_cbranch_scc1 L_ldB_5
    s_waitcnt vmcnt(16)
    s_barrier
    s_waitcnt vmcnt(8)
    s_barrier
    s_waitcnt vmcnt(0)
    s_barrier
    s_endpgm
L_ld_A:
    s_add_u32 s29, s89, s51
    s_and_b32 s29, s29, 15
    s_and_b32 s90, s89, 3
    s_lshl_b32 s90, s90, 14
    s_lshl_b32 s28, s29, 7
    s_add_u32 s26, s90, s48
    s_mov_b32 m0, s26
    s_add_u32 s27, s40, s28
    s_add_u32 s26, s26, 4096
    buffer_load_dwordx4 v4, s[8:11], s27 offen lds
    s_mov_b32 m0, s26
    s_add_u32 s27, s41, s28
    s_add_u32 s26, s26, 4096
    buffer_load_dwordx4 v4, s[8:11], s27 offen lds
    s_mov_b32 m0, s26
    s_add_u32 s27, s42, s28
    s_add_u32 s26, s26, 4096
    buffer_load_dwordx4 v4, s[8:11], s27 offen lds
    s_mov_b32 m0, s26
    s_add_u32 s27, s43, s28
    s_add_u32 s26, s26, 4096
    buffer_load_dwordx4 v4, s[8:11], s27 offen lds
    s_lshl_b32 s28, s29, 6
    s_mul_i32 s28, s28, s39
    s_add_u32 s26, s90, s48
    s_add_u32 s26, s26, 65536
    s_mov_b32 m0, s26
    s_add_u32 s27, s44, s28
    s_add_u32 s26, s26, 4096
    buffer_load_dwordx4 v5, s[12:15], s27 offen lds
    s_mov_b32 m0, s26
    s_add_u32 s27, s45, s28
    s_add_u32 s26, s26, 4096
    buffer_load_dwordx4 v5, s[12:15], s27 offen lds
    s_mov_b32 m0, s26
    s_add_u32 s27, s46, s28
    s_add_u32 s26, s26, 4096
    buffer_load_dwordx4 v5, s[12:15], s27 offen lds
    s_mov_b32 m0, s26
    s_add_u32 s27, s47, s28
    s_add_u32 s26, s26, 4096
    buffer_load_dwordx4 v5, s[12:15], s27 offen lds
    s_lshr_b32 s26, s90, 2
    s_add_u32 s26, s26, s48
    s_add_u32 s26, s26, 131072
    s_mov_b32 m0, s26
    s_lshl_b32 s27, s29, 12
    buffer_load_dwordx4 v6, s[16:19], s27 offen lds
    s_add_u32 s89, s89, 1
    s_add_u32 s29, s89, s51
    s_and_b32 s29, s29, 15
    s_and_b32 s90, s89, 3
    s_lshl_b32 s90, s90, 14
    s_lshl_b32 s28, s29, 7
    s_add_u32 s26, s90, s48
    s_mov_b32 m0, s26
    s_add_u32 s27, s40, s28
    s_add_u32 s26, s26, 4096
    buffer_load_dwordx4 v4, s[8:11], s27 offen lds
    s_mov_b32 m0, s26
    s_add_u32 s27, s41, s28
    s_add_u32 s26, s26, 4096
    buffer_load_dwordx4 v4, s[8:11], s27 offen lds
    s_mov_b32 m0, s26
    s_add_u32 s27, s42, s28
    s_add_u32 s26, s26, 4096
    buffer_load_dwordx4 v4, s[8:11], s27 offen lds
    s_mov_b32 m0, s26
    s_add_u32 s27, s43, s28
    s_add_u32 s26, s26, 4096
    buffer_load_dwordx4 v4, s[8:11], s27 offen lds
    s_lshl_b32 s28, s29, 6
    s_mul_i32 s28, s28, s39
    s_add_u32 s26, s90, s48
    s_add_u32 s26, s26, 65536
    s_mov_b32 m0, s26
    s_add_u32 s27, s44, s28
    s_add_u32 s26, s26, 4096
    buffer_load_dwordx4 v5, s[12:15], s27 offen lds
    s_mov_b32 m0, s26
    s_add_u32 s27, s45, s28
    s_add_u32 s26, s26, 4096
    buffer_load_dwordx4 v5, s[12:15], s27 offen lds
    s_mov_b32 m0, s26
    s_add_u32 s27, s46, s28
    s_add_u32 s26, s26, 4096
    buffer_load_dwordx4 v5, s[12:15], s27 offen lds
    s_mov_b32 m0, s26
    s_add_u32 s27, s47, s28
    s_add_u32 s26, s26, 4096
    buffer_load_dwordx4 v5, s[12:15], s27 offen lds
    s_lshr_b32 s26, s90, 2
    s_add_u32 s26, s26, s48
    s_add_u32 s26, s26, 131072
    s_mov_b32 m0, s26
    s_lshl_b32 s27, s29, 12
    buffer_load_dwordx4 v6, s[16:19], s27 offen lds
    s_add_u32 s89, s89, 1
    s_add_u32 s29, s89, s51
    s_and_b32 s29, s29, 15
    s_and_b32 s90, s89, 3
    s_lshl_b32 s90, s90, 14
    s_lshl_b32 s28, s29, 7
    s_add_u32 s26, s90, s48
    s_mov_b32 m0, s26
    s_add_u32 s27, s40, s28
    s_add_u32 s26, s26, 4096
    buffer_load_dwordx4 v4, s[8:11], s27 offen lds
    s_mov_b32 m0, s26
    s_add_u32 s27, s41, s28
    s_add_u32 s26, s26, 4096
    buffer_load_dwordx4 v4, s[8:11], s27 offen lds
    s_mov_b32 m0, s26
    s_add_u32 s27, s42, s28
    s_add_u32 s26, s26, 4096
    buffer_load_dwordx4 v4, s[8:11], s27 offen lds
    s_mov_b32 m0, s26
    s_add_u32 s27, s43, s28
    s_add_u32 s26, s26, 4096
    buffer_load_dwordx4 v4, s[8:11], s27 offen lds
    s_lshl_b32 s28, s29, 6
    s_mul_i32 s28, s28, s39
    s_add_u32 s26, s90, s48
    s_add_u32 s26, s26, 65536
    s_mov_b32 m0, s26
    s_add_u32 s27, s44, s28
    s_add_u32 s26, s26, 4096
    buffer_load_dwordx4 v5, s[12:15], s27 offen lds
    s_mov_b32 m0, s26
    s_add_u32 s27, s45, s28
    s_add_u32 s26, s26, 4096
    buffer_load_dwordx4 v5, s[12:15], s27 offen lds
    s_mov_b32 m0, s26
    s_add_u32 s27, s46, s28
    s_add_u32 s26, s26, 4096
    buffer_load_dwordx4 v5, s[12:15], s27 offen lds
    s_mov_b32 m0, s26
    s_add_u32 s27, s47, s28
    s_add_u32 s26, s26, 4096
    buffer_load_dwordx4 v5, s[12:15], s27 offen lds
    s_lshr_b32 s26, s90, 2
    s_add_u32 s26, s26, s48
    s_add_u32 s26, s26, 131072
    s_mov_b32 m0, s26
    s_lshl_b32 s27, s29, 12
    buffer_load_dwordx4 v6, s[16:19], s27 offen lds
    s_add_u32 s89, s89, 1
    s_add_u32 s29, s89, s51
    s_and_b32 s29, s29, 15
    s_and_b32 s90, s89, 3
    s_lshl_b32 s90, s90, 14
    s_lshl_b32 s28, s29, 7
    s_add_u32 s26, s90, s48
    s_mov_b32 m0, s26
    s_add_u32 s27, s40, s28
    s_add_u32 s26, s26, 4096
L_ldA_0:
    s_waitcnt vmcnt(18)
    s_barrier
    buffer_load_dwordx4 v4, s[8:11], s27 offen lds
    s_mov_b32 m0, s26
    s_add_u32 s27, s41, s28
    s_add_u32 s26, s26, 4096
    buffer_load_dwordx4 v4, s[8:11], s27 offen lds
    s_mov_b32 m0, s26
    s_add_u32 s27, s42, s28
    s_add_u32 s26, s26, 4096
    buffer_load_dwordx4 v4, s[8:11], s27 offen lds
    s_mov_b32 m0, s26
    s_add_u32 s27, s43, s28
    s_add_u32 s26, s26, 4096
    buffer_load_dwordx4 v4, s[8:11], s27 offen lds
    s_lshl_b32 s28, s29, 6
    s_mul_i32 s28, s28, s39
    s_add_u32 s26, s90, s48
    s_add_u32 s26, s26, 65536
    s_mov_b32 m0, s26
    s_add_u32 s27, s44, s28
    s_add_u32 s26, s26, 4096
    buffer_load_dwordx4 v5, s[12:15], s27 offen lds
    s_mov_b32 m0, s26
    s_add_u32 s27, s45, s28
    s_add_u32 s26, s26, 4096
    buffer_load_dwordx4 v5, s[12:15], s27 offen lds
    s_mov_b32 m0, s26
    s_add_u32 s27, s46, s28
    s_add_u32 s26, s26, 4096
    buffer_load_dwordx4 v5, s[12:15], s27 offen lds
    s_mov_b32 m0, s26
    s_add_u32 s27, s47, s28
    s_add_u32 s26, s26, 4096
    buffer_load_dwordx4 v5, s[12:15], s27 offen lds
    s_lshr_b32 s26, s90, 2
    s_add_u32 s26, s26, s48
    s_add_u32 s26, s26, 131072
    s_mov_b32 m0, s26
    s_lshl_b32 s27, s29, 12
    buffer_load_dwordx4 v6, s[16:19], s27 offen lds
    s_add_u32 s89, s89, 1
    s_add_u32 s29, s89, s51
    s_and_b32 s29, s29, 15
    s_and_b32 s90, s89, 3
    s_lshl_b32 s90, s90, 14
    s_lshl_b32 s28, s29, 7
    s_add_u32 s26, s90, s48
    s_mov_b32 m0, s26
    s_add_u32 s27, s40, s28
    s_add_u32 s26, s26, 4096
    s_cmp_lt_u32 s89, 16
    s_cbranch_scc1 L_ldA_0
    s_mov_b32 s33, 1
    s_cmp_eq_u32 s36, 3
    s_cselect_b32 s26, s64, s74
    s_cselect_b32 s27, s65, s75
    s_lshl_b32 s28, s34, 18
    s_add_u32 s8, s26, s28
    s_addc_u32 s9, s27, 0
    s_and_b32 s9, s9, 0xffff
    s_mov_b32 s10, 262144
    s_mov_b32 s11, 0x20000
    s_cmp_eq_u32 s36, 3
    s_cselect_b32 s26, s66, s76
    s_cselect_b32 s27, s67, s77
    s_cselect_b32 s28, 0, s36
    s_lshl_b32 s28, s28, 11
    s_lshr_b32 s29, s35, 1
    s_xor_b32 s29, s29, s33
    s_lshl_b32 s29, s29, 2
    s_and_b32 s30, s35, 1
    s_add_u32 s29, s29, s30
    s_lshl_b32 s30, s33, 3
    s_add_u32 s29, s29, s30
    s_lshl_b32 s29, s29, 7
    s_add_u32 s28, s28, s29
    s_lshl_b32 s29, s39, 10
    s_sub_u32 s29, s29, s28
    s_add_u32 s12, s26, s28
    s_addc_u32 s13, s27, 0
    s_and_b32 s13, s13, 0xffff
    s_mov_b32 s14, s29
    s_mov_b32 s15, 0x20000
    s_add_u32 s26, s24, 0
    s_lshl_b32 s40, s26, 14
    s_add_u32 s26, s24, 4
    s_lshl_b32 s41, s26, 14
    s_add_u32 s26, s24, 8
    s_lshl_b32 s42, s26, 14
    s_add_u32 s26, s24, 12
    s_lshl_b32 s43, s26, 14
    s_and_b32 s26, s32, 7
    s_lshl_b32 s51, s26, 1
    s_add_u32 s29, s89, s51
    s_and_b32 s29, s29, 15
    s_and_b32 s90, s89, 3
    s_lshl_b32 s90, s90, 14
    s_lshl_b32 s28, s29, 7
    s_add_u32 s26, s90, s48
    s_mov_b32 m0, s26
    s_add_u32 s27, s40, s28
    s_add_u32 s26, s26, 4096
    s_waitcnt vmcnt(18)
    s_barrier
    buffer_load_dwordx4 v4, s[8:11], s27 offen lds
    s_mov_b32 m0, s26
    s_add_u32 s27, s41, s28
    s_add_u32 s26, s26, 4096
    buffer_load_dwordx4 v4, s[8:11], s27 offen lds
    s_mov_b32 m0, s26
    s_add_u32 s27, s42, s28
    s_add_u32 s26, s26, 4096
    buffer_load_dwordx4 v4, s[8:11], s27 offen lds
    s_mov_b32 m0, s26
    s_add_u32 s27, s43, s28
    s_add_u32 s26, s26, 4096
    buffer_load_dwordx4 v4, s[8:11], s27 offen lds
    s_lshl_b32 s28, s29, 6
    s_mul_i32 s28, s28, s39
    s_add_u32 s26, s90, s48
    s_add_u32 s26, s26, 65536
    s_mov_b32 m0, s26
    s_add_u32 s27, s44, s28
    s_add_u32 s26, s26, 4096
    buffer_load_dwordx4 v5, s[12:15], s27 offen lds
    s_mov_b32 m0, s26
    s_add_u32 s27, s45, s28
    s_add_u32 s26, s26, 4096
    buffer_load_dwordx4 v5, s[12:15], s27 offen lds
    s_mov_b32 m0, s26
    s_add_u32 s27, s46, s28
    s_add_u32 s26, s26, 4096
    buffer_load_dwordx4 v5, s[12:15], s27 offen lds
    s_mov_b32 m0, s26
    s_add_u32 s27, s47, s28
    s_add_u32 s26, s26, 4096
    buffer_load_dwordx4 v5, s[12:15], s27 offen lds
    s_add_u32 s89, s89, 1
    s_add_u32 s29, s89, s51
    s_and_b32 s29, s29, 15
    s_and_b32 s90, s89, 3
    s_lshl_b32 s90, s90, 14
    s_lshl_b32 s28, s29, 7
    s_add_u32 s26, s90, s48
    s_mov_b32 m0, s26
    s_add_u32 s27, s40, s28
    s_add_u32 s26, s26, 4096
    s_waitcnt vmcnt(17)
    s_barrier
    buffer_load_dwordx4 v4, s[8:11], s27 offen lds
    s_mov_b32 m0, s26
    s_add_u32 s27, s41, s28
    s_add_u32 s26, s26, 4096
    buffer_load_dwordx4 v4, s[8:11], s27 offen lds
    s_mov_b32 m0, s26
    s_add_u32 s27, s42, s28
    s_add_u32 s26, s26, 4096
    buffer_load_dwordx4 v4, s[8:11], s27 offen lds
    s_mov_b32 m0, s26
    s_add_u32 s27, s43, s28
    s_add_u32 s26, s26, 4096
    buffer_load_dwordx4 v4, s[8:11], s27 offen lds
    s_lshl_b32 s28, s29, 6
    s_mul_i32 s28, s28, s39
    s_add_u32 s26, s90, s48
    s_add_u32 s26, s26, 65536
    s_mov_b32 m0, s26
    s_add_u32 s27, s44, s28
    s_add_u32 s26, s26, 4096
    buffer_load_dwordx4 v5, s[12:15], s27 offen lds
    s_mov_b32 m0, s26
    s_add_u32 s27, s45, s28
    s_add_u32 s26, s26, 4096
    buffer_load_dwordx4 v5, s[12:15], s27 offen lds
    s_mov_b32 m0, s26
    s_add_u32 s27, s46, s28
    s_add_u32 s26, s26, 4096
    buffer_load_dwordx4 v5, s[12:15], s27 offen lds
    s_mov_b32 m0, s26
    s_add_u32 s27, s47, s28
    s_add_u32 s26, s26, 4096
    buffer_load_dwordx4 v5, s[12:15], s27 offen lds
    s_add_u32 s89, s89, 1
    s_waitcnt vmcnt(16)
    s_barrier
    s_add_u32 s29, s89, s51
    s_and_b32 s29, s29, 15
    s_and_b32 s90, s89, 3
    s_lshl_b32 s90, s90, 14
    s_lshl_b32 s28, s29, 7
    s_add_u32 s26, s90, s48
    s_mov_b32 m0, s26
    s_add_u32 s27, s40, s28
    s_add_u32 s26, s26, 4096
L_ldA_1:
    s_waitcnt vmcnt(8)
    s_barrier
    buffer_load_dwordx4 v4, s[8:11], s27 offen lds
    s_mov_b32 m0, s26
    s_add_u32 s27, s41, s28
    s_add_u32 s26, s26, 4096
    buffer_load_dwordx4 v4, s[8:11], s27 offen lds
    s_mov_b32 m0, s26
    s_add_u32 s27, s42, s28
    s_add_u32 s26, s26, 4096
    buffer_load_dwordx4 v4, s[8:11], s27 offen lds
    s_mov_b32 m0, s26
    s_add_u32 s27, s43, s28
    s_add_u32 s26, s26, 4096
    buffer_load_dwordx4 v4, s[8:11], s27 offen lds
    s_lshl_b32 s28, s29, 6
    s_mul_i32 s28, s28, s39
    s_add_u32 s26, s90, s48
    s_add_u32 s26, s26, 65536
    s_mov_b32 m0, s26
    s_add_u32 s27, s44, s28
    s_add_u32 s26, s26, 4096
    buffer_load_dwordx4 v5, s[12:15], s27 offen lds
    s_mov_b32 m0, s26
    s_add_u32 s27, s45, s28
    s_add_u32 s26, s26, 4096
    buffer_load_dwordx4 v5, s[12:15], s27 offen lds
    s_mov_b32 m0, s26
    s_add_u32 s27, s46, s28
    s_add_u32 s26, s26, 4096
    buffer_load_dwordx4 v5, s[12:15], s27 offen lds
    s_mov_b32 m0, s26
    s_add_u32 s27, s47, s28
    s_add_u32 s26, s26, 4096
    buffer_load_dwordx4 v5, s[12:15], s27 offen lds
    s_add_u32 s89, s89, 1
    s_add_u32 s29, s89, s51
    s_and_b32 s29, s29, 15
    s_and_b32 s90, s89, 3
    s_lshl_b32 s90, s90, 14
    s_lshl_b32 s28, s29, 7
    s_add_u32 s26, s90, s48
    s_mov_b32 m0, s26
    s_add_u32 s27, s40, s28
    s_add_u32 s26, s26, 4096
    s_cmp_lt_u32 s89, 32
    s_cbranch_scc1 L_ldA_1
    s_mov_b32 s33, 0
    s_lshl_b32 s26, s33, 4
    s_add_u32 s26, s26, s85
    s_lshl_b32 s26, s26, 18
    s_add_u32 s26, s26, 8388608
    s_cmp_eq_u32 s84, 0
    s_cselect_b32 s26, 16777216, s26
    s_add_u32 s8, s4, s26
    s_addc_u32 s9, s5, 0
    s_and_b32 s9, s9, 0xffff
    s_mov_b32 s10, 262144
    s_mov_b32 s11, 0x20000
    s_lshl_b32 s26, s84, 5
    s_add_u32 s26, s26, s85
    s_add_u32 s26, s26, 0
    s_lshl_b32 s26, s26, 17
    s_lshl_b32 s27, s86, 14
    s_add_u32 s26, s26, s27
    s_add_u32 s16, s4, s26
    s_addc_u32 s17, s5, 0
    s_and_b32 s17, s17, 0xffff
    s_mov_b32 s18, 16384
    s_mov_b32 s19, 0x20000
    s_and_b32 s90, s89, 3
    s_lshl_b32 s90, s90, 14
    s_and_b32 s28, s89, 7
    s_lshl_b32 s28, s28, 15
    s_add_u32 s28, s28, s49
    s_add_u32 s26, s90, s49
    s_mov_b32 m0, s26
    s_add_u32 s26, s26, 65536
    s_waitcnt vmcnt(8)
    s_barrier
    buffer_load_dwordx4 v7, s[8:11], s28 offen offset:0 lds
    buffer_load_dwordx4 v7, s[8:11], s28 offen offset:1024 lds
    buffer_load_dwordx4 v7, s[8:11], s28 offen offset:2048 lds
    buffer_load_dwordx4 v7, s[8:11], s28 offen offset:3072 lds
    s_mov_b32 m0, s26
    s_add_u32 s28, s28, 16384
    buffer_load_dwordx4 v7, s[8:11], s28 offen offset:0 lds
    buffer_load_dwordx4 v7, s[8:11], s28 offen offset:1024 lds
    buffer_load_dwordx4 v7, s[8:11], s28 offen offset:2048 lds
    buffer_load_dwordx4 v7, s[8:11], s28 offen offset:3072 lds
    s_add_u32 s89, s89, 1
    s_add_u32 s26, s49, 131072
    s_mov_b32 m0, s26
    s_nop 0
    buffer_load_dwordx4 v7, s[16:19], s49 offen offset:0 lds
    buffer_load_dwordx4 v7, s[16:19], s49 offen offset:1024 lds
    buffer_load_dwordx4 v7, s[16:19], s49 offen offset:2048 lds
    buffer_load_dwordx4 v7, s[16:19], s49 offen offset:3072 lds
    s_and_b32 s90, s89, 3
    s_lshl_b32 s90, s90, 14
    s_and_b32 s28, s89, 7
    s_lshl_b32 s28, s28, 15
    s_add_u32 s28, s28, s49
    s_add_u32 s26, s90, s49
    s_mov_b32 m0, s26
    s_add_u32 s26, s26, 65536
    s_waitcnt vmcnt(12)
    s_barrier
    buffer_load_dwordx4 v7, s[8:11], s28 offen offset:0 lds
    buffer_load_dwordx4 v7, s[8:11], s28 offen offset:1024 lds
    buffer_load_dwordx4 v7, s[8:11], s28 offen offset:2048 lds
    buffer_load_dwordx4 v7, s[8:11], s28 offen offset:3072 lds
    s_mov_b32 m0, s26
    s_add_u32 s28, s28, 16384
    buffer_load_dwordx4 v7, s[8:11], s28 offen offset:0 lds
    buffer_load_dwordx4 v7, s[8:11], s28 offen offset:1024 lds
    buffer_load_dwordx4 v7, s[8:11], s28 offen offset:2048 lds
    buffer_load_dwordx4 v7, s[8:11], s28 offen offset:3072 lds
    s_add_u32 s89, s89, 1
    s_waitcnt vmcnt(8)
    s_barrier
    s_and_b32 s90, s89, 3
    s_lshl_b32 s90, s90, 14
    s_and_b32 s28, s89, 7
    s_lshl_b32 s28, s28, 15
    s_add_u32 s28, s28, s49
    s_add_u32 s26, s90, s49
    s_mov_b32 m0, s26
    s_add_u32 s26, s26, 65536
    s_waitcnt vmcnt(0)
    s_barrier
    buffer_load_dwordx4 v7, s[8:11], s28 offen offset:0 lds
    buffer_load_dwordx4 v7, s[8:11], s28 offen offset:1024 lds
    buffer_load_dwordx4 v7, s[8:11], s28 offen offset:2048 lds
    buffer_load_dwordx4 v7, s[8:11], s28 offen offset:3072 lds
    s_mov_b32 m0, s26
    s_add_u32 s28, s28, 16384
    buffer_load_dwordx4 v7, s[8:11], s28 offen offset:0 lds
    buffer_load_dwordx4 v7, s[8:11], s28 offen offset:1024 lds
    buffer_load_dwordx4 v7, s[8:11], s28 offen offset:2048 lds
    buffer_load_dwordx4 v7, s[8:11], s28 offen offset:3072 lds
    s_add_u32 s89, s89, 1
    s_and_b32 s90, s89, 3
    s_lshl_b32 s90, s90, 14
    s_and_b32 s28, s89, 7
    s_lshl_b32 s28, s28, 15
    s_add_u32 s28, s28, s49
    s_add_u32 s26, s90, s49
    s_mov_b32 m0, s26
    s_add_u32 s26, s26, 65536
    buffer_load_dwordx4 v7, s[8:11], s28 offen offset:0 lds
    buffer_load_dwordx4 v7, s[8:11], s28 offen offset:1024 lds
    buffer_load_dwordx4 v7, s[8:11], s28 offen offset:2048 lds
    buffer_load_dwordx4 v7, s[8:11], s28 offen offset:3072 lds
    s_mov_b32 m0, s26
    s_add_u32 s28, s28, 16384
    buffer_load_dwordx4 v7, s[8:11], s28 offen offset:0 lds
    buffer_load_dwordx4 v7, s[8:11], s28 offen offset:1024 lds
    buffer_load_dwordx4 v7, s[8:11], s28 offen offset:2048 lds
    buffer_load_dwordx4 v7, s[8:11], s28 offen offset:3072 lds
    s_add_u32 s89, s89, 1
    s_and_b32 s90, s89, 3
    s_lshl_b32 s90, s90, 14
    s_and_b32 s28, s89, 7
    s_lshl_b32 s28, s28, 15
    s_add_u32 s28, s28, s49
    s_add_u32 s26, s90, s49
    s_mov_b32 m0, s26
    s_add_u32 s26, s26, 65536
L_ldA_2:
    s_waitcnt vmcnt(8)
    s_barrier
    buffer_load_dwordx4 v7, s[8:11], s28 offen offset:0 lds
    buffer_load_dwordx4 v7, s[8:11], s28 offen offset:1024 lds
    buffer_load_dwordx4 v7, s[8:11], s28 offen offset:2048 lds
    buffer_load_dwordx4 v7, s[8:11], s28 offen offset:3072 lds
    s_mov_b32 m0, s26
    s_add_u32 s28, s28, 16384
    buffer_load_dwordx4 v7, s[8:11], s28 offen offset:0 lds
    buffer_load_dwordx4 v7, s[8:11], s28 offen offset:1024 lds
    buffer_load_dwordx4 v7, s[8:11], s28 offen offset:2048 lds
    buffer_load_dwordx4 v7, s[8:11], s28 offen offset:3072 lds
    s_add_u32 s89, s89, 1
    s_and_b32 s90, s89, 3
    s_lshl_b32 s90, s90, 14
    s_and_b32 s28, s89, 7
    s_lshl_b32 s28, s28, 15
    s_add_u32 s28, s28, s49
    s_add_u32 s26, s90, s49
    s_mov_b32 m0, s26
    s_add_u32 s26, s26, 65536
    s_cmp_lt_u32 s89, 40
    s_cbranch_scc1 L_ldA_2
    s_mov_b32 s33, 1
    s_lshl_b32 s26, s33, 4
    s_add_u32 s26, s26, s85
    s_lshl_b32 s26, s26, 18
    s_add_u32 s26, s26, 8388608
    s_cmp_eq_u32 s84, 0
    s_cselect_b32 s26, 16777216, s26
    s_add_u32 s8, s4, s26
    s_addc_u32 s9, s5, 0
    s_and_b32 s9, s9, 0xffff
    s_mov_b32 s10, 262144
    s_mov_b32 s11, 0x20000
    s_lshl_b32 s26, s84, 5
    s_add_u32 s26, s26, s85
    s_add_u32 s26, s26, 16
    s_lshl_b32 s26, s26, 17
    s_lshl_b32 s27, s86, 14
    s_add_u32 s26, s26, s27
    s_add_u32 s16, s4, s26
    s_addc_u32 s17, s5, 0
    s_and_b32 s17, s17, 0xffff
    s_mov_b32 s18, 16384
    s_mov_b32 s19, 0x20000
    s_and_b32 s90, s89, 3
    s_lshl_b32 s90, s90, 14
    s_and_b32 s28, s89, 7
    s_lshl_b32 s28, s28, 15
    s_add_u32 s28, s28, s49
    s_add_u32 s26, s90, s49
    s_mov_b32 m0, s26
    s_add_u32 s26, s26, 65536
    s_waitcnt vmcnt(8)
    s_barrier
    buffer_load_dwordx4 v7, s[8:11], s28 offen offset:0 lds
    buffer_load_dwordx4 v7, s[8:11], s28 offen offset:1024 lds
    buffer_load_dwordx4 v7, s[8:11], s28 offen offset:2048 lds
    buffer_load_dwordx4 v7, s[8:11], s28 offen offset:3072 lds
    s_mov_b32 m0, s26
    s_add_u32 s28, s28, 16384
    buffer_load_dwordx4 v7, s[8:11], s28 offen offset:0 lds
    buffer_load_dwordx4 v7, s[8:11], s28 offen offset:1024 lds
    buffer_load_dwordx4 v7, s[8:11], s28 offen offset:2048 lds
    buffer_load_dwordx4 v7, s[8:11], s28 offen offset:3072 lds
    s_add_u32 s89, s89, 1
    s_add_u32 s26, s49, 131072
    s_mov_b32 m0, s26
    s_nop 0
    buffer_load_dwordx4 v7, s[16:19], s49 offen offset:0 lds
    buffer_load_dwordx4 v7, s[16:19], s49 offen offset:1024 lds
    buffer_load_dwordx4 v7, s[16:19], s49 offen offset:2048 lds
    buffer_load_dwordx4 v7, s[16:19], s49 offen offset:3072 lds
    s_and_b32 s90, s89, 3
    s_lshl_b32 s90, s90, 14
    s_and_b32 s28, s89, 7
    s_lshl_b32 s28, s28, 15
    s_add_u32 s28, s28, s49
    s_add_u32 s26, s90, s49
    s_mov_b32 m0, s26
    s_add_u32 s26, s26, 65536
    s_waitcnt vmcnt(12)
    s_barrier
    buffer_load_dwordx4 v7, s[8:11], s28 offen offset:0 lds
    buffer_load_dwordx4 v7, s[8:11], s28 offen offset:1024 lds
    buffer_load_dwordx4 v7, s[8:11], s28 offen offset:2048 lds
    buffer_load_dwordx4 v7, s[8:11], s28 offen offset:3072 lds
    s_mov_b32 m0, s26
    s_add_u32 s28, s28, 16384
    buffer_load_dwordx4 v7, s[8:11], s28 offen offset:0 lds
    buffer_load_dwordx4 v7, s[8:11], s28 offen offset:1024 lds
    buffer_load_dwordx4 v7, s[8:11], s28 offen offset:2048 lds
    buffer_load_dwordx4 v7, s[8:11], s28 offen offset:3072 lds
    s_add_u32 s89, s89, 1
    s_and_b32 s90, s89, 3
    s_lshl_b32 s90, s90, 14
    s_and_b32 s28, s89, 7
    s_lshl_b32 s28, s28, 15
    s_add_u32 s28, s28, s49
    s_add_u32 s26, s90, s49
    s_mov_b32 m0, s26
    s_add_u32 s26, s26, 65536
L_ldA_3:
    s_waitcnt vmcnt(8)
    s_barrier
    buffer_load_dwordx4 v7, s[8:11], s28 offen offset:0 lds
    buffer_load_dwordx4 v7, s[8:11], s28 offen offset:1024 lds
    buffer_load_dwordx4 v7, s[8:11], s28 offen offset:2048 lds
    buffer_load_dwordx4 v7, s[8:11], s28 offen offset:3072 lds
    s_mov_b32 m0, s26
    s_add_u32 s28, s28, 16384
    buffer_load_dwordx4 v7, s[8:11], s28 offen offset:0 lds
    buffer_load_dwordx4 v7, s[8:11], s28 offen offset:1024 lds
    buffer_load_dwordx4 v7, s[8:11], s28 offen offset:2048 lds
    buffer_load_dwordx4 v7, s[8:11], s28 offen offset:3072 lds
    s_add_u32 s89, s89, 1
    s_and_b32 s90, s89, 3
    s_lshl_b32 s90, s90, 14
    s_and_b32 s28, s89, 7
    s_lshl_b32 s28, s28, 15
    s_add_u32 s28, s28, s49
    s_add_u32 s26, s90, s49
    s_mov_b32 m0, s26
    s_add_u32 s26, s26, 65536
    s_cmp_lt_u32 s89, 48
    s_cbranch_scc1 L_ldA_3
    s_cmp_eq_u32 s84, 0
    s_cselect_b32 s52, 2, 0
    s_lshl_b32 s26, s84, 22
    s_lshl_b32 s27, s87, 18
    s_add_u32 s26, s26, s27
    s_add_u32 s26, s26, 17825792
    s_add_u32 s8, s4, s26
    s_addc_u32 s9, s5, 0
    s_and_b32 s9, s9, 0xffff
    s_mov_b32 s10, 262144
    s_mov_b32 s11, 0x20000
    s_cmp_eq_u32 s84, 0
    s_cselect_b32 s27, s72, s78
    s_cselect_b32 s28, s73, s79
    s_lshl_b32 s26, s88, 8
    s_sub_u32 s29, 2097152, s26
    s_add_u32 s12, s27, s26
    s_addc_u32 s13, s28, 0
    s_and_b32 s13, s13, 0xffff
    s_mov_b32 s14, s29
    s_mov_b32 s15, 0x20000
    s_lshl_b32 s26, s24, 15
    v_add_u32 v4, s26, v7
    v_lshrrev_b32 v8, 4, v2
    s_and_b32 s26, s24, 1
    s_lshl_b32 s26, s26, 2
    v_or_b32 v9, s26, v8
    v_and_b32 v10, 15, v2
    v_lshrrev_b32 v10, 1, v10
    v_xor_b32 v9, v9, v10
    v_lshlrev_b32 v9, 5, v9
    v_and_b32 v10, 1, v2
    v_lshlrev_b32 v10, 4, v10
    v_add_u32 v9, v9, v10
    s_lshl_b32 s26, s24, 2
    v_add_u32 v8, s26, v8
    v_lshlrev_b32 v8, 11, v8
    v_add_u32 v5, v8, v9
    s_and_b32 s90, s89, 3
    s_lshl_b32 s90, s90, 14
    s_and_b32 s29, s89, 15
    s_and_b32 s26, s89, 2
    s_lshl_b32 s26, s26, 1
    s_and_b32 s27, s89, 4
    s_lshr_b32 s27, s27, 1
    s_or_b32 s26, s26, s27
    s_and_b32 s29, s29, 9
    s_or_b32 s29, s29, s26
    s_lshl_b32 s27, s29, 11
    s_add_u32 s26, s90, s50
    s_mov_b32 m0, s26
    s_add_u32 s26, s26, 8192
    s_waitcnt vmcnt(8)
    s_barrier
    buffer_load_dwordx4 v4, s[8:11], s27 offen lds
    buffer_load_dwordx4 v4, s[8:11], s27 offen offset:1024 lds
    s_mov_b32 m0, s26
    s_add_u32 s27, s27, 0x20000
    buffer_load_dwordx4 v4, s[8:11], s27 offen lds
    buffer_load_dwordx4 v4, s[8:11], s27 offen offset:1024 lds
    s_lshl_b32 s27, s29, 17
    s_add_u32 s26, s90, s48
    s_add_u32 s26, s26, 65536
    s_mov_b32 m0, s26
    s_add_u32 s26, s26, 4096
    buffer_load_dwordx4 v5, s[12:15], s27 offen lds
    s_add_u32 s27, s27, 32768
    s_mov_b32 m0, s26
    s_add_u32 s26, s26, 4096
    buffer_load_dwordx4 v5, s[12:15], s27 offen lds
    s_add_u32 s27, s27, 32768
    s_mov_b32 m0, s26
    s_add_u32 s26, s26, 4096
    buffer_load_dwordx4 v5, s[12:15], s27 offen lds
    s_add_u32 s27, s27, 32768
    s_mov_b32 m0, s26
    s_add_u32 s26, s26, 4096
    buffer_load_dwordx4 v5, s[12:15], s27 offen lds
    s_add_u32 s27, s27, 32768
    s_add_u32 s89, s89, 1
    s_and_b32 s90, s89, 3
    s_lshl_b32 s90, s90, 14
    s_and_b32 s29, s89, 15
    s_and_b32 s26, s89, 2
    s_lshl_b32 s26, s26, 1
    s_and_b32 s27, s89, 4
    s_lshr_b32 s27, s27, 1
    s_or_b32 s26, s26, s27
    s_and_b32 s29, s29, 9
    s_or_b32 s29, s29, s26
    s_lshl_b32 s27, s29, 11
    s_add_u32 s26, s90, s50
    s_mov_b32 m0, s26
    s_add_u32 s26, s26, 8192
L_ldA_4:
    s_waitcnt vmcnt(8)
    s_barrier
    buffer_load_dwordx4 v4, s[8:11], s27 offen lds
    buffer_load_dwordx4 v4, s[8:11], s27 offen offset:1024 lds
    s_mov_b32 m0, s26
    s_add_u32 s27, s27, 0x20000
    buffer_load_dwordx4 v4, s[8:11], s27 offen lds
    buffer_load_dwordx4 v4, s[8:11], s27 offen offset:1024 lds
    s_lshl_b32 s27, s29, 17
    s_add_u32 s26, s90, s48
    s_add_u32 s26, s26, 65536
    s_mov_b32 m0, s26
    s_add_u32 s26, s26, 4096
    buffer_load_dwordx4 v5, s[12:15], s27 offen lds
    s_add_u32 s27, s27, 32768
    s_mov_b32 m0, s26
    s_add_u32 s26, s26, 4096
    buffer_load_dwordx4 v5, s[12:15], s27 offen lds
    s_add_u32 s27, s27, 32768
    s_mov_b32 m0, s26
    s_add_u32 s26, s26, 4096
    buffer_load_dwordx4 v5, s[12:15], s27 offen lds
    s_add_u32 s27, s27, 32768
    s_mov_b32 m0, s26
    s_add_u32 s26, s26, 4096
    buffer_load_dwordx4 v5, s[12:15], s27 offen lds
    s_add_u32 s27, s27, 32768
    s_add_u32 s89, s89, 1
    s_and_b32 s90, s89, 3
    s_lshl_b32 s90, s90, 14
    s_and_b32 s29, s89, 15
    s_and_b32 s26, s89, 2
    s_lshl_b32 s26, s26, 1
    s_and_b32 s27, s89, 4
    s_lshr_b32 s27, s27, 1
    s_or_b32 s26, s26, s27
    s_and_b32 s29, s29, 9
    s_or_b32 s29, s29, s26
    s_lshl_b32 s27, s29, 11
    s_add_u32 s26, s90, s50
    s_mov_b32 m0, s26
    s_add_u32 s26, s26, 8192
    s_cmp_lt_u32 s89, 52
    s_cbranch_scc1 L_ldA_4
    s_and_b32 s90, s89, 3
    s_lshl_b32 s90, s90, 14
    s_and_b32 s29, s89, 15
    s_and_b32 s26, s89, 2
    s_lshl_b32 s26, s26, 1
    s_and_b32 s27, s89, 4
    s_lshr_b32 s27, s27, 1
    s_or_b32 s26, s26, s27
    s_and_b32 s29, s29, 9
    s_or_b32 s29, s29, s26
    s_lshl_b32 s27, s29, 11
    s_add_u32 s26, s90, s50
    s_mov_b32 m0, s26
    s_add_u32 s26, s26, 8192
    s_waitcnt vmcnt(8)
    s_barrier
    buffer_load_dwordx4 v4, s[8:11], s27 offen lds
    buffer_load_dwordx4 v4, s[8:11], s27 offen offset:1024 lds
    s_mov_b32 m0, s26
    s_add_u32 s27, s27, 0x20000
    buffer_load_dwordx4 v4, s[8:11], s27 offen lds
    buffer_load_dwordx4 v4, s[8:11], s27 offen offset:1024 lds
    s_lshl_b32 s27, s29, 17
    s_add_u32 s26, s90, s48
    s_add_u32 s26, s26, 65536
    s_mov_b32 m0, s26
    s_add_u32 s26, s26, 4096
    buffer_load_dwordx4 v5, s[12:15], s27 offen lds
    s_add_u32 s27, s27, 32768
    s_mov_b32 m0, s26
    s_add_u32 s26, s26, 4096
    buffer_load_dwordx4 v5, s[12:15], s27 offen lds
    s_add_u32 s27, s27, 32768
    s_mov_b32 m0, s26
    s_add_u32 s26, s26, 4096
    buffer_load_dwordx4 v5, s[12:15], s27 offen lds
    s_add_u32 s27, s27, 32768
    s_mov_b32 m0, s26
    s_add_u32 s26, s26, 4096
    buffer_load_dwordx4 v5, s[12:15], s27 offen lds
    s_add_u32 s27, s27, 32768
    s_add_u32 s89, s89, 1
    s_and_b32 s90, s89, 3
    s_lshl_b32 s90, s90, 14
    s_and_b32 s29, s89, 15
    s_and_b32 s26, s89, 2
    s_lshl_b32 s26, s26, 1
    s_and_b32 s27, s89, 4
    s_lshr_b32 s27, s27, 1
    s_or_b32 s26, s26, s27
    s_and_b32 s29, s29, 9
    s_or_b32 s29, s29, s26
    s_lshl_b32 s27, s29, 11
    s_add_u32 s26, s90, s50
    s_mov_b32 m0, s26
    s_add_u32 s26, s26, 8192
    buffer_load_dwordx4 v4, s[8:11], s27 offen lds
    buffer_load_dwordx4 v4, s[8:11], s27 offen offset:1024 lds
    s_mov_b32 m0, s26
    s_add_u32 s27, s27, 0x20000
    buffer_load_dwordx4 v4, s[8:11], s27 offen lds
    buffer_load_dwordx4 v4, s[8:11], s27 offen offset:1024 lds
    s_lshl_b32 s27, s29, 17
    s_add_u32 s26, s90, s48
    s_add_u32 s26, s26, 65536
    s_mov_b32 m0, s26
    s_add_u32 s26, s26, 4096
    buffer_load_dwordx4 v5, s[12:15], s27 offen lds
    s_add_u32 s27, s27, 32768
    s_mov_b32 m0, s26
    s_add_u32 s26, s26, 4096
    buffer_load_dwordx4 v5, s[12:15], s27 offen lds
    s_add_u32 s27, s27, 32768
    s_mov_b32 m0, s26
    s_add_u32 s26, s26, 4096
    buffer_load_dwordx4 v5, s[12:15], s27 offen lds
    s_add_u32 s27, s27, 32768
    s_mov_b32 m0, s26
    s_add_u32 s26, s26, 4096
    buffer_load_dwordx4 v5, s[12:15], s27 offen lds
    s_add_u32 s27, s27, 32768
    s_add_u32 s89, s89, 1
    s_and_b32 s90, s89, 3
    s_lshl_b32 s90, s90, 14
    s_and_b32 s29, s89, 15
    s_and_b32 s26, s89, 2
    s_lshl_b32 s26, s26, 1
    s_and_b32 s27, s89, 4
    s_lshr_b32 s27, s27, 1
    s_or_b32 s26, s26, s27
    s_and_b32 s29, s29, 9
    s_or_b32 s29, s29, s26
    s_lshl_b32 s27, s29, 11
    s_add_u32 s26, s90, s50
    s_mov_b32 m0, s26
    s_add_u32 s26, s26, 8192
L_ldA_5:
    s_waitcnt vmcnt(16)
    s_barrier
    buffer_load_dwordx4 v4, s[8:11], s27 offen lds
    buffer_load_dwordx4 v4, s[8:11], s27 offen offset:1024 lds
    s_mov_b32 m0, s26
    s_add_u32 s27, s27, 0x20000
    buffer_load_dwordx4 v4, s[8:11], s27 offen lds
    buffer_load_dwordx4 v4, s[8:11], s27 offen offset:1024 lds
    s_lshl_b32 s27, s29, 17
    s_add_u32 s26, s90, s48
    s_add_u32 s26, s26, 65536
    s_mov_b32 m0, s26
    s_add_u32 s26, s26, 4096
    buffer_load_dwordx4 v5, s[12:15], s27 offen lds
    s_add_u32 s27, s27, 32768
    s_mov_b32 m0, s26
    s_add_u32 s26, s26, 4096
    buffer_load_dwordx4 v5, s[12:15], s27 offen lds
    s_add_u32 s27, s27, 32768
    s_mov_b32 m0, s26
    s_add_u32 s26, s26, 4096
    buffer_load_dwordx4 v5, s[12:15], s27 offen lds
    s_add_u32 s27, s27, 32768
    s_mov_b32 m0, s26
    s_add_u32 s26, s26, 4096
    buffer_load_dwordx4 v5, s[12:15], s27 offen lds
    s_add_u32 s27, s27, 32768
    s_add_u32 s89, s89, 1
    s_and_b32 s90, s89, 3
    s_lshl_b32 s90, s90, 14
    s_and_b32 s29, s89, 15
    s_and_b32 s26, s89, 2
    s_lshl_b32 s26, s26, 1
    s_and_b32 s27, s89, 4
    s_lshr_b32 s27, s27, 1
    s_or_b32 s26, s26, s27
    s_and_b32 s29, s29, 9
    s_or_b32 s29, s29, s26
    s_lshl_b32 s27, s29, 11
    s_add_u32 s26, s90, s50
    s_mov_b32 m0, s26
    s_add_u32 s26, s26, 8192
    s_cmp_lt_u32 s89, 64
    s_cbranch_scc1 L_ldA_5
    s_waitcnt vmcnt(16)
    s_barrier
    s_waitcnt vmcnt(8)
    s_barrier
    s_waitcnt vmcnt(0)
    s_barrier
    s_endpgm
L_helper:
    s_cmp_eq_u32 s36, 3
    s_cselect_b32 s26, 4, s35
    s_cselect_b32 s27, s35, s36
    s_lshl_b32 s26, s26, 8
    s_lshl_b32 s27, s27, 4
    s_add_u32 s27, s27, s34
    s_lshl_b32 s27, s27, 2
    s_add_u32 s40, s26, s27
    s_add_u32 s40, s40, 0
    s_lshl_b32 s26, s84, 3
    s_add_u32 s26, s26, s86
    s_lshl_b32 s26, s26, 6
    s_lshl_b32 s27, s85, 2
    s_add_u32 s41, s26, s27
    s_add_u32 s41, s41, 4096
    s_mov_b32 s26, 27262976
    s_waitcnt lgkmcnt(0)
    s_add_u32 s8, s4, s26
    s_addc_u32 s9, s5, 0
    s_and_b32 s9, s9, 0xffff
    s_mov_b32 s10, 8192
    s_mov_b32 s11, 0x20000
    s_mov_b32 s12, s82
    s_and_b32 s13, s83, 0xffff
    s_mov_b32 s14, 256
    s_mov_b32 s15, 0x20000
    v_mov_b32 v5, 0
    v_mov_b32 v6, 0
    v_lshlrev_b32 v7, 2, v2
    s_mov_b64 exec, 1
    buffer_store_dword v5, v6, s[8:11], s40 offen sc1
    s_add_u32 s26, s40, 2048
    buffer_store_dword v5, v6, s[8:11], s26 offen sc1
    buffer_store_dword v5, v6, s[8:11], s41 offen sc1
    s_add_u32 s26, s41, 1024
    buffer_store_dword v5, v6, s[8:11], s26 offen sc1
    v_mov_b32 v5, 1
    s_mov_b64 exec, -1
    s_waitcnt vmcnt(0)
    s_mov_b64 exec, 1
    buffer_atomic_add v5, v6, s[12:15], 0 offen sc1
    s_mov_b64 exec, -1
    v_mov_b32 v11, 0x100
    s_lshr_b32 s26, s85, 3
    s_lshl_b32 s26, s26, 1
    s_lshr_b32 s27, s85, 1
    s_and_b32 s27, s27, 1
    s_or_b32 s26, s26, s27
    s_cmp_eq_u32 s84, 0
    s_cselect_b32 s26, 4, s26
    s_cselect_b32 s45, -1, 0xffff
    s_mov_b32 s44, -1
    s_lshl_b32 s42, s26, 8
    s_add_u32 s42, s42, 0
    s_lshl_b32 s26, s84, 3
    s_lshr_b32 s27, s87, 1
    s_add_u32 s26, s26, s27
    s_lshl_b32 s43, s26, 6
    s_add_u32 s43, s43, 4096
    s_mov_b32 s46, 0xffff
    s_mov_b32 s47, 0
    s_barrier
    s_barrier
    s_barrier
    s_barrier
    s_barrier
    s_barrier
    s_barrier
    s_barrier
    s_barrier
    s_barrier
    s_barrier
    s_barrier
    s_barrier
    s_barrier
    s_barrier
    s_barrier
    s_barrier
    s_barrier
    s_barrier
    s_add_u32 s26, s40, 0
    s_mov_b64 exec, 1
    buffer_store_dword v5, v6, s[8:11], s26 offen sc1
    s_mov_b64 exec, -1
    s_barrier
    s_barrier
    s_barrier
    s_barrier
    s_barrier
    s_barrier
    s_barrier
    s_barrier
    s_barrier
    buffer_load_dword v10, v6, s[12:15], 0 offen sc1
    s_barrier
    s_mov_b32 s30, 40000
L_cnt:
    s_waitcnt vmcnt(0)
    v_cmp_eq_u32 vcc, v11, v10
    s_nop 1
    s_cmp_eq_u64 vcc, exec
    s_cbranch_scc1 L_cnt_done
    s_sleep 2
    buffer_load_dword v10, v6, s[12:15], 0 offen sc1
    s_sub_u32 s30, s30, 1
    s_cmp_lg_u32 s30, 0
    s_cbranch_scc1 L_cnt
L_cnt_done:
    buffer_load_dword v4, v7, s[8:11], s42 offen sc1
    s_barrier
    s_waitcnt vmcnt(0)
    v_cmp_ne_u32 vcc, 0, v4
    s_nop 1
    s_and_b64 vcc, vcc, s[44:45]
    s_cmp_eq_u64 vcc, s[44:45]
    s_cbranch_scc1 L_poll0_done
    s_mov_b32 s30, 10000
    buffer_load_dword v12, v7, s[8:11], s42 offen sc1
    s_sleep 2
    buffer_load_dword v13, v7, s[8:11], s42 offen sc1
    s_sleep 2
    buffer_load_dword v14, v7, s[8:11], s42 offen sc1
    s_sleep 2
    buffer_load_dword v15, v7, s[8:11], s42 offen sc1
L_poll0:
    s_waitcnt vmcnt(3)
    v_cmp_ne_u32 vcc, 0, v12
    s_nop 1
    s_and_b64 vcc, vcc, s[44:45]
    s_cmp_eq_u64 vcc, s[44:45]
    s_cbranch_scc1 L_poll0_done
    buffer_load_dword v12, v7, s[8:11], s42 offen sc1
    s_waitcnt vmcnt(3)
    v_cmp_ne_u32 vcc, 0, v13
    s_nop 1
    s_and_b64 vcc, vcc, s[44:45]
    s_cmp_eq_u64 vcc, s[44:45]
    s_cbranch_scc1 L_poll0_done
    buffer_load_dword v13, v7, s[8:11], s42 offen sc1
    s_waitcnt vmcnt(3)
    v_cmp_ne_u32 vcc, 0, v14
    s_nop 1
    s_and_b64 vcc, vcc, s[44:45]
    s_cmp_eq_u64 vcc, s[44:45]
    s_cbranch_scc1 L_poll0_done
    buffer_load_dword v14, v7, s[8:11], s42 offen sc1
    s_waitcnt vmcnt(3)
    v_cmp_ne_u32 vcc, 0, v15
    s_nop 1
    s_and_b64 vcc, vcc, s[44:45]
    s_cmp_eq_u64 vcc, s[44:45]
    s_cbranch_scc1 L_poll0_done
    buffer_load_dword v15, v7, s[8:11], s42 offen sc1
    s_sub_u32 s30, s30, 1
    s_cmp_lg_u32 s30, 0
    s_cbranch_scc1 L_poll0
L_poll0_done:
    s_barrier
    s_barrier
    s_barrier
    s_barrier
    s_add_u32 s26, s40, 2048
    s_mov_b64 exec, 1
    buffer_store_dword v5, v6, s[8:11], s26 offen sc1
    s_mov_b64 exec, -1
    s_barrier
    s_barrier
    s_barrier
    s_cmp_eq_u32 s84, 0
    s_cselect_b32 s26, 0, 512
    s_xor_b32 s42, s42, s26
    s_add_u32 s42, s42, 2048
    buffer_load_dword v4, v7, s[8:11], s42 offen sc1
    s_barrier
    s_waitcnt vmcnt(0)
    v_cmp_ne_u32 vcc, 0, v4
    s_nop 1
    s_and_b64 vcc, vcc, s[44:45]
    s_cmp_eq_u64 vcc, s[44:45]
    s_cbranch_scc1 L_poll1_done
    s_mov_b32 s30, 10000
    buffer_load_dword v12, v7, s[8:11], s42 offen sc1
    s_sleep 2
    buffer_load_dword v13, v7, s[8:11], s42 offen sc1
    s_sleep 2
    buffer_load_dword v14, v7, s[8:11], s42 offen sc1
    s_sleep 2
    buffer_load_dword v15, v7, s[8:11], s42 offen sc1
L_poll1:
    s_waitcnt vmcnt(3)
    v_cmp_ne_u32 vcc, 0, v12
    s_nop 1
    s_and_b64 vcc, vcc, s[44:45]
    s_cmp_eq_u64 vcc, s[44:45]
    s_cbranch_scc1 L_poll1_done
    buffer_load_dword v12, v7, s[8:11], s42 offen sc1
    s_waitcnt vmcnt(3)
    v_cmp_ne_u32 vcc, 0, v13
    s_nop 1
    s_and_b64 vcc, vcc, s[44:45]
    s_cmp_eq_u64 vcc, s[44:45]
    s_cbranch_scc1 L_poll1_done
    buffer_load_dword v13, v7, s[8:11], s42 offen sc1
    s_waitcnt vmcnt(3)
    v_cmp_ne_u32 vcc, 0, v14
    s_nop 1
    s_and_b64 vcc, vcc, s[44:45]
    s_cmp_eq_u64 vcc, s[44:45]
    s_cbranch_scc1 L_poll1_done
    buffer_load_dword v14, v7, s[8:11], s42 offen sc1
    s_waitcnt vmcnt(3)
    v_cmp_ne_u32 vcc, 0, v15
    s_nop 1
    s_and_b64 vcc, vcc, s[44:45]
    s_cmp_eq_u64 vcc, s[44:45]
    s_cbranch_scc1 L_poll1_done
    buffer_load_dword v15, v7, s[8:11], s42 offen sc1
    s_sub_u32 s30, s30, 1
    s_cmp_lg_u32 s30, 0
    s_cbranch_scc1 L_poll1
L_poll1_done:
    s_barrier
    s_cmp_eq_u32 s84, 0
    s_cselect_b32 s27, s72, s78
    s_cselect_b32 s28, s73, s79
    s_mov_b32 s16, s27
    s_and_b32 s17, s28, 0xffff
    s_mov_b32 s18, 2097152
    s_mov_b32 s19, 0x20000
    s_lshl_b32 s27, s32, 16
    v_lshlrev_b32 v8, 7, v2
    buffer_load_dword v9, v8, s[16:19], s27 offen
    s_add_u32 s27, s27, 8192
    buffer_load_dword v9, v8, s[16:19], s27 offen
    s_add_u32 s27, s27, 8192
    buffer_load_dword v9, v8, s[16:19], s27 offen
    s_add_u32 s27, s27, 8192
    buffer_load_dword v9, v8, s[16:19], s27 offen
    s_add_u32 s27, s27, 8192
    buffer_load_dword v9, v8, s[16:19], s27 offen
    s_add_u32 s27, s27, 8192
    buffer_load_dword v9, v8, s[16:19], s27 offen
    s_add_u32 s27, s27, 8192
    buffer_load_dword v9, v8, s[16:19], s27 offen
    s_add_u32 s27, s27, 8192
    buffer_load_dword v9, v8, s[16:19], s27 offen
    s_barrier
    s_barrier
    s_barrier
    s_add_u32 s26, s41, 0
    s_mov_b64 exec, 1
    buffer_store_dword v5, v6, s[8:11], s26 offen sc1
    s_mov_b64 exec, -1
    s_barrier
    s_barrier
    s_barrier
    buffer_load_dword v4, v7, s[8:11], s43 offen sc1
    s_barrier
    s_waitcnt vmcnt(0)
    v_cmp_ne_u32 vcc, 0, v4
    s_nop 1
    s_and_b64 vcc, vcc, s[46:47]
    s_cmp_eq_u64 vcc, s[46:47]
    s_cbranch_scc1 L_poll2_done
    s_mov_b32 s30, 10000
    buffer_load_dword v12, v7, s[8:11], s43 offen sc1
    s_sleep 2
    buffer_load_dword v13, v7, s[8:11], s43 offen sc1
    s_sleep 2
    buffer_load_dword v14, v7, s[8:11], s43 offen sc1
    s_sleep 2
    buffer_load_dword v15, v7, s[8:11], s43 offen sc1
L_poll2:
    s_waitcnt vmcnt(3)
    v_cmp_ne_u32 vcc, 0, v12
    s_nop 1
    s_and_b64 vcc, vcc, s[46:47]
    s_cmp_eq_u64 vcc, s[46:47]
    s_cbranch_scc1 L_poll2_done
    buffer_load_dword v12, v7, s[8:11], s43 offen sc1
    s_waitcnt vmcnt(3)
    v_cmp_ne_u32 vcc, 0, v13
    s_nop 1
    s_and_b64 vcc, vcc, s[46:47]
    s_cmp_eq_u64 vcc, s[46:47]
    s_cbranch_scc1 L_poll2_done
    buffer_load_dword v13, v7, s[8:11], s43 offen sc1
    s_waitcnt vmcnt(3)
    v_cmp_ne_u32 vcc, 0, v14
    s_nop 1
    s_and_b64 vcc, vcc, s[46:47]
    s_cmp_eq_u64 vcc, s[46:47]
    s_cbranch_scc1 L_poll2_done
    buffer_load_dword v14, v7, s[8:11], s43 offen sc1
    s_waitcnt vmcnt(3)
    v_cmp_ne_u32 vcc, 0, v15
    s_nop 1
    s_and_b64 vcc, vcc, s[46:47]
    s_cmp_eq_u64 vcc, s[46:47]
    s_cbranch_scc1 L_poll2_done
    buffer_load_dword v15, v7, s[8:11], s43 offen sc1
    s_sub_u32 s30, s30, 1
    s_cmp_lg_u32 s30, 0
    s_cbranch_scc1 L_poll2
L_poll2_done:
    s_barrier
    s_barrier
    s_barrier
    s_barrier
    s_add_u32 s26, s41, 1024
    s_mov_b64 exec, 1
    buffer_store_dword v5, v6, s[8:11], s26 offen sc1
    s_mov_b64 exec, -1
    s_barrier
    s_barrier
    s_add_u32 s43, s43, 1024
    s_mov_b32 s46, 0x0f0f
    buffer_load_dword v4, v7, s[8:11], s43 offen sc1
    s_barrier
    s_waitcnt vmcnt(0)
    v_cmp_ne_u32 vcc, 0, v4
    s_nop 1
    s_and_b64 vcc, vcc, s[46:47]
    s_cmp_eq_u64 vcc, s[46:47]
    s_cbranch_scc1 L_poll3_done
    s_mov_b32 s30, 10000
    buffer_load_dword v12, v7, s[8:11], s43 offen sc1
    s_sleep 2
    buffer_load_dword v13, v7, s[8:11], s43 offen sc1
    s_sleep 2
    buffer_load_dword v14, v7, s[8:11], s43 offen sc1
    s_sleep 2
    buffer_load_dword v15, v7, s[8:11], s43 offen sc1
L_poll3:
    s_waitcnt vmcnt(3)
    v_cmp_ne_u32 vcc, 0, v12
    s_nop 1
    s_and_b64 vcc, vcc, s[46:47]
    s_cmp_eq_u64 vcc, s[46:47]
    s_cbranch_scc1 L_poll3_done
    buffer_load_dword v12, v7, s[8:11], s43 offen sc1
    s_waitcnt vmcnt(3)
    v_cmp_ne_u32 vcc, 0, v13
    s_nop 1
    s_and_b64 vcc, vcc, s[46:47]
    s_cmp_eq_u64 vcc, s[46:47]
    s_cbranch_scc1 L_poll3_done
    buffer_load_dword v13, v7, s[8:11], s43 offen sc1
    s_waitcnt vmcnt(3)
    v_cmp_ne_u32 vcc, 0, v14
    s_nop 1
    s_and_b64 vcc, vcc, s[46:47]
    s_cmp_eq_u64 vcc, s[46:47]
    s_cbranch_scc1 L_poll3_done
    buffer_load_dword v14, v7, s[8:11], s43 offen sc1
    s_waitcnt vmcnt(3)
    v_cmp_ne_u32 vcc, 0, v15
    s_nop 1
    s_and_b64 vcc, vcc, s[46:47]
    s_cmp_eq_u64 vcc, s[46:47]
    s_cbranch_scc1 L_poll3_done
    buffer_load_dword v15, v7, s[8:11], s43 offen sc1
    s_sub_u32 s30, s30, 1
    s_cmp_lg_u32 s30, 0
    s_cbranch_scc1 L_poll3
L_poll3_done:
    s_barrier
    s_barrier
    s_barrier
    s_waitcnt vmcnt(0)
    s_xor_b32 s46, s46, 0xffff
    buffer_load_dword v4, v7, s[8:11], s43 offen sc1
    s_barrier
    s_waitcnt vmcnt(0)
    v_cmp_ne_u32 vcc, 0, v4
    s_nop 1
    s_and_b64 vcc, vcc, s[46:47]
    s_cmp_eq_u64 vcc, s[46:47]
    s_cbranch_scc1 L_poll4_done
    s_mov_b32 s30, 10000
    buffer_load_dword v12, v7, s[8:11], s43 offen sc1
    s_sleep 2
    buffer_load_dword v13, v7, s[8:11], s43 offen sc1
    s_sleep 2
    buffer_load_dword v14, v7, s[8:11], s43 offen sc1
    s_sleep 2
    buffer_load_dword v15, v7, s[8:11], s43 offen sc1
L_poll4:
    s_waitcnt vmcnt(3)
    v_cmp_ne_u32 vcc, 0, v12
    s_nop 1
    s_and_b64 vcc, vcc, s[46:47]
    s_cmp_eq_u64 vcc, s[46:47]
    s_cbranch_scc1 L_poll4_done
    buffer_load_dword v12, v7, s[8:11], s43 offen sc1
    s_waitcnt vmcnt(3)
    v_cmp_ne_u32 vcc, 0, v13
    s_nop 1
    s_and_b64 vcc, vcc, s[46:47]
    s_cmp_eq_u64 vcc, s[46:47]
    s_cbranch_scc1 L_poll4_done
    buffer_load_dword v13, v7, s[8:11], s43 offen sc1
    s_waitcnt vmcnt(3)
    v_cmp_ne_u32 vcc, 0, v14
    s_nop 1
    s_and_b64 vcc, vcc, s[46:47]
    s_cmp_eq_u64 vcc, s[46:47]
    s_cbranch_scc1 L_poll4_done
    buffer_load_dword v14, v7, s[8:11], s43 offen sc1
    s_waitcnt vmcnt(3)
    v_cmp_ne_u32 vcc, 0, v15
    s_nop 1
    s_and_b64 vcc, vcc, s[46:47]
    s_cmp_eq_u64 vcc, s[46:47]
    s_cbranch_scc1 L_poll4_done
    buffer_load_dword v15, v7, s[8:11], s43 offen sc1
    s_sub_u32 s30, s30, 1
    s_cmp_lg_u32 s30, 0
    s_cbranch_scc1 L_poll4
L_poll4_done:
    s_barrier
    s_barrier
    s_barrier
    s_barrier
    s_barrier
    s_waitcnt vmcnt(0)
    s_barrier
    s_barrier
    s_endpgm
L_compute:
    s_setprio 2
    s_sub_u32 s24, s24, 4
    s_and_b32 s56, s24, 1
    s_lshr_b32 s57, s24, 1
    v_lshlrev_b32 v167, 4, v2
    v_and_b32 v68, 15, v2
    v_lshrrev_b32 v69, 4, v2
    v_lshrrev_b32 v70, 1, v68
    v_xor_b32 v70, v70, v69
    v_lshlrev_b32 v70, 4, v70
    v_lshlrev_b32 v71, 7, v68
    v_add_u32 v70, v70, v71
    s_lshl_b32 s26, s56, 13
    v_add_u32 v156, s26, v70
    v_xor_b32 v157, 64, v156
    v_lshrrev_b32 v70, 2, v68
    v_and_b32 v71, 1, v69
    v_lshlrev_b32 v71, 2, v71
    v_or_b32 v71, v71, v70
    s_lshl_b32 s26, s57, 2
    v_xor_b32 v71, s26, v71
    v_lshlrev_b32 v71, 5, v71
    v_lshlrev_b32 v72, 3, v69
    v_add_u32 v72, v72, v70
    v_lshlrev_b32 v73, 8, v72
    v_add_u32 v71, v71, v73
    v_and_b32 v73, 3, v68
    v_lshlrev_b32 v73, 3, v73
    v_add_u32 v71, v71, v73
    v_add_u32 v158, 65536, v71
    v_xor_b32 v159, 32, v158
    v_xor_b32 v160, 64, v158
    v_xor_b32 v161, 96, v158
    v_lshlrev_b32 v72, 6, v72
    v_and_b32 v71, 1, v69
    v_xor_b32 v71, s57, v71
    v_lshlrev_b32 v71, 5, v71
    v_add_u32 v72, v72, v71
    v_add_u32 v72, v72, v73
    v_add_u32 v162, 131072, v72
    s_mov_b32 s92, 0x3e8293ee
    s_mov_b32 s93, 0x3e8293ee
    s_mov_b32 s33, 0
    s_waitcnt lgkmcnt(0)
    s_cmp_eq_u32 s36, 3
    s_cbranch_scc1 L_g1_A
    s_cmp_eq_u32 s36, 2
    s_cbranch_scc1 L_g1_V
    s_cmp_eq_u32 s36, 1
    s_cbranch_scc1 L_g1_K
L_g1_Q:
    s_lshr_b32 s29, s35, 1
    s_lshl_b32 s29, s29, 3
    s_and_b32 s27, s35, 1
    s_lshl_b32 s27, s27, 1
    s_add_u32 s29, s29, s27
    s_lshl_b32 s27, s57, 2
    s_add_u32 s27, s27, s29
    s_mul_i32 s26, s27, 131072
    s_lshl_b32 s27, s34, 2
    s_lshl_b32 s28, s56, 1
    s_add_u32 s27, s27, s28
    s_mul_i32 s27, s27, 2048
    s_add_u32 s26, s26, s27
    s_add_u32 s26, s26, 4194304
    s_add_u32 s20, s4, s26
    s_addc_u32 s21, s5, 0
    s_and_b32 s21, s21, 0xffff
    s_mov_b32 s22, 1048576
    s_mov_b32 s23, 0x20000
    s_mov_b32 s40, 0
    s_mov_b32 s41, 2048
    v_and_b32 v68, 15, v2
    v_lshrrev_b32 v69, 4, v2
    v_and_b32 v71, 1, v69
    v_lshlrev_b32 v71, 9, v71
    v_lshlrev_b32 v72, 4, v68
    v_add_u32 v71, v71, v72
    v_lshrrev_b32 v70, 1, v69
    v_lshlrev_b32 v70, 10, v70
    v_add_u32 v74, v70, v71
    v_add_u32 v163, 0, v74
    v_add_u32 v164, 256, v74
    v_add_u32 v165, 131072, v74
    v_add_u32 v166, 131328, v74
    s_barrier
    ds_read_b64_tr_b16 v[100:101], v158 offset:0
    ds_read_b64_tr_b16 v[102:103], v158 offset:1024
    ds_read_b128 v[68:71], v156 offset:0
    ds_read_b64_tr_b16 v[104:105], v159 offset:0
    ds_read_b64_tr_b16 v[106:107], v159 offset:1024
    ds_read_b64_tr_b16 v[108:109], v160 offset:0
    ds_read_b64_tr_b16 v[110:111], v160 offset:1024
    ds_read_b64_tr_b16 v[112:113], v161 offset:0
    ds_read_b64_tr_b16 v[114:115], v161 offset:1024
    ds_read_b128 v[72:75], v156 offset:2048
    ds_read_b128 v[76:79], v156 offset:4096
    ds_read_b128 v[80:83], v156 offset:6144
L_g1_Q_go:
    s_waitcnt lgkmcnt(9)
    v_mfma_f32_16x16x32_bf16 v[4:7], v[100:103], v[68:71], 0
    ds_read_b64_tr_b16 v[116:117], v158 offset:8192
    s_waitcnt lgkmcnt(8)
    v_mfma_f32_16x16x32_bf16 v[8:11], v[104:107], v[68:71], 0
    ds_read_b64_tr_b16 v[118:119], v158 offset:9216
    s_waitcnt lgkmcnt(7)
    v_mfma_f32_16x16x32_bf16 v[12:15], v[108:111], v[68:71], 0
    ds_read_b128 v[84:87], v157 offset:0
    s_waitcnt lgkmcnt(6)
    v_mfma_f32_16x16x32_bf16 v[16:19], v[112:115], v[68:71], 0
    ds_read_b64_tr_b16 v[120:121], v159 offset:8192
    s_waitcnt lgkmcnt(6)
    v_mfma_f32_16x16x32_bf16 v[20:23], v[100:103], v[72:75], 0
    ds_read_b64_tr_b16 v[122:123], v159 offset:9216
    v_mfma_f32_16x16x32_bf16 v[24:27], v[104:107], v[72:75], 0
    ds_read_b64_tr_b16 v[124:125], v160 offset:8192
    v_mfma_f32_16x16x32_bf16 v[28:31], v[108:111], v[72:75], 0
    ds_read_b64_tr_b16 v[126:127], v160 offset:9216
    v_mfma_f32_16x16x32_bf16 v[32:35], v[112:115], v[72:75], 0
    ds_read_b64_tr_b16 v[128:129], v161 offset:8192
    s_waitcnt lgkmcnt(9)
    v_mfma_f32_16x16x32_bf16 v[36:39], v[100:103], v[76:79], 0
    ds_read_b64_tr_b16 v[130:131], v161 offset:9216
    v_mfma_f32_16x16x32_bf16 v[40:43], v[104:107], v[76:79], 0
    ds_read_b128 v[88:91], v157 offset:2048
    v_mfma_f32_16x16x32_bf16 v[44:47], v[108:111], v[76:79], 0
    ds_read_b128 v[92:95], v157 offset:4096
    v_mfma_f32_16x16x32_bf16 v[48:51], v[112:115], v[76:79], 0
    ds_read_b128 v[96:99], v157 offset:6144
    s_waitcnt lgkmcnt(12)
    v_mfma_f32_16x16x32_bf16 v[52:55], v[100:103], v[80:83], 0
    v_mfma_f32_16x16x32_bf16 v[56:59], v[104:107], v[80:83], 0
    v_mfma_f32_16x16x32_bf16 v[60:63], v[108:111], v[80:83], 0
    v_mfma_f32_16x16x32_bf16 v[64:67], v[112:115], v[80:83], 0
    s_mov_b32 s58, 0
.p2align 6
L_loop_Q:
    s_waitcnt lgkmcnt(9)
    v_mfma_f32_16x16x32_bf16 v[4:7], v[116:119], v[84:87], v[4:7]
    s_waitcnt lgkmcnt(7)
    v_mfma_f32_16x16x32_bf16 v[8:11], v[120:123], v[84:87], v[8:11]
    s_waitcnt lgkmcnt(5)
    v_mfma_f32_16x16x32_bf16 v[12:15], v[124:127], v[84:87], v[12:15]
    s_waitcnt lgkmcnt(3)
    v_mfma_f32_16x16x32_bf16 v[16:19], v[128:131], v[84:87], v[16:19]
    s_waitcnt lgkmcnt(0)
    s_barrier
    ds_read_b64_tr_b16 v[100:101], v158 offset:16384
    v_mfma_f32_16x16x32_bf16 v[20:23], v[116:119], v[88:91], v[20:23]
    ds_read_b64_tr_b16 v[102:103], v158 offset:17408
    v_mfma_f32_16x16x32_bf16 v[24:27], v[120:123], v[88:91], v[24:27]
    ds_read_b128 v[68:71], v156 offset:16384
    v_mfma_f32_16x16x32_bf16 v[28:31], v[124:127], v[88:91], v[28:31]
    ds_read_b64_tr_b16 v[104:105], v159 offset:16384
    v_mfma_f32_16x16x32_bf16 v[32:35], v[128:131], v[88:91], v[32:35]
    ds_read_b64_tr_b16 v[106:107], v159 offset:17408
    v_mfma_f32_16x16x32_bf16 v[36:39], v[116:119], v[92:95], v[36:39]
    ds_read_b64_tr_b16 v[108:109], v160 offset:16384
    v_mfma_f32_16x16x32_bf16 v[40:43], v[120:123], v[92:95], v[40:43]
    ds_read_b64_tr_b16 v[110:111], v160 offset:17408
    v_mfma_f32_16x16x32_bf16 v[44:47], v[124:127], v[92:95], v[44:47]
    ds_read_b64_tr_b16 v[112:113], v161 offset:16384
    v_mfma_f32_16x16x32_bf16 v[48:51], v[128:131], v[92:95], v[48:51]
    ds_read_b64_tr_b16 v[114:115], v161 offset:17408
    v_mfma_f32_16x16x32_bf16 v[52:55], v[116:119], v[96:99], v[52:55]
    ds_read_b128 v[72:75], v156 offset:18432
    v_mfma_f32_16x16x32_bf16 v[56:59], v[120:123], v[96:99], v[56:59]
    ds_read_b128 v[76:79], v156 offset:20480
    v_mfma_f32_16x16x32_bf16 v[60:63], v[124:127], v[96:99], v[60:63]
    ds_read_b128 v[80:83], v156 offset:22528
    v_mfma_f32_16x16x32_bf16 v[64:67], v[128:131], v[96:99], v[64:67]
    s_waitcnt lgkmcnt(9)
    v_mfma_f32_16x16x32_bf16 v[4:7], v[100:103], v[68:71], v[4:7]
    ds_read_b64_tr_b16 v[116:117], v158 offset:24576
    s_waitcnt lgkmcnt(8)
    v_mfma_f32_16x16x32_bf16 v[8:11], v[104:107], v[68:71], v[8:11]
    ds_read_b64_tr_b16 v[118:119], v158 offset:25600
    s_waitcnt lgkmcnt(7)
    v_mfma_f32_16x16x32_bf16 v[12:15], v[108:111], v[68:71], v[12:15]
    ds_read_b128 v[84:87], v157 offset:16384
    s_waitcnt lgkmcnt(6)
    v_mfma_f32_16x16x32_bf16 v[16:19], v[112:115], v[68:71], v[16:19]
    ds_read_b64_tr_b16 v[120:121], v159 offset:24576
    s_waitcnt lgkmcnt(6)
    v_mfma_f32_16x16x32_bf16 v[20:23], v[100:103], v[72:75], v[20:23]
    ds_read_b64_tr_b16 v[122:123], v159 offset:25600
    v_mfma_f32_16x16x32_bf16 v[24:27], v[104:107], v[72:75], v[24:27]
    ds_read_b64_tr_b16 v[124:125], v160 offset:24576
    v_mfma_f32_16x16x32_bf16 v[28:31], v[108:111], v[72:75], v[28:31]
    ds_read_b64_tr_b16 v[126:127], v160 offset:25600
    v_mfma_f32_16x16x32_bf16 v[32:35], v[112:115], v[72:75], v[32:35]
    ds_read_b64_tr_b16 v[128:129], v161 offset:24576
    s_waitcnt lgkmcnt(9)
    v_mfma_f32_16x16x32_bf16 v[36:39], v[100:103], v[76:79], v[36:39]
    ds_read_b64_tr_b16 v[130:131], v161 offset:25600
    v_mfma_f32_16x16x32_bf16 v[40:43], v[104:107], v[76:79], v[40:43]
    ds_read_b128 v[88:91], v157 offset:18432
    v_mfma_f32_16x16x32_bf16 v[44:47], v[108:111], v[76:79], v[44:47]
    ds_read_b128 v[92:95], v157 offset:20480
    v_mfma_f32_16x16x32_bf16 v[48:51], v[112:115], v[76:79], v[48:51]
    ds_read_b128 v[96:99], v157 offset:22528
    s_waitcnt lgkmcnt(12)
    v_mfma_f32_16x16x32_bf16 v[52:55], v[100:103], v[80:83], v[52:55]
    v_mfma_f32_16x16x32_bf16 v[56:59], v[104:107], v[80:83], v[56:59]
    v_mfma_f32_16x16x32_bf16 v[60:63], v[108:111], v[80:83], v[60:63]
    v_mfma_f32_16x16x32_bf16 v[64:67], v[112:115], v[80:83], v[64:67]
    s_waitcnt lgkmcnt(9)
    v_mfma_f32_16x16x32_bf16 v[4:7], v[116:119], v[84:87], v[4:7]
    s_waitcnt lgkmcnt(7)
    v_mfma_f32_16x16x32_bf16 v[8:11], v[120:123], v[84:87], v[8:11]
    s_waitcnt lgkmcnt(5)
    v_mfma_f32_16x16x32_bf16 v[12:15], v[124:127], v[84:87], v[12:15]
    s_waitcnt lgkmcnt(3)
    v_mfma_f32_16x16x32_bf16 v[16:19], v[128:131], v[84:87], v[16:19]
    s_waitcnt lgkmcnt(0)
    s_waitcnt vmcnt(0)
    s_barrier
    ds_read_b64_tr_b16 v[100:101], v158 offset:32768
    v_mfma_f32_16x16x32_bf16 v[20:23], v[116:119], v[88:91], v[20:23]
    ds_read_b64_tr_b16 v[102:103], v158 offset:33792
    v_mfma_f32_16x16x32_bf16 v[24:27], v[120:123], v[88:91], v[24:27]
    ds_read_b128 v[68:71], v156 offset:32768
    v_mfma_f32_16x16x32_bf16 v[28:31], v[124:127], v[88:91], v[28:31]
    ds_read_b64_tr_b16 v[104:105], v159 offset:32768
    v_mfma_f32_16x16x32_bf16 v[32:35], v[128:131], v[88:91], v[32:35]
    ds_read_b64_tr_b16 v[106:107], v159 offset:33792
    v_mfma_f32_16x16x32_bf16 v[36:39], v[116:119], v[92:95], v[36:39]
    ds_read_b64_tr_b16 v[108:109], v160 offset:32768
    v_mfma_f32_16x16x32_bf16 v[40:43], v[120:123], v[92:95], v[40:43]
    ds_read_b64_tr_b16 v[110:111], v160 offset:33792
    v_mfma_f32_16x16x32_bf16 v[44:47], v[124:127], v[92:95], v[44:47]
    ds_read_b64_tr_b16 v[112:113], v161 offset:32768
    v_mfma_f32_16x16x32_bf16 v[48:51], v[128:131], v[92:95], v[48:51]
    ds_read_b64_tr_b16 v[114:115], v161 offset:33792
    v_mfma_f32_16x16x32_bf16 v[52:55], v[116:119], v[96:99], v[52:55]
    ds_read_b128 v[72:75], v156 offset:34816
    v_mfma_f32_16x16x32_bf16 v[56:59], v[120:123], v[96:99], v[56:59]
    ds_read_b128 v[76:79], v156 offset:36864
    v_mfma_f32_16x16x32_bf16 v[60:63], v[124:127], v[96:99], v[60:63]
    ds_read_b128 v[80:83], v156 offset:38912
    v_mfma_f32_16x16x32_bf16 v[64:67], v[128:131], v[96:99], v[64:67]
    s_waitcnt lgkmcnt(9)
    v_mfma_f32_16x16x32_bf16 v[4:7], v[100:103], v[68:71], v[4:7]
    ds_read_b64_tr_b16 v[116:117], v158 offset:40960
    s_waitcnt lgkmcnt(8)
    v_mfma_f32_16x16x32_bf16 v[8:11], v[104:107], v[68:71], v[8:11]
    ds_read_b64_tr_b16 v[118:119], v158 offset:41984
    s_waitcnt lgkmcnt(7)
    v_mfma_f32_16x16x32_bf16 v[12:15], v[108:111], v[68:71], v[12:15]
    ds_read_b128 v[84:87], v157 offset:32768
    s_waitcnt lgkmcnt(6)
    v_mfma_f32_16x16x32_bf16 v[16:19], v[112:115], v[68:71], v[16:19]
    ds_read_b64_tr_b16 v[120:121], v159 offset:40960
    s_waitcnt lgkmcnt(6)
    v_mfma_f32_16x16x32_bf16 v[20:23], v[100:103], v[72:75], v[20:23]
    ds_read_b64_tr_b16 v[122:123], v159 offset:41984
    v_mfma_f32_16x16x32_bf16 v[24:27], v[104:107], v[72:75], v[24:27]
    ds_read_b64_tr_b16 v[124:125], v160 offset:40960
    v_mfma_f32_16x16x32_bf16 v[28:31], v[108:111], v[72:75], v[28:31]
    ds_read_b64_tr_b16 v[126:127], v160 offset:41984
    v_mfma_f32_16x16x32_bf16 v[32:35], v[112:115], v[72:75], v[32:35]
    ds_read_b64_tr_b16 v[128:129], v161 offset:40960
    s_waitcnt lgkmcnt(9)
    v_mfma_f32_16x16x32_bf16 v[36:39], v[100:103], v[76:79], v[36:39]
    ds_read_b64_tr_b16 v[130:131], v161 offset:41984
    v_mfma_f32_16x16x32_bf16 v[40:43], v[104:107], v[76:79], v[40:43]
    ds_read_b128 v[88:91], v157 offset:34816
    v_mfma_f32_16x16x32_bf16 v[44:47], v[108:111], v[76:79], v[44:47]
    ds_read_b128 v[92:95], v157 offset:36864
    v_mfma_f32_16x16x32_bf16 v[48:51], v[112:115], v[76:79], v[48:51]
    ds_read_b128 v[96:99], v157 offset:38912
    s_waitcnt lgkmcnt(12)
    v_mfma_f32_16x16x32_bf16 v[52:55], v[100:103], v[80:83], v[52:55]
    v_mfma_f32_16x16x32_bf16 v[56:59], v[104:107], v[80:83], v[56:59]
    v_mfma_f32_16x16x32_bf16 v[60:63], v[108:111], v[80:83], v[60:63]
    v_mfma_f32_16x16x32_bf16 v[64:67], v[112:115], v[80:83], v[64:67]
    s_waitcnt lgkmcnt(9)
    v_mfma_f32_16x16x32_bf16 v[4:7], v[116:119], v[84:87], v[4:7]
    s_waitcnt lgkmcnt(7)
    v_mfma_f32_16x16x32_bf16 v[8:11], v[120:123], v[84:87], v[8:11]
    s_waitcnt lgkmcnt(5)
    v_mfma_f32_16x16x32_bf16 v[12:15], v[124:127], v[84:87], v[12:15]
    s_waitcnt lgkmcnt(3)
    v_mfma_f32_16x16x32_bf16 v[16:19], v[128:131], v[84:87], v[16:19]
    s_waitcnt lgkmcnt(0)
    s_barrier
    ds_read_b64_tr_b16 v[100:101], v158 offset:49152
    v_mfma_f32_16x16x32_bf16 v[20:23], v[116:119], v[88:91], v[20:23]
    ds_read_b64_tr_b16 v[102:103], v158 offset:50176
    v_mfma_f32_16x16x32_bf16 v[24:27], v[120:123], v[88:91], v[24:27]
    ds_read_b128 v[68:71], v156 offset:49152
    v_mfma_f32_16x16x32_bf16 v[28:31], v[124:127], v[88:91], v[28:31]
    ds_read_b64_tr_b16 v[104:105], v159 offset:49152
    v_mfma_f32_16x16x32_bf16 v[32:35], v[128:131], v[88:91], v[32:35]
    ds_read_b64_tr_b16 v[106:107], v159 offset:50176
    v_mfma_f32_16x16x32_bf16 v[36:39], v[116:119], v[92:95], v[36:39]
    ds_read_b64_tr_b16 v[108:109], v160 offset:49152
    v_mfma_f32_16x16x32_bf16 v[40:43], v[120:123], v[92:95], v[40:43]
    ds_read_b64_tr_b16 v[110:111], v160 offset:50176
    v_mfma_f32_16x16x32_bf16 v[44:47], v[124:127], v[92:95], v[44:47]
    ds_read_b64_tr_b16 v[112:113], v161 offset:49152
    v_mfma_f32_16x16x32_bf16 v[48:51], v[128:131], v[92:95], v[48:51]
    ds_read_b64_tr_b16 v[114:115], v161 offset:50176
    v_mfma_f32_16x16x32_bf16 v[52:55], v[116:119], v[96:99], v[52:55]
    ds_read_b128 v[72:75], v156 offset:51200
    v_mfma_f32_16x16x32_bf16 v[56:59], v[120:123], v[96:99], v[56:59]
    ds_read_b128 v[76:79], v156 offset:53248
    v_mfma_f32_16x16x32_bf16 v[60:63], v[124:127], v[96:99], v[60:63]
    ds_read_b128 v[80:83], v156 offset:55296
    v_mfma_f32_16x16x32_bf16 v[64:67], v[128:131], v[96:99], v[64:67]
    s_waitcnt lgkmcnt(9)
    v_mfma_f32_16x16x32_bf16 v[4:7], v[100:103], v[68:71], v[4:7]
    ds_read_b64_tr_b16 v[116:117], v158 offset:57344
    s_waitcnt lgkmcnt(8)
    v_mfma_f32_16x16x32_bf16 v[8:11], v[104:107], v[68:71], v[8:11]
    ds_read_b64_tr_b16 v[118:119], v158 offset:58368
    s_waitcnt lgkmcnt(7)
    v_mfma_f32_16x16x32_bf16 v[12:15], v[108:111], v[68:71], v[12:15]
    ds_read_b128 v[84:87], v157 offset:49152
    s_waitcnt lgkmcnt(6)
    v_mfma_f32_16x16x32_bf16 v[16:19], v[112:115], v[68:71], v[16:19]
    ds_read_b64_tr_b16 v[120:121], v159 offset:57344
    s_waitcnt lgkmcnt(6)
    v_mfma_f32_16x16x32_bf16 v[20:23], v[100:103], v[72:75], v[20:23]
    ds_read_b64_tr_b16 v[122:123], v159 offset:58368
    v_mfma_f32_16x16x32_bf16 v[24:27], v[104:107], v[72:75], v[24:27]
    ds_read_b64_tr_b16 v[124:125], v160 offset:57344
    v_mfma_f32_16x16x32_bf16 v[28:31], v[108:111], v[72:75], v[28:31]
    ds_read_b64_tr_b16 v[126:127], v160 offset:58368
    v_mfma_f32_16x16x32_bf16 v[32:35], v[112:115], v[72:75], v[32:35]
    ds_read_b64_tr_b16 v[128:129], v161 offset:57344
    s_waitcnt lgkmcnt(9)
    v_mfma_f32_16x16x32_bf16 v[36:39], v[100:103], v[76:79], v[36:39]
    ds_read_b64_tr_b16 v[130:131], v161 offset:58368
    v_mfma_f32_16x16x32_bf16 v[40:43], v[104:107], v[76:79], v[40:43]
    ds_read_b128 v[88:91], v157 offset:51200
    v_mfma_f32_16x16x32_bf16 v[44:47], v[108:111], v[76:79], v[44:47]
    ds_read_b128 v[92:95], v157 offset:53248
    v_mfma_f32_16x16x32_bf16 v[48:51], v[112:115], v[76:79], v[48:51]
    ds_read_b128 v[96:99], v157 offset:55296
    s_waitcnt lgkmcnt(12)
    v_mfma_f32_16x16x32_bf16 v[52:55], v[100:103], v[80:83], v[52:55]
    v_mfma_f32_16x16x32_bf16 v[56:59], v[104:107], v[80:83], v[56:59]
    v_mfma_f32_16x16x32_bf16 v[60:63], v[108:111], v[80:83], v[60:63]
    v_mfma_f32_16x16x32_bf16 v[64:67], v[112:115], v[80:83], v[64:67]
    s_waitcnt lgkmcnt(9)
    v_mfma_f32_16x16x32_bf16 v[4:7], v[116:119], v[84:87], v[4:7]
    s_waitcnt lgkmcnt(7)
    v_mfma_f32_16x16x32_bf16 v[8:11], v[120:123], v[84:87], v[8:11]
    s_waitcnt lgkmcnt(5)
    v_mfma_f32_16x16x32_bf16 v[12:15], v[124:127], v[84:87], v[12:15]
    s_waitcnt lgkmcnt(3)
    v_mfma_f32_16x16x32_bf16 v[16:19], v[128:131], v[84:87], v[16:19]
    s_waitcnt lgkmcnt(0)
    s_barrier
    ds_read_b64_tr_b16 v[100:101], v158 offset:0
    v_mfma_f32_16x16x32_bf16 v[20:23], v[116:119], v[88:91], v[20:23]
    ds_read_b64_tr_b16 v[102:103], v158 offset:1024
    v_mfma_f32_16x16x32_bf16 v[24:27], v[120:123], v[88:91], v[24:27]
    ds_read_b128 v[68:71], v156 offset:0
    v_mfma_f32_16x16x32_bf16 v[28:31], v[124:127], v[88:91], v[28:31]
    ds_read_b64_tr_b16 v[104:105], v159 offset:0
    v_mfma_f32_16x16x32_bf16 v[32:35], v[128:131], v[88:91], v[32:35]
    ds_read_b64_tr_b16 v[106:107], v159 offset:1024
    v_mfma_f32_16x16x32_bf16 v[36:39], v[116:119], v[92:95], v[36:39]
    ds_read_b64_tr_b16 v[108:109], v160 offset:0
    v_mfma_f32_16x16x32_bf16 v[40:43], v[120:123], v[92:95], v[40:43]
    ds_read_b64_tr_b16 v[110:111], v160 offset:1024
    v_mfma_f32_16x16x32_bf16 v[44:47], v[124:127], v[92:95], v[44:47]
    ds_read_b64_tr_b16 v[112:113], v161 offset:0
    v_mfma_f32_16x16x32_bf16 v[48:51], v[128:131], v[92:95], v[48:51]
    ds_read_b64_tr_b16 v[114:115], v161 offset:1024
    v_mfma_f32_16x16x32_bf16 v[52:55], v[116:119], v[96:99], v[52:55]
    ds_read_b128 v[72:75], v156 offset:2048
    v_mfma_f32_16x16x32_bf16 v[56:59], v[120:123], v[96:99], v[56:59]
    ds_read_b128 v[76:79], v156 offset:4096
    v_mfma_f32_16x16x32_bf16 v[60:63], v[124:127], v[96:99], v[60:63]
    ds_read_b128 v[80:83], v156 offset:6144
    v_mfma_f32_16x16x32_bf16 v[64:67], v[128:131], v[96:99], v[64:67]
    s_waitcnt lgkmcnt(9)
    v_mfma_f32_16x16x32_bf16 v[4:7], v[100:103], v[68:71], v[4:7]
    ds_read_b64_tr_b16 v[116:117], v158 offset:8192
    s_waitcnt lgkmcnt(8)
    v_mfma_f32_16x16x32_bf16 v[8:11], v[104:107], v[68:71], v[8:11]
    ds_read_b64_tr_b16 v[118:119], v158 offset:9216
    s_waitcnt lgkmcnt(7)
    v_mfma_f32_16x16x32_bf16 v[12:15], v[108:111], v[68:71], v[12:15]
    ds_read_b128 v[84:87], v157 offset:0
    s_waitcnt lgkmcnt(6)
    v_mfma_f32_16x16x32_bf16 v[16:19], v[112:115], v[68:71], v[16:19]
    ds_read_b64_tr_b16 v[120:121], v159 offset:8192
    s_waitcnt lgkmcnt(6)
    v_mfma_f32_16x16x32_bf16 v[20:23], v[100:103], v[72:75], v[20:23]
    ds_read_b64_tr_b16 v[122:123], v159 offset:9216
    v_mfma_f32_16x16x32_bf16 v[24:27], v[104:107], v[72:75], v[24:27]
    ds_read_b64_tr_b16 v[124:125], v160 offset:8192
    v_mfma_f32_16x16x32_bf16 v[28:31], v[108:111], v[72:75], v[28:31]
    ds_read_b64_tr_b16 v[126:127], v160 offset:9216
    v_mfma_f32_16x16x32_bf16 v[32:35], v[112:115], v[72:75], v[32:35]
    ds_read_b64_tr_b16 v[128:129], v161 offset:8192
    s_waitcnt lgkmcnt(9)
    v_mfma_f32_16x16x32_bf16 v[36:39], v[100:103], v[76:79], v[36:39]
    ds_read_b64_tr_b16 v[130:131], v161 offset:9216
    v_mfma_f32_16x16x32_bf16 v[40:43], v[104:107], v[76:79], v[40:43]
    ds_read_b128 v[88:91], v157 offset:2048
    v_mfma_f32_16x16x32_bf16 v[44:47], v[108:111], v[76:79], v[44:47]
    ds_read_b128 v[92:95], v157 offset:4096
    v_mfma_f32_16x16x32_bf16 v[48:51], v[112:115], v[76:79], v[48:51]
    ds_read_b128 v[96:99], v157 offset:6144
    s_waitcnt lgkmcnt(12)
    v_mfma_f32_16x16x32_bf16 v[52:55], v[100:103], v[80:83], v[52:55]
    v_mfma_f32_16x16x32_bf16 v[56:59], v[104:107], v[80:83], v[56:59]
    v_mfma_f32_16x16x32_bf16 v[60:63], v[108:111], v[80:83], v[60:63]
    v_mfma_f32_16x16x32_bf16 v[64:67], v[112:115], v[80:83], v[64:67]
    s_add_u32 s58, s58, 1
    s_cmp_lt_u32 s58, 3
    s_cbranch_scc1 L_loop_Q
    s_waitcnt lgkmcnt(9)
    v_mfma_f32_16x16x32_bf16 v[4:7], v[116:119], v[84:87], v[4:7]
    s_waitcnt lgkmcnt(7)
    v_mfma_f32_16x16x32_bf16 v[8:11], v[120:123], v[84:87], v[8:11]
    s_waitcnt lgkmcnt(5)
    v_mfma_f32_16x16x32_bf16 v[12:15], v[124:127], v[84:87], v[12:15]
    s_waitcnt lgkmcnt(3)
    v_mfma_f32_16x16x32_bf16 v[16:19], v[128:131], v[84:87], v[16:19]
    s_waitcnt lgkmcnt(0)
    s_barrier
    ds_read_b64_tr_b16 v[100:101], v158 offset:16384
    v_mfma_f32_16x16x32_bf16 v[20:23], v[116:119], v[88:91], v[20:23]
    ds_read_b64_tr_b16 v[102:103], v158 offset:17408
    v_mfma_f32_16x16x32_bf16 v[24:27], v[120:123], v[88:91], v[24:27]
    ds_read_b128 v[68:71], v156 offset:16384
    v_mfma_f32_16x16x32_bf16 v[28:31], v[124:127], v[88:91], v[28:31]
    ds_read_b64_tr_b16 v[104:105], v159 offset:16384
    v_mfma_f32_16x16x32_bf16 v[32:35], v[128:131], v[88:91], v[32:35]
    ds_read_b64_tr_b16 v[106:107], v159 offset:17408
    v_mfma_f32_16x16x32_bf16 v[36:39], v[116:119], v[92:95], v[36:39]
    ds_read_b64_tr_b16 v[108:109], v160 offset:16384
    v_mfma_f32_16x16x32_bf16 v[40:43], v[120:123], v[92:95], v[40:43]
    ds_read_b64_tr_b16 v[110:111], v160 offset:17408
    v_mfma_f32_16x16x32_bf16 v[44:47], v[124:127], v[92:95], v[44:47]
    ds_read_b64_tr_b16 v[112:113], v161 offset:16384
    v_mfma_f32_16x16x32_bf16 v[48:51], v[128:131], v[92:95], v[48:51]
    ds_read_b64_tr_b16 v[114:115], v161 offset:17408
    v_mfma_f32_16x16x32_bf16 v[52:55], v[116:119], v[96:99], v[52:55]
    ds_read_b128 v[72:75], v156 offset:18432
    v_mfma_f32_16x16x32_bf16 v[56:59], v[120:123], v[96:99], v[56:59]
    ds_read_b128 v[76:79], v156 offset:20480
    v_mfma_f32_16x16x32_bf16 v[60:63], v[124:127], v[96:99], v[60:63]
    ds_read_b128 v[80:83], v156 offset:22528
    v_mfma_f32_16x16x32_bf16 v[64:67], v[128:131], v[96:99], v[64:67]
    s_waitcnt lgkmcnt(9)
    v_mfma_f32_16x16x32_bf16 v[4:7], v[100:103], v[68:71], v[4:7]
    ds_read_b64_tr_b16 v[116:117], v158 offset:24576
    s_waitcnt lgkmcnt(8)
    v_mfma_f32_16x16x32_bf16 v[8:11], v[104:107], v[68:71], v[8:11]
    ds_read_b64_tr_b16 v[118:119], v158 offset:25600
    s_waitcnt lgkmcnt(7)
    v_mfma_f32_16x16x32_bf16 v[12:15], v[108:111], v[68:71], v[12:15]
    ds_read_b128 v[84:87], v157 offset:16384
    s_waitcnt lgkmcnt(6)
    v_mfma_f32_16x16x32_bf16 v[16:19], v[112:115], v[68:71], v[16:19]
    ds_read_b64_tr_b16 v[120:121], v159 offset:24576
    s_waitcnt lgkmcnt(6)
    v_mfma_f32_16x16x32_bf16 v[20:23], v[100:103], v[72:75], v[20:23]
    ds_read_b64_tr_b16 v[122:123], v159 offset:25600
    v_mfma_f32_16x16x32_bf16 v[24:27], v[104:107], v[72:75], v[24:27]
    ds_read_b64_tr_b16 v[124:125], v160 offset:24576
    v_mfma_f32_16x16x32_bf16 v[28:31], v[108:111], v[72:75], v[28:31]
    ds_read_b64_tr_b16 v[126:127], v160 offset:25600
    v_mfma_f32_16x16x32_bf16 v[32:35], v[112:115], v[72:75], v[32:35]
    ds_read_b64_tr_b16 v[128:129], v161 offset:24576
    s_waitcnt lgkmcnt(9)
    v_mfma_f32_16x16x32_bf16 v[36:39], v[100:103], v[76:79], v[36:39]
    ds_read_b64_tr_b16 v[130:131], v161 offset:25600
    v_mfma_f32_16x16x32_bf16 v[40:43], v[104:107], v[76:79], v[40:43]
    ds_read_b128 v[88:91], v157 offset:18432
    v_mfma_f32_16x16x32_bf16 v[44:47], v[108:111], v[76:79], v[44:47]
    ds_read_b128 v[92:95], v157 offset:20480
    v_mfma_f32_16x16x32_bf16 v[48:51], v[112:115], v[76:79], v[48:51]
    ds_read_b128 v[96:99], v157 offset:22528
    s_waitcnt lgkmcnt(12)
    v_mfma_f32_16x16x32_bf16 v[52:55], v[100:103], v[80:83], v[52:55]
    v_mfma_f32_16x16x32_bf16 v[56:59], v[104:107], v[80:83], v[56:59]
    v_mfma_f32_16x16x32_bf16 v[60:63], v[108:111], v[80:83], v[60:63]
    v_mfma_f32_16x16x32_bf16 v[64:67], v[112:115], v[80:83], v[64:67]
    s_waitcnt lgkmcnt(9)
    v_mfma_f32_16x16x32_bf16 v[4:7], v[116:119], v[84:87], v[4:7]
    s_waitcnt lgkmcnt(7)
    v_mfma_f32_16x16x32_bf16 v[8:11], v[120:123], v[84:87], v[8:11]
    s_waitcnt lgkmcnt(5)
    v_mfma_f32_16x16x32_bf16 v[12:15], v[124:127], v[84:87], v[12:15]
    s_waitcnt lgkmcnt(3)
    v_mfma_f32_16x16x32_bf16 v[16:19], v[128:131], v[84:87], v[16:19]
    s_waitcnt lgkmcnt(0)
    s_waitcnt vmcnt(0)
    s_barrier
    ds_read_b64_tr_b16 v[100:101], v158 offset:32768
    v_mfma_f32_16x16x32_bf16 v[20:23], v[116:119], v[88:91], v[20:23]
    ds_read_b64_tr_b16 v[102:103], v158 offset:33792
    v_mfma_f32_16x16x32_bf16 v[24:27], v[120:123], v[88:91], v[24:27]
    ds_read_b128 v[68:71], v156 offset:32768
    v_mfma_f32_16x16x32_bf16 v[28:31], v[124:127], v[88:91], v[28:31]
    ds_read_b64_tr_b16 v[104:105], v159 offset:32768
    v_mfma_f32_16x16x32_bf16 v[32:35], v[128:131], v[88:91], v[32:35]
    ds_read_b64_tr_b16 v[106:107], v159 offset:33792
    v_mfma_f32_16x16x32_bf16 v[36:39], v[116:119], v[92:95], v[36:39]
    ds_read_b64_tr_b16 v[108:109], v160 offset:32768
    v_mfma_f32_16x16x32_bf16 v[40:43], v[120:123], v[92:95], v[40:43]
    ds_read_b64_tr_b16 v[110:111], v160 offset:33792
    v_mfma_f32_16x16x32_bf16 v[44:47], v[124:127], v[92:95], v[44:47]
    ds_read_b64_tr_b16 v[112:113], v161 offset:32768
    v_mfma_f32_16x16x32_bf16 v[48:51], v[128:131], v[92:95], v[48:51]
    ds_read_b64_tr_b16 v[114:115], v161 offset:33792
    v_mfma_f32_16x16x32_bf16 v[52:55], v[116:119], v[96:99], v[52:55]
    ds_read_b128 v[72:75], v156 offset:34816
    v_mfma_f32_16x16x32_bf16 v[56:59], v[120:123], v[96:99], v[56:59]
    ds_read_b128 v[76:79], v156 offset:36864
    v_mfma_f32_16x16x32_bf16 v[60:63], v[124:127], v[96:99], v[60:63]
    ds_read_b128 v[80:83], v156 offset:38912
    v_mfma_f32_16x16x32_bf16 v[64:67], v[128:131], v[96:99], v[64:67]
    s_waitcnt lgkmcnt(9)
    v_mfma_f32_16x16x32_bf16 v[4:7], v[100:103], v[68:71], v[4:7]
    ds_read_b64_tr_b16 v[116:117], v158 offset:40960
    s_waitcnt lgkmcnt(8)
    v_mfma_f32_16x16x32_bf16 v[8:11], v[104:107], v[68:71], v[8:11]
    ds_read_b64_tr_b16 v[118:119], v158 offset:41984
    s_waitcnt lgkmcnt(7)
    v_mfma_f32_16x16x32_bf16 v[12:15], v[108:111], v[68:71], v[12:15]
    ds_read_b128 v[84:87], v157 offset:32768
    s_waitcnt lgkmcnt(6)
    v_mfma_f32_16x16x32_bf16 v[16:19], v[112:115], v[68:71], v[16:19]
    ds_read_b64_tr_b16 v[120:121], v159 offset:40960
    s_waitcnt lgkmcnt(6)
    v_mfma_f32_16x16x32_bf16 v[20:23], v[100:103], v[72:75], v[20:23]
    ds_read_b64_tr_b16 v[122:123], v159 offset:41984
    v_mfma_f32_16x16x32_bf16 v[24:27], v[104:107], v[72:75], v[24:27]
    ds_read_b64_tr_b16 v[124:125], v160 offset:40960
    v_mfma_f32_16x16x32_bf16 v[28:31], v[108:111], v[72:75], v[28:31]
    ds_read_b64_tr_b16 v[126:127], v160 offset:41984
    v_mfma_f32_16x16x32_bf16 v[32:35], v[112:115], v[72:75], v[32:35]
    ds_read_b64_tr_b16 v[128:129], v161 offset:40960
    s_waitcnt lgkmcnt(9)
    v_mfma_f32_16x16x32_bf16 v[36:39], v[100:103], v[76:79], v[36:39]
    ds_read_b64_tr_b16 v[130:131], v161 offset:41984
    v_mfma_f32_16x16x32_bf16 v[40:43], v[104:107], v[76:79], v[40:43]
    ds_read_b128 v[88:91], v157 offset:34816
    v_mfma_f32_16x16x32_bf16 v[44:47], v[108:111], v[76:79], v[44:47]
    ds_read_b128 v[92:95], v157 offset:36864
    v_mfma_f32_16x16x32_bf16 v[48:51], v[112:115], v[76:79], v[48:51]
    ds_read_b128 v[96:99], v157 offset:38912
    s_waitcnt lgkmcnt(12)
    v_mfma_f32_16x16x32_bf16 v[52:55], v[100:103], v[80:83], v[52:55]
    v_mfma_f32_16x16x32_bf16 v[56:59], v[104:107], v[80:83], v[56:59]
    v_mfma_f32_16x16x32_bf16 v[60:63], v[108:111], v[80:83], v[60:63]
    v_mfma_f32_16x16x32_bf16 v[64:67], v[112:115], v[80:83], v[64:67]
    s_waitcnt lgkmcnt(9)
    v_mfma_f32_16x16x32_bf16 v[4:7], v[116:119], v[84:87], v[4:7]
    s_waitcnt lgkmcnt(7)
    v_mfma_f32_16x16x32_bf16 v[8:11], v[120:123], v[84:87], v[8:11]
    s_waitcnt lgkmcnt(5)
    v_mfma_f32_16x16x32_bf16 v[12:15], v[124:127], v[84:87], v[12:15]
    s_waitcnt lgkmcnt(3)
    v_mfma_f32_16x16x32_bf16 v[16:19], v[128:131], v[84:87], v[16:19]
    s_waitcnt lgkmcnt(0)
    s_barrier
    ds_read_b64_tr_b16 v[100:101], v158 offset:49152
    v_mfma_f32_16x16x32_bf16 v[20:23], v[116:119], v[88:91], v[20:23]
    ds_read_b64_tr_b16 v[102:103], v158 offset:50176
    v_mfma_f32_16x16x32_bf16 v[24:27], v[120:123], v[88:91], v[24:27]
    ds_read_b128 v[68:71], v156 offset:49152
    v_mfma_f32_16x16x32_bf16 v[28:31], v[124:127], v[88:91], v[28:31]
    ds_read_b64_tr_b16 v[104:105], v159 offset:49152
    v_mfma_f32_16x16x32_bf16 v[32:35], v[128:131], v[88:91], v[32:35]
    ds_read_b64_tr_b16 v[106:107], v159 offset:50176
    v_mfma_f32_16x16x32_bf16 v[36:39], v[116:119], v[92:95], v[36:39]
    ds_read_b64_tr_b16 v[108:109], v160 offset:49152
    v_mfma_f32_16x16x32_bf16 v[40:43], v[120:123], v[92:95], v[40:43]
    ds_read_b64_tr_b16 v[110:111], v160 offset:50176
    v_mfma_f32_16x16x32_bf16 v[44:47], v[124:127], v[92:95], v[44:47]
    ds_read_b64_tr_b16 v[112:113], v161 offset:49152
    v_mfma_f32_16x16x32_bf16 v[48:51], v[128:131], v[92:95], v[48:51]
    ds_read_b64_tr_b16 v[114:115], v161 offset:50176
    v_mfma_f32_16x16x32_bf16 v[52:55], v[116:119], v[96:99], v[52:55]
    ds_read_b128 v[72:75], v156 offset:51200
    v_mfma_f32_16x16x32_bf16 v[56:59], v[120:123], v[96:99], v[56:59]
    ds_read_b128 v[76:79], v156 offset:53248
    v_mfma_f32_16x16x32_bf16 v[60:63], v[124:127], v[96:99], v[60:63]
    ds_read_b128 v[80:83], v156 offset:55296
    v_mfma_f32_16x16x32_bf16 v[64:67], v[128:131], v[96:99], v[64:67]
    s_waitcnt lgkmcnt(9)
    v_mfma_f32_16x16x32_bf16 v[4:7], v[100:103], v[68:71], v[4:7]
    ds_read_b64_tr_b16 v[116:117], v158 offset:57344
    s_waitcnt lgkmcnt(8)
    v_mfma_f32_16x16x32_bf16 v[8:11], v[104:107], v[68:71], v[8:11]
    ds_read_b64_tr_b16 v[118:119], v158 offset:58368
    s_waitcnt lgkmcnt(7)
    v_mfma_f32_16x16x32_bf16 v[12:15], v[108:111], v[68:71], v[12:15]
    ds_read_b128 v[84:87], v157 offset:49152
    s_waitcnt lgkmcnt(6)
    v_mfma_f32_16x16x32_bf16 v[16:19], v[112:115], v[68:71], v[16:19]
    ds_read_b64_tr_b16 v[120:121], v159 offset:57344
    s_waitcnt lgkmcnt(6)
    v_mfma_f32_16x16x32_bf16 v[20:23], v[100:103], v[72:75], v[20:23]
    ds_read_b64_tr_b16 v[122:123], v159 offset:58368
    v_mfma_f32_16x16x32_bf16 v[24:27], v[104:107], v[72:75], v[24:27]
    ds_read_b64_tr_b16 v[124:125], v160 offset:57344
    v_mfma_f32_16x16x32_bf16 v[28:31], v[108:111], v[72:75], v[28:31]
    ds_read_b64_tr_b16 v[126:127], v160 offset:58368
    v_mfma_f32_16x16x32_bf16 v[32:35], v[112:115], v[72:75], v[32:35]
    ds_read_b64_tr_b16 v[128:129], v161 offset:57344
    s_waitcnt lgkmcnt(9)
    v_mfma_f32_16x16x32_bf16 v[36:39], v[100:103], v[76:79], v[36:39]
    ds_read_b64_tr_b16 v[130:131], v161 offset:58368
    v_mfma_f32_16x16x32_bf16 v[40:43], v[104:107], v[76:79], v[40:43]
    ds_read_b128 v[88:91], v157 offset:51200
    v_mfma_f32_16x16x32_bf16 v[44:47], v[108:111], v[76:79], v[44:47]
    ds_read_b128 v[92:95], v157 offset:53248
    v_mfma_f32_16x16x32_bf16 v[48:51], v[112:115], v[76:79], v[48:51]
    ds_read_b128 v[96:99], v157 offset:55296
    s_waitcnt lgkmcnt(12)
    v_mfma_f32_16x16x32_bf16 v[52:55], v[100:103], v[80:83], v[52:55]
    v_mfma_f32_16x16x32_bf16 v[56:59], v[104:107], v[80:83], v[56:59]
    v_mfma_f32_16x16x32_bf16 v[60:63], v[108:111], v[80:83], v[60:63]
    v_mfma_f32_16x16x32_bf16 v[64:67], v[112:115], v[80:83], v[64:67]
    s_waitcnt lgkmcnt(9)
    v_mfma_f32_16x16x32_bf16 v[4:7], v[116:119], v[84:87], v[4:7]
    s_waitcnt lgkmcnt(7)
    v_mfma_f32_16x16x32_bf16 v[8:11], v[120:123], v[84:87], v[8:11]
    s_waitcnt lgkmcnt(5)
    v_mfma_f32_16x16x32_bf16 v[12:15], v[124:127], v[84:87], v[12:15]
    s_waitcnt lgkmcnt(3)
    v_mfma_f32_16x16x32_bf16 v[16:19], v[128:131], v[84:87], v[16:19]
    s_waitcnt lgkmcnt(0)
    s_barrier
    ds_read_b64_tr_b16 v[100:101], v158 offset:0
    v_mfma_f32_16x16x32_bf16 v[20:23], v[116:119], v[88:91], v[20:23]
    ds_read_b64_tr_b16 v[102:103], v158 offset:1024
    v_mfma_f32_16x16x32_bf16 v[24:27], v[120:123], v[88:91], v[24:27]
    ds_read_b128 v[68:71], v156 offset:0
    v_mfma_f32_16x16x32_bf16 v[28:31], v[124:127], v[88:91], v[28:31]
    ds_read_b64_tr_b16 v[104:105], v159 offset:0
    v_mfma_f32_16x16x32_bf16 v[32:35], v[128:131], v[88:91], v[32:35]
    ds_read_b64_tr_b16 v[106:107], v159 offset:1024
    v_mfma_f32_16x16x32_bf16 v[36:39], v[116:119], v[92:95], v[36:39]
    ds_read_b64_tr_b16 v[108:109], v160 offset:0
    v_pk_mul_f32 v[4:5], v[4:5], s[92:93]
    v_pk_mul_f32 v[6:7], v[6:7], s[92:93]
    v_pk_mul_f32 v[8:9], v[8:9], s[92:93]
    v_pk_mul_f32 v[10:11], v[10:11], s[92:93]
    v_cvt_pk_bf16_f32 v148, v4, v5
    v_mfma_f32_16x16x32_bf16 v[40:43], v[120:123], v[92:95], v[40:43]
    ds_read_b64_tr_b16 v[110:111], v160 offset:1024
    v_cvt_pk_bf16_f32 v149, v6, v7
    v_cvt_pk_bf16_f32 v150, v8, v9
    v_cvt_pk_bf16_f32 v151, v10, v11
    buffer_store_dwordx4 v[148:151], v163, s[20:23], s40 offen sc1
    v_pk_mul_f32 v[12:13], v[12:13], s[92:93]
    v_mfma_f32_16x16x32_bf16 v[44:47], v[124:127], v[92:95], v[44:47]
    ds_read_b64_tr_b16 v[112:113], v161 offset:0
    v_pk_mul_f32 v[14:15], v[14:15], s[92:93]
    v_pk_mul_f32 v[16:17], v[16:17], s[92:93]
    v_pk_mul_f32 v[18:19], v[18:19], s[92:93]
    v_cvt_pk_bf16_f32 v152, v12, v13
    v_mfma_f32_16x16x32_bf16 v[48:51], v[128:131], v[92:95], v[48:51]
    ds_read_b64_tr_b16 v[114:115], v161 offset:1024
    v_cvt_pk_bf16_f32 v153, v14, v15
    v_cvt_pk_bf16_f32 v154, v16, v17
    v_cvt_pk_bf16_f32 v155, v18, v19
    buffer_store_dwordx4 v[152:155], v165, s[20:23], s40 offen sc1
    v_mfma_f32_16x16x32_bf16 v[52:55], v[116:119], v[96:99], v[52:55]
    ds_read_b128 v[72:75], v156 offset:2048
    v_pk_mul_f32 v[20:21], v[20:21], s[92:93]
    v_pk_mul_f32 v[22:23], v[22:23], s[92:93]
    v_pk_mul_f32 v[24:25], v[24:25], s[92:93]
    v_pk_mul_f32 v[26:27], v[26:27], s[92:93]
    v_cvt_pk_bf16_f32 v148, v20, v21
    v_mfma_f32_16x16x32_bf16 v[56:59], v[120:123], v[96:99], v[56:59]
    ds_read_b128 v[76:79], v156 offset:4096
    v_cvt_pk_bf16_f32 v149, v22, v23
    v_cvt_pk_bf16_f32 v150, v24, v25
    v_cvt_pk_bf16_f32 v151, v26, v27
    buffer_store_dwordx4 v[148:151], v164, s[20:23], s40 offen sc1
    v_pk_mul_f32 v[28:29], v[28:29], s[92:93]
    v_mfma_f32_16x16x32_bf16 v[60:63], v[124:127], v[96:99], v[60:63]
    ds_read_b128 v[80:83], v156 offset:6144
    v_pk_mul_f32 v[30:31], v[30:31], s[92:93]
    v_pk_mul_f32 v[32:33], v[32:33], s[92:93]
    v_pk_mul_f32 v[34:35], v[34:35], s[92:93]
    v_cvt_pk_bf16_f32 v152, v28, v29
    v_mfma_f32_16x16x32_bf16 v[64:67], v[128:131], v[96:99], v[64:67]
    v_cvt_pk_bf16_f32 v153, v30, v31
    v_cvt_pk_bf16_f32 v154, v32, v33
    v_cvt_pk_bf16_f32 v155, v34, v35
    buffer_store_dwordx4 v[152:155], v166, s[20:23], s40 offen sc1
    v_pk_mul_f32 v[36:37], v[36:37], s[92:93]
    v_pk_mul_f32 v[38:39], v[38:39], s[92:93]
    v_pk_mul_f32 v[40:41], v[40:41], s[92:93]
    v_pk_mul_f32 v[42:43], v[42:43], s[92:93]
    v_cvt_pk_bf16_f32 v148, v36, v37
    v_cvt_pk_bf16_f32 v149, v38, v39
    v_cvt_pk_bf16_f32 v150, v40, v41
    v_cvt_pk_bf16_f32 v151, v42, v43
    buffer_store_dwordx4 v[148:151], v163, s[20:23], s41 offen sc1
    v_pk_mul_f32 v[44:45], v[44:45], s[92:93]
    v_pk_mul_f32 v[46:47], v[46:47], s[92:93]
    v_pk_mul_f32 v[48:49], v[48:49], s[92:93]
    v_pk_mul_f32 v[50:51], v[50:51], s[92:93]
    v_cvt_pk_bf16_f32 v152, v44, v45
    v_cvt_pk_bf16_f32 v153, v46, v47
    v_cvt_pk_bf16_f32 v154, v48, v49
    v_cvt_pk_bf16_f32 v155, v50, v51
    buffer_store_dwordx4 v[152:155], v165, s[20:23], s41 offen sc1
    s_nop 3
    v_pk_mul_f32 v[52:53], v[52:53], s[92:93]
    v_pk_mul_f32 v[54:55], v[54:55], s[92:93]
    v_pk_mul_f32 v[56:57], v[56:57], s[92:93]
    v_pk_mul_f32 v[58:59], v[58:59], s[92:93]
    v_cvt_pk_bf16_f32 v148, v52, v53
    v_cvt_pk_bf16_f32 v149, v54, v55
    v_cvt_pk_bf16_f32 v150, v56, v57
    v_cvt_pk_bf16_f32 v151, v58, v59
    buffer_store_dwordx4 v[148:151], v164, s[20:23], s41 offen sc1
    v_pk_mul_f32 v[60:61], v[60:61], s[92:93]
    v_pk_mul_f32 v[62:63], v[62:63], s[92:93]
    v_pk_mul_f32 v[64:65], v[64:65], s[92:93]
    v_pk_mul_f32 v[66:67], v[66:67], s[92:93]
    v_cvt_pk_bf16_f32 v152, v60, v61
    v_cvt_pk_bf16_f32 v153, v62, v63
    v_cvt_pk_bf16_f32 v154, v64, v65
    v_cvt_pk_bf16_f32 v155, v66, v67
    buffer_store_dwordx4 v[152:155], v166, s[20:23], s41 offen sc1
    s_cmp_eq_u32 s33, 1
    s_cbranch_scc1 L_att
    s_mov_b32 s33, 1
    s_cmp_lt_u32 s35, 2
    s_mov_b32 s26, 3145728
    s_cselect_b32 s26, s26, 1048576
    s_add_u32 s20, s20, s26
    s_addc_u32 s21, s21, 0
    s_branch L_g1_Q_go
L_g1_K:
    s_lshr_b32 s29, s35, 1
    s_lshl_b32 s29, s29, 3
    s_and_b32 s27, s35, 1
    s_lshl_b32 s27, s27, 1
    s_add_u32 s29, s29, s27
    s_lshl_b32 s27, s57, 2
    s_add_u32 s27, s27, s29
    s_mul_i32 s26, s27, 262144
    s_lshl_b32 s27, s34, 2
    s_lshl_b32 s28, s56, 1
    s_add_u32 s27, s27, s28
    s_mul_i32 s27, s27, 4096
    s_add_u32 s26, s26, s27
    s_add_u32 s26, s26, 8388608
    s_add_u32 s20, s4, s26
    s_addc_u32 s21, s5, 0
    s_and_b32 s21, s21, 0xffff
    s_mov_b32 s22, 1048576
    s_mov_b32 s23, 0x20000
    s_mov_b32 s40, 0
    s_mov_b32 s41, 4096
    v_and_b32 v68, 15, v2
    v_lshrrev_b32 v69, 4, v2
    v_and_b32 v71, 1, v69
    v_lshlrev_b32 v71, 9, v71
    v_lshlrev_b32 v72, 4, v68
    v_add_u32 v71, v71, v72
    v_lshrrev_b32 v70, 1, v69
    v_lshlrev_b32 v70, 10, v70
    v_add_u32 v74, v70, v71
    v_add_u32 v163, 0, v74
    v_add_u32 v164, 256, v74
    v_add_u32 v165, 262144, v74
    v_add_u32 v166, 262400, v74
    s_barrier
    ds_read_b64_tr_b16 v[100:101], v158 offset:0
    ds_read_b64_tr_b16 v[102:103], v158 offset:1024
    ds_read_b128 v[68:71], v156 offset:0
    ds_read_b64_tr_b16 v[104:105], v159 offset:0
    ds_read_b64_tr_b16 v[106:107], v159 offset:1024
    ds_read_b64_tr_b16 v[108:109], v160 offset:0
    ds_read_b64_tr_b16 v[110:111], v160 offset:1024
    ds_read_b64_tr_b16 v[112:113], v161 offset:0
    ds_read_b64_tr_b16 v[114:115], v161 offset:1024
    ds_read_b128 v[72:75], v156 offset:2048
    ds_read_b128 v[76:79], v156 offset:4096
    ds_read_b128 v[80:83], v156 offset:6144
L_g1_K_go:
    s_waitcnt lgkmcnt(9)
    v_mfma_f32_16x16x32_bf16 v[4:7], v[100:103], v[68:71], 0
    ds_read_b64_tr_b16 v[116:117], v158 offset:8192
    s_waitcnt lgkmcnt(8)
    v_mfma_f32_16x16x32_bf16 v[8:11], v[104:107], v[68:71], 0
    ds_read_b64_tr_b16 v[118:119], v158 offset:9216
    s_waitcnt lgkmcnt(7)
    v_mfma_f32_16x16x32_bf16 v[12:15], v[108:111], v[68:71], 0
    ds_read_b128 v[84:87], v157 offset:0
    s_waitcnt lgkmcnt(6)
    v_mfma_f32_16x16x32_bf16 v[16:19], v[112:115], v[68:71], 0
    ds_read_b64_tr_b16 v[120:121], v159 offset:8192
    s_waitcnt lgkmcnt(6)
    v_mfma_f32_16x16x32_bf16 v[20:23], v[100:103], v[72:75], 0
    ds_read_b64_tr_b16 v[122:123], v159 offset:9216
    v_mfma_f32_16x16x32_bf16 v[24:27], v[104:107], v[72:75], 0
    ds_read_b64_tr_b16 v[124:125], v160 offset:8192
    v_mfma_f32_16x16x32_bf16 v[28:31], v[108:111], v[72:75], 0
    ds_read_b64_tr_b16 v[126:127], v160 offset:9216
    v_mfma_f32_16x16x32_bf16 v[32:35], v[112:115], v[72:75], 0
    ds_read_b64_tr_b16 v[128:129], v161 offset:8192
    s_waitcnt lgkmcnt(9)
    v_mfma_f32_16x16x32_bf16 v[36:39], v[100:103], v[76:79], 0
    ds_read_b64_tr_b16 v[130:131], v161 offset:9216
    v_mfma_f32_16x16x32_bf16 v[40:43], v[104:107], v[76:79], 0
    ds_read_b128 v[88:91], v157 offset:2048
    v_mfma_f32_16x16x32_bf16 v[44:47], v[108:111], v[76:79], 0
    ds_read_b128 v[92:95], v157 offset:4096
    v_mfma_f32_16x16x32_bf16 v[48:51], v[112:115], v[76:79], 0
    ds_read_b128 v[96:99], v157 offset:6144
    s_waitcnt lgkmcnt(12)
    v_mfma_f32_16x16x32_bf16 v[52:55], v[100:103], v[80:83], 0
    v_mfma_f32_16x16x32_bf16 v[56:59], v[104:107], v[80:83], 0
    v_mfma_f32_16x16x32_bf16 v[60:63], v[108:111], v[80:83], 0
    v_mfma_f32_16x16x32_bf16 v[64:67], v[112:115], v[80:83], 0
    s_mov_b32 s58, 0
.p2align 6
L_loop_K:
    s_waitcnt lgkmcnt(9)
    v_mfma_f32_16x16x32_bf16 v[4:7], v[116:119], v[84:87], v[4:7]
    s_waitcnt lgkmcnt(7)
    v_mfma_f32_16x16x32_bf16 v[8:11], v[120:123], v[84:87], v[8:11]
    s_waitcnt lgkmcnt(5)
    v_mfma_f32_16x16x32_bf16 v[12:15], v[124:127], v[84:87], v[12:15]
    s_waitcnt lgkmcnt(3)
    v_mfma_f32_16x16x32_bf16 v[16:19], v[128:131], v[84:87], v[16:19]
    s_waitcnt lgkmcnt(0)
    s_barrier
    ds_read_b64_tr_b16 v[100:101], v158 offset:16384
    v_mfma_f32_16x16x32_bf16 v[20:23], v[116:119], v[88:91], v[20:23]
    ds_read_b64_tr_b16 v[102:103], v158 offset:17408
    v_mfma_f32_16x16x32_bf16 v[24:27], v[120:123], v[88:91], v[24:27]
    ds_read_b128 v[68:71], v156 offset:16384
    v_mfma_f32_16x16x32_bf16 v[28:31], v[124:127], v[88:91], v[28:31]
    ds_read_b64_tr_b16 v[104:105], v159 offset:16384
    v_mfma_f32_16x16x32_bf16 v[32:35], v[128:131], v[88:91], v[32:35]
    ds_read_b64_tr_b16 v[106:107], v159 offset:17408
    v_mfma_f32_16x16x32_bf16 v[36:39], v[116:119], v[92:95], v[36:39]
    ds_read_b64_tr_b16 v[108:109], v160 offset:16384
    v_mfma_f32_16x16x32_bf16 v[40:43], v[120:123], v[92:95], v[40:43]
    ds_read_b64_tr_b16 v[110:111], v160 offset:17408
    v_mfma_f32_16x16x32_bf16 v[44:47], v[124:127], v[92:95], v[44:47]
    ds_read_b64_tr_b16 v[112:113], v161 offset:16384
    v_mfma_f32_16x16x32_bf16 v[48:51], v[128:131], v[92:95], v[48:51]
    ds_read_b64_tr_b16 v[114:115], v161 offset:17408
    v_mfma_f32_16x16x32_bf16 v[52:55], v[116:119], v[96:99], v[52:55]
    ds_read_b128 v[72:75], v156 offset:18432
    v_mfma_f32_16x16x32_bf16 v[56:59], v[120:123], v[96:99], v[56:59]
    ds_read_b128 v[76:79], v156 offset:20480
    v_mfma_f32_16x16x32_bf16 v[60:63], v[124:127], v[96:99], v[60:63]
    ds_read_b128 v[80:83], v156 offset:22528
    v_mfma_f32_16x16x32_bf16 v[64:67], v[128:131], v[96:99], v[64:67]
    s_waitcnt lgkmcnt(9)
    v_mfma_f32_16x16x32_bf16 v[4:7], v[100:103], v[68:71], v[4:7]
    ds_read_b64_tr_b16 v[116:117], v158 offset:24576
    s_waitcnt lgkmcnt(8)
    v_mfma_f32_16x16x32_bf16 v[8:11], v[104:107], v[68:71], v[8:11]
    ds_read_b64_tr_b16 v[118:119], v158 offset:25600
    s_waitcnt lgkmcnt(7)
    v_mfma_f32_16x16x32_bf16 v[12:15], v[108:111], v[68:71], v[12:15]
    ds_read_b128 v[84:87], v157 offset:16384
    s_waitcnt lgkmcnt(6)
    v_mfma_f32_16x16x32_bf16 v[16:19], v[112:115], v[68:71], v[16:19]
    ds_read_b64_tr_b16 v[120:121], v159 offset:24576
    s_waitcnt lgkmcnt(6)
    v_mfma_f32_16x16x32_bf16 v[20:23], v[100:103], v[72:75], v[20:23]
    ds_read_b64_tr_b16 v[122:123], v159 offset:25600
    v_mfma_f32_16x16x32_bf16 v[24:27], v[104:107], v[72:75], v[24:27]
    ds_read_b64_tr_b16 v[124:125], v160 offset:24576
    v_mfma_f32_16x16x32_bf16 v[28:31], v[108:111], v[72:75], v[28:31]
    ds_read_b64_tr_b16 v[126:127], v160 offset:25600
    v_mfma_f32_16x16x32_bf16 v[32:35], v[112:115], v[72:75], v[32:35]
    ds_read_b64_tr_b16 v[128:129], v161 offset:24576
    s_waitcnt lgkmcnt(9)
    v_mfma_f32_16x16x32_bf16 v[36:39], v[100:103], v[76:79], v[36:39]
    ds_read_b64_tr_b16 v[130:131], v161 offset:25600
    v_mfma_f32_16x16x32_bf16 v[40:43], v[104:107], v[76:79], v[40:43]
    ds_read_b128 v[88:91], v157 offset:18432
    v_mfma_f32_16x16x32_bf16 v[44:47], v[108:111], v[76:79], v[44:47]
    ds_read_b128 v[92:95], v157 offset:20480
    v_mfma_f32_16x16x32_bf16 v[48:51], v[112:115], v[76:79], v[48:51]
    ds_read_b128 v[96:99], v157 offset:22528
    s_waitcnt lgkmcnt(12)
    v_mfma_f32_16x16x32_bf16 v[52:55], v[100:103], v[80:83], v[52:55]
    v_mfma_f32_16x16x32_bf16 v[56:59], v[104:107], v[80:83], v[56:59]
    v_mfma_f32_16x16x32_bf16 v[60:63], v[108:111], v[80:83], v[60:63]
    v_mfma_f32_16x16x32_bf16 v[64:67], v[112:115], v[80:83], v[64:67]
    s_waitcnt lgkmcnt(9)
    v_mfma_f32_16x16x32_bf16 v[4:7], v[116:119], v[84:87], v[4:7]
    s_waitcnt lgkmcnt(7)
    v_mfma_f32_16x16x32_bf16 v[8:11], v[120:123], v[84:87], v[8:11]
    s_waitcnt lgkmcnt(5)
    v_mfma_f32_16x16x32_bf16 v[12:15], v[124:127], v[84:87], v[12:15]
    s_waitcnt lgkmcnt(3)
    v_mfma_f32_16x16x32_bf16 v[16:19], v[128:131], v[84:87], v[16:19]
    s_waitcnt lgkmcnt(0)
    s_waitcnt vmcnt(0)
    s_barrier
    ds_read_b64_tr_b16 v[100:101], v158 offset:32768
    v_mfma_f32_16x16x32_bf16 v[20:23], v[116:119], v[88:91], v[20:23]
    ds_read_b64_tr_b16 v[102:103], v158 offset:33792
    v_mfma_f32_16x16x32_bf16 v[24:27], v[120:123], v[88:91], v[24:27]
    ds_read_b128 v[68:71], v156 offset:32768
    v_mfma_f32_16x16x32_bf16 v[28:31], v[124:127], v[88:91], v[28:31]
    ds_read_b64_tr_b16 v[104:105], v159 offset:32768
    v_mfma_f32_16x16x32_bf16 v[32:35], v[128:131], v[88:91], v[32:35]
    ds_read_b64_tr_b16 v[106:107], v159 offset:33792
    v_mfma_f32_16x16x32_bf16 v[36:39], v[116:119], v[92:95], v[36:39]
    ds_read_b64_tr_b16 v[108:109], v160 offset:32768
    v_mfma_f32_16x16x32_bf16 v[40:43], v[120:123], v[92:95], v[40:43]
    ds_read_b64_tr_b16 v[110:111], v160 offset:33792
    v_mfma_f32_16x16x32_bf16 v[44:47], v[124:127], v[92:95], v[44:47]
    ds_read_b64_tr_b16 v[112:113], v161 offset:32768
    v_mfma_f32_16x16x32_bf16 v[48:51], v[128:131], v[92:95], v[48:51]
    ds_read_b64_tr_b16 v[114:115], v161 offset:33792
    v_mfma_f32_16x16x32_bf16 v[52:55], v[116:119], v[96:99], v[52:55]
    ds_read_b128 v[72:75], v156 offset:34816
    v_mfma_f32_16x16x32_bf16 v[56:59], v[120:123], v[96:99], v[56:59]
    ds_read_b128 v[76:79], v156 offset:36864
    v_mfma_f32_16x16x32_bf16 v[60:63], v[124:127], v[96:99], v[60:63]
    ds_read_b128 v[80:83], v156 offset:38912
    v_mfma_f32_16x16x32_bf16 v[64:67], v[128:131], v[96:99], v[64:67]
    s_waitcnt lgkmcnt(9)
    v_mfma_f32_16x16x32_bf16 v[4:7], v[100:103], v[68:71], v[4:7]
    ds_read_b64_tr_b16 v[116:117], v158 offset:40960
    s_waitcnt lgkmcnt(8)
    v_mfma_f32_16x16x32_bf16 v[8:11], v[104:107], v[68:71], v[8:11]
    ds_read_b64_tr_b16 v[118:119], v158 offset:41984
    s_waitcnt lgkmcnt(7)
    v_mfma_f32_16x16x32_bf16 v[12:15], v[108:111], v[68:71], v[12:15]
    ds_read_b128 v[84:87], v157 offset:32768
    s_waitcnt lgkmcnt(6)
    v_mfma_f32_16x16x32_bf16 v[16:19], v[112:115], v[68:71], v[16:19]
    ds_read_b64_tr_b16 v[120:121], v159 offset:40960
    s_waitcnt lgkmcnt(6)
    v_mfma_f32_16x16x32_bf16 v[20:23], v[100:103], v[72:75], v[20:23]
    ds_read_b64_tr_b16 v[122:123], v159 offset:41984
    v_mfma_f32_16x16x32_bf16 v[24:27], v[104:107], v[72:75], v[24:27]
    ds_read_b64_tr_b16 v[124:125], v160 offset:40960
    v_mfma_f32_16x16x32_bf16 v[28:31], v[108:111], v[72:75], v[28:31]
    ds_read_b64_tr_b16 v[126:127], v160 offset:41984
    v_mfma_f32_16x16x32_bf16 v[32:35], v[112:115], v[72:75], v[32:35]
    ds_read_b64_tr_b16 v[128:129], v161 offset:40960
    s_waitcnt lgkmcnt(9)
    v_mfma_f32_16x16x32_bf16 v[36:39], v[100:103], v[76:79], v[36:39]
    ds_read_b64_tr_b16 v[130:131], v161 offset:41984
    v_mfma_f32_16x16x32_bf16 v[40:43], v[104:107], v[76:79], v[40:43]
    ds_read_b128 v[88:91], v157 offset:34816
    v_mfma_f32_16x16x32_bf16 v[44:47], v[108:111], v[76:79], v[44:47]
    ds_read_b128 v[92:95], v157 offset:36864
    v_mfma_f32_16x16x32_bf16 v[48:51], v[112:115], v[76:79], v[48:51]
    ds_read_b128 v[96:99], v157 offset:38912
    s_waitcnt lgkmcnt(12)
    v_mfma_f32_16x16x32_bf16 v[52:55], v[100:103], v[80:83], v[52:55]
    v_mfma_f32_16x16x32_bf16 v[56:59], v[104:107], v[80:83], v[56:59]
    v_mfma_f32_16x16x32_bf16 v[60:63], v[108:111], v[80:83], v[60:63]
    v_mfma_f32_16x16x32_bf16 v[64:67], v[112:115], v[80:83], v[64:67]
    s_waitcnt lgkmcnt(9)
    v_mfma_f32_16x16x32_bf16 v[4:7], v[116:119], v[84:87], v[4:7]
    s_waitcnt lgkmcnt(7)
    v_mfma_f32_16x16x32_bf16 v[8:11], v[120:123], v[84:87], v[8:11]
    s_waitcnt lgkmcnt(5)
    v_mfma_f32_16x16x32_bf16 v[12:15], v[124:127], v[84:87], v[12:15]
    s_waitcnt lgkmcnt(3)
    v_mfma_f32_16x16x32_bf16 v[16:19], v[128:131], v[84:87], v[16:19]
    s_waitcnt lgkmcnt(0)
    s_barrier
    ds_read_b64_tr_b16 v[100:101], v158 offset:49152
    v_mfma_f32_16x16x32_bf16 v[20:23], v[116:119], v[88:91], v[20:23]
    ds_read_b64_tr_b16 v[102:103], v158 offset:50176
    v_mfma_f32_16x16x32_bf16 v[24:27], v[120:123], v[88:91], v[24:27]
    ds_read_b128 v[68:71], v156 offset:49152
    v_mfma_f32_16x16x32_bf16 v[28:31], v[124:127], v[88:91], v[28:31]
    ds_read_b64_tr_b16 v[104:105], v159 offset:49152
    v_mfma_f32_16x16x32_bf16 v[32:35], v[128:131], v[88:91], v[32:35]
    ds_read_b64_tr_b16 v[106:107], v159 offset:50176
    v_mfma_f32_16x16x32_bf16 v[36:39], v[116:119], v[92:95], v[36:39]
    ds_read_b64_tr_b16 v[108:109], v160 offset:49152
    v_mfma_f32_16x16x32_bf16 v[40:43], v[120:123], v[92:95], v[40:43]
    ds_read_b64_tr_b16 v[110:111], v160 offset:50176
    v_mfma_f32_16x16x32_bf16 v[44:47], v[124:127], v[92:95], v[44:47]
    ds_read_b64_tr_b16 v[112:113], v161 offset:49152
    v_mfma_f32_16x16x32_bf16 v[48:51], v[128:131], v[92:95], v[48:51]
    ds_read_b64_tr_b16 v[114:115], v161 offset:50176
    v_mfma_f32_16x16x32_bf16 v[52:55], v[116:119], v[96:99], v[52:55]
    ds_read_b128 v[72:75], v156 offset:51200
    v_mfma_f32_16x16x32_bf16 v[56:59], v[120:123], v[96:99], v[56:59]
    ds_read_b128 v[76:79], v156 offset:53248
    v_mfma_f32_16x16x32_bf16 v[60:63], v[124:127], v[96:99], v[60:63]
    ds_read_b128 v[80:83], v156 offset:55296
    v_mfma_f32_16x16x32_bf16 v[64:67], v[128:131], v[96:99], v[64:67]
    s_waitcnt lgkmcnt(9)
    v_mfma_f32_16x16x32_bf16 v[4:7], v[100:103], v[68:71], v[4:7]
    ds_read_b64_tr_b16 v[116:117], v158 offset:57344
    s_waitcnt lgkmcnt(8)
    v_mfma_f32_16x16x32_bf16 v[8:11], v[104:107], v[68:71], v[8:11]
    ds_read_b64_tr_b16 v[118:119], v158 offset:58368
    s_waitcnt lgkmcnt(7)
    v_mfma_f32_16x16x32_bf16 v[12:15], v[108:111], v[68:71], v[12:15]
    ds_read_b128 v[84:87], v157 offset:49152
    s_waitcnt lgkmcnt(6)
    v_mfma_f32_16x16x32_bf16 v[16:19], v[112:115], v[68:71], v[16:19]
    ds_read_b64_tr_b16 v[120:121], v159 offset:57344
    s_waitcnt lgkmcnt(6)
    v_mfma_f32_16x16x32_bf16 v[20:23], v[100:103], v[72:75], v[20:23]
    ds_read_b64_tr_b16 v[122:123], v159 offset:58368
    v_mfma_f32_16x16x32_bf16 v[24:27], v[104:107], v[72:75], v[24:27]
    ds_read_b64_tr_b16 v[124:125], v160 offset:57344
    v_mfma_f32_16x16x32_bf16 v[28:31], v[108:111], v[72:75], v[28:31]
    ds_read_b64_tr_b16 v[126:127], v160 offset:58368
    v_mfma_f32_16x16x32_bf16 v[32:35], v[112:115], v[72:75], v[32:35]
    ds_read_b64_tr_b16 v[128:129], v161 offset:57344
    s_waitcnt lgkmcnt(9)
    v_mfma_f32_16x16x32_bf16 v[36:39], v[100:103], v[76:79], v[36:39]
    ds_read_b64_tr_b16 v[130:131], v161 offset:58368
    v_mfma_f32_16x16x32_bf16 v[40:43], v[104:107], v[76:79], v[40:43]
    ds_read_b128 v[88:91], v157 offset:51200
    v_mfma_f32_16x16x32_bf16 v[44:47], v[108:111], v[76:79], v[44:47]
    ds_read_b128 v[92:95], v157 offset:53248
    v_mfma_f32_16x16x32_bf16 v[48:51], v[112:115], v[76:79], v[48:51]
    ds_read_b128 v[96:99], v157 offset:55296
    s_waitcnt lgkmcnt(12)
    v_mfma_f32_16x16x32_bf16 v[52:55], v[100:103], v[80:83], v[52:55]
    v_mfma_f32_16x16x32_bf16 v[56:59], v[104:107], v[80:83], v[56:59]
    v_mfma_f32_16x16x32_bf16 v[60:63], v[108:111], v[80:83], v[60:63]
    v_mfma_f32_16x16x32_bf16 v[64:67], v[112:115], v[80:83], v[64:67]
    s_waitcnt lgkmcnt(9)
    v_mfma_f32_16x16x32_bf16 v[4:7], v[116:119], v[84:87], v[4:7]
    s_waitcnt lgkmcnt(7)
    v_mfma_f32_16x16x32_bf16 v[8:11], v[120:123], v[84:87], v[8:11]
    s_waitcnt lgkmcnt(5)
    v_mfma_f32_16x16x32_bf16 v[12:15], v[124:127], v[84:87], v[12:15]
    s_waitcnt lgkmcnt(3)
    v_mfma_f32_16x16x32_bf16 v[16:19], v[128:131], v[84:87], v[16:19]
    s_waitcnt lgkmcnt(0)
    s_barrier
    ds_read_b64_tr_b16 v[100:101], v158 offset:0
    v_mfma_f32_16x16x32_bf16 v[20:23], v[116:119], v[88:91], v[20:23]
    ds_read_b64_tr_b16 v[102:103], v158 offset:1024
    v_mfma_f32_16x16x32_bf16 v[24:27], v[120:123], v[88:91], v[24:27]
    ds_read_b128 v[68:71], v156 offset:0
    v_mfma_f32_16x16x32_bf16 v[28:31], v[124:127], v[88:91], v[28:31]
    ds_read_b64_tr_b16 v[104:105], v159 offset:0
    v_mfma_f32_16x16x32_bf16 v[32:35], v[128:131], v[88:91], v[32:35]
    ds_read_b64_tr_b16 v[106:107], v159 offset:1024
    v_mfma_f32_16x16x32_bf16 v[36:39], v[116:119], v[92:95], v[36:39]
    ds_read_b64_tr_b16 v[108:109], v160 offset:0
    v_mfma_f32_16x16x32_bf16 v[40:43], v[120:123], v[92:95], v[40:43]
    ds_read_b64_tr_b16 v[110:111], v160 offset:1024
    v_mfma_f32_16x16x32_bf16 v[44:47], v[124:127], v[92:95], v[44:47]
    ds_read_b64_tr_b16 v[112:113], v161 offset:0
    v_mfma_f32_16x16x32_bf16 v[48:51], v[128:131], v[92:95], v[48:51]
    ds_read_b64_tr_b16 v[114:115], v161 offset:1024
    v_mfma_f32_16x16x32_bf16 v[52:55], v[116:119], v[96:99], v[52:55]
    ds_read_b128 v[72:75], v156 offset:2048
    v_mfma_f32_16x16x32_bf16 v[56:59], v[120:123], v[96:99], v[56:59]
    ds_read_b128 v[76:79], v156 offset:4096
    v_mfma_f32_16x16x32_bf16 v[60:63], v[124:127], v[96:99], v[60:63]
    ds_read_b128 v[80:83], v156 offset:6144
    v_mfma_f32_16x16x32_bf16 v[64:67], v[128:131], v[96:99], v[64:67]
    s_waitcnt lgkmcnt(9)
    v_mfma_f32_16x16x32_bf16 v[4:7], v[100:103], v[68:71], v[4:7]
    ds_read_b64_tr_b16 v[116:117], v158 offset:8192
    s_waitcnt lgkmcnt(8)
    v_mfma_f32_16x16x32_bf16 v[8:11], v[104:107], v[68:71], v[8:11]
    ds_read_b64_tr_b16 v[118:119], v158 offset:9216
    s_waitcnt lgkmcnt(7)
    v_mfma_f32_16x16x32_bf16 v[12:15], v[108:111], v[68:71], v[12:15]
    ds_read_b128 v[84:87], v157 offset:0
    s_waitcnt lgkmcnt(6)
    v_mfma_f32_16x16x32_bf16 v[16:19], v[112:115], v[68:71], v[16:19]
    ds_read_b64_tr_b16 v[120:121], v159 offset:8192
    s_waitcnt lgkmcnt(6)
    v_mfma_f32_16x16x32_bf16 v[20:23], v[100:103], v[72:75], v[20:23]
    ds_read_b64_tr_b16 v[122:123], v159 offset:9216
    v_mfma_f32_16x16x32_bf16 v[24:27], v[104:107], v[72:75], v[24:27]
    ds_read_b64_tr_b16 v[124:125], v160 offset:8192
    v_mfma_f32_16x16x32_bf16 v[28:31], v[108:111], v[72:75], v[28:31]
    ds_read_b64_tr_b16 v[126:127], v160 offset:9216
    v_mfma_f32_16x16x32_bf16 v[32:35], v[112:115], v[72:75], v[32:35]
    ds_read_b64_tr_b16 v[128:129], v161 offset:8192
    s_waitcnt lgkmcnt(9)
    v_mfma_f32_16x16x32_bf16 v[36:39], v[100:103], v[76:79], v[36:39]
    ds_read_b64_tr_b16 v[130:131], v161 offset:9216
    v_mfma_f32_16x16x32_bf16 v[40:43], v[104:107], v[76:79], v[40:43]
    ds_read_b128 v[88:91], v157 offset:2048
    v_mfma_f32_16x16x32_bf16 v[44:47], v[108:111], v[76:79], v[44:47]
    ds_read_b128 v[92:95], v157 offset:4096
    v_mfma_f32_16x16x32_bf16 v[48:51], v[112:115], v[76:79], v[48:51]
    ds_read_b128 v[96:99], v157 offset:6144
    s_waitcnt lgkmcnt(12)
    v_mfma_f32_16x16x32_bf16 v[52:55], v[100:103], v[80:83], v[52:55]
    v_mfma_f32_16x16x32_bf16 v[56:59], v[104:107], v[80:83], v[56:59]
    v_mfma_f32_16x16x32_bf16 v[60:63], v[108:111], v[80:83], v[60:63]
    v_mfma_f32_16x16x32_bf16 v[64:67], v[112:115], v[80:83], v[64:67]
    s_add_u32 s58, s58, 1
    s_cmp_lt_u32 s58, 3
    s_cbranch_scc1 L_loop_K
    s_waitcnt lgkmcnt(9)
    v_mfma_f32_16x16x32_bf16 v[4:7], v[116:119], v[84:87], v[4:7]
    s_waitcnt lgkmcnt(7)
    v_mfma_f32_16x16x32_bf16 v[8:11], v[120:123], v[84:87], v[8:11]
    s_waitcnt lgkmcnt(5)
    v_mfma_f32_16x16x32_bf16 v[12:15], v[124:127], v[84:87], v[12:15]
    s_waitcnt lgkmcnt(3)
    v_mfma_f32_16x16x32_bf16 v[16:19], v[128:131], v[84:87], v[16:19]
    s_waitcnt lgkmcnt(0)
    s_barrier
    ds_read_b64_tr_b16 v[100:101], v158 offset:16384
    v_mfma_f32_16x16x32_bf16 v[20:23], v[116:119], v[88:91], v[20:23]
    ds_read_b64_tr_b16 v[102:103], v158 offset:17408
    v_mfma_f32_16x16x32_bf16 v[24:27], v[120:123], v[88:91], v[24:27]
    ds_read_b128 v[68:71], v156 offset:16384
    v_mfma_f32_16x16x32_bf16 v[28:31], v[124:127], v[88:91], v[28:31]
    ds_read_b64_tr_b16 v[104:105], v159 offset:16384
    v_mfma_f32_16x16x32_bf16 v[32:35], v[128:131], v[88:91], v[32:35]
    ds_read_b64_tr_b16 v[106:107], v159 offset:17408
    v_mfma_f32_16x16x32_bf16 v[36:39], v[116:119], v[92:95], v[36:39]
    ds_read_b64_tr_b16 v[108:109], v160 offset:16384
    v_mfma_f32_16x16x32_bf16 v[40:43], v[120:123], v[92:95], v[40:43]
    ds_read_b64_tr_b16 v[110:111], v160 offset:17408
    v_mfma_f32_16x16x32_bf16 v[44:47], v[124:127], v[92:95], v[44:47]
    ds_read_b64_tr_b16 v[112:113], v161 offset:16384
    v_mfma_f32_16x16x32_bf16 v[48:51], v[128:131], v[92:95], v[48:51]
    ds_read_b64_tr_b16 v[114:115], v161 offset:17408
    v_mfma_f32_16x16x32_bf16 v[52:55], v[116:119], v[96:99], v[52:55]
    ds_read_b128 v[72:75], v156 offset:18432
    v_mfma_f32_16x16x32_bf16 v[56:59], v[120:123], v[96:99], v[56:59]
    ds_read_b128 v[76:79], v156 offset:20480
    v_mfma_f32_16x16x32_bf16 v[60:63], v[124:127], v[96:99], v[60:63]
    ds_read_b128 v[80:83], v156 offset:22528
    v_mfma_f32_16x16x32_bf16 v[64:67], v[128:131], v[96:99], v[64:67]
    s_waitcnt lgkmcnt(9)
    v_mfma_f32_16x16x32_bf16 v[4:7], v[100:103], v[68:71], v[4:7]
    ds_read_b64_tr_b16 v[116:117], v158 offset:24576
    s_waitcnt lgkmcnt(8)
    v_mfma_f32_16x16x32_bf16 v[8:11], v[104:107], v[68:71], v[8:11]
    ds_read_b64_tr_b16 v[118:119], v158 offset:25600
    s_waitcnt lgkmcnt(7)
    v_mfma_f32_16x16x32_bf16 v[12:15], v[108:111], v[68:71], v[12:15]
    ds_read_b128 v[84:87], v157 offset:16384
    s_waitcnt lgkmcnt(6)
    v_mfma_f32_16x16x32_bf16 v[16:19], v[112:115], v[68:71], v[16:19]
    ds_read_b64_tr_b16 v[120:121], v159 offset:24576
    s_waitcnt lgkmcnt(6)
    v_mfma_f32_16x16x32_bf16 v[20:23], v[100:103], v[72:75], v[20:23]
    ds_read_b64_tr_b16 v[122:123], v159 offset:25600
    v_mfma_f32_16x16x32_bf16 v[24:27], v[104:107], v[72:75], v[24:27]
    ds_read_b64_tr_b16 v[124:125], v160 offset:24576
    v_mfma_f32_16x16x32_bf16 v[28:31], v[108:111], v[72:75], v[28:31]
    ds_read_b64_tr_b16 v[126:127], v160 offset:25600
    v_mfma_f32_16x16x32_bf16 v[32:35], v[112:115], v[72:75], v[32:35]
    ds_read_b64_tr_b16 v[128:129], v161 offset:24576
    s_waitcnt lgkmcnt(9)
    v_mfma_f32_16x16x32_bf16 v[36:39], v[100:103], v[76:79], v[36:39]
    ds_read_b64_tr_b16 v[130:131], v161 offset:25600
    v_mfma_f32_16x16x32_bf16 v[40:43], v[104:107], v[76:79], v[40:43]
    ds_read_b128 v[88:91], v157 offset:18432
    v_mfma_f32_16x16x32_bf16 v[44:47], v[108:111], v[76:79], v[44:47]
    ds_read_b128 v[92:95], v157 offset:20480
    v_mfma_f32_16x16x32_bf16 v[48:51], v[112:115], v[76:79], v[48:51]
    ds_read_b128 v[96:99], v157 offset:22528
    s_waitcnt lgkmcnt(12)
    v_mfma_f32_16x16x32_bf16 v[52:55], v[100:103], v[80:83], v[52:55]
    v_mfma_f32_16x16x32_bf16 v[56:59], v[104:107], v[80:83], v[56:59]
    v_mfma_f32_16x16x32_bf16 v[60:63], v[108:111], v[80:83], v[60:63]
    v_mfma_f32_16x16x32_bf16 v[64:67], v[112:115], v[80:83], v[64:67]
    s_waitcnt lgkmcnt(9)
    v_mfma_f32_16x16x32_bf16 v[4:7], v[116:119], v[84:87], v[4:7]
    s_waitcnt lgkmcnt(7)
    v_mfma_f32_16x16x32_bf16 v[8:11], v[120:123], v[84:87], v[8:11]
    s_waitcnt lgkmcnt(5)
    v_mfma_f32_16x16x32_bf16 v[12:15], v[124:127], v[84:87], v[12:15]
    s_waitcnt lgkmcnt(3)
    v_mfma_f32_16x16x32_bf16 v[16:19], v[128:131], v[84:87], v[16:19]
    s_waitcnt lgkmcnt(0)
    s_waitcnt vmcnt(0)
    s_barrier
    ds_read_b64_tr_b16 v[100:101], v158 offset:32768
    v_mfma_f32_16x16x32_bf16 v[20:23], v[116:119], v[88:91], v[20:23]
    ds_read_b64_tr_b16 v[102:103], v158 offset:33792
    v_mfma_f32_16x16x32_bf16 v[24:27], v[120:123], v[88:91], v[24:27]
    ds_read_b128 v[68:71], v156 offset:32768
    v_mfma_f32_16x16x32_bf16 v[28:31], v[124:127], v[88:91], v[28:31]
    ds_read_b64_tr_b16 v[104:105], v159 offset:32768
    v_mfma_f32_16x16x32_bf16 v[32:35], v[128:131], v[88:91], v[32:35]
    ds_read_b64_tr_b16 v[106:107], v159 offset:33792
    v_mfma_f32_16x16x32_bf16 v[36:39], v[116:119], v[92:95], v[36:39]
    ds_read_b64_tr_b16 v[108:109], v160 offset:32768
    v_mfma_f32_16x16x32_bf16 v[40:43], v[120:123], v[92:95], v[40:43]
    ds_read_b64_tr_b16 v[110:111], v160 offset:33792
    v_mfma_f32_16x16x32_bf16 v[44:47], v[124:127], v[92:95], v[44:47]
    ds_read_b64_tr_b16 v[112:113], v161 offset:32768
    v_mfma_f32_16x16x32_bf16 v[48:51], v[128:131], v[92:95], v[48:51]
    ds_read_b64_tr_b16 v[114:115], v161 offset:33792
    v_mfma_f32_16x16x32_bf16 v[52:55], v[116:119], v[96:99], v[52:55]
    ds_read_b128 v[72:75], v156 offset:34816
    v_mfma_f32_16x16x32_bf16 v[56:59], v[120:123], v[96:99], v[56:59]
    ds_read_b128 v[76:79], v156 offset:36864
    v_mfma_f32_16x16x32_bf16 v[60:63], v[124:127], v[96:99], v[60:63]
    ds_read_b128 v[80:83], v156 offset:38912
    v_mfma_f32_16x16x32_bf16 v[64:67], v[128:131], v[96:99], v[64:67]
    s_waitcnt lgkmcnt(9)
    v_mfma_f32_16x16x32_bf16 v[4:7], v[100:103], v[68:71], v[4:7]
    ds_read_b64_tr_b16 v[116:117], v158 offset:40960
    s_waitcnt lgkmcnt(8)
    v_mfma_f32_16x16x32_bf16 v[8:11], v[104:107], v[68:71], v[8:11]
    ds_read_b64_tr_b16 v[118:119], v158 offset:41984
    s_waitcnt lgkmcnt(7)
    v_mfma_f32_16x16x32_bf16 v[12:15], v[108:111], v[68:71], v[12:15]
    ds_read_b128 v[84:87], v157 offset:32768
    s_waitcnt lgkmcnt(6)
    v_mfma_f32_16x16x32_bf16 v[16:19], v[112:115], v[68:71], v[16:19]
    ds_read_b64_tr_b16 v[120:121], v159 offset:40960
    s_waitcnt lgkmcnt(6)
    v_mfma_f32_16x16x32_bf16 v[20:23], v[100:103], v[72:75], v[20:23]
    ds_read_b64_tr_b16 v[122:123], v159 offset:41984
    v_mfma_f32_16x16x32_bf16 v[24:27], v[104:107], v[72:75], v[24:27]
    ds_read_b64_tr_b16 v[124:125], v160 offset:40960
    v_mfma_f32_16x16x32_bf16 v[28:31], v[108:111], v[72:75], v[28:31]
    ds_read_b64_tr_b16 v[126:127], v160 offset:41984
    v_mfma_f32_16x16x32_bf16 v[32:35], v[112:115], v[72:75], v[32:35]
    ds_read_b64_tr_b16 v[128:129], v161 offset:40960
    s_waitcnt lgkmcnt(9)
    v_mfma_f32_16x16x32_bf16 v[36:39], v[100:103], v[76:79], v[36:39]
    ds_read_b64_tr_b16 v[130:131], v161 offset:41984
    v_mfma_f32_16x16x32_bf16 v[40:43], v[104:107], v[76:79], v[40:43]
    ds_read_b128 v[88:91], v157 offset:34816
    v_mfma_f32_16x16x32_bf16 v[44:47], v[108:111], v[76:79], v[44:47]
    ds_read_b128 v[92:95], v157 offset:36864
    v_mfma_f32_16x16x32_bf16 v[48:51], v[112:115], v[76:79], v[48:51]
    ds_read_b128 v[96:99], v157 offset:38912
    s_waitcnt lgkmcnt(12)
    v_mfma_f32_16x16x32_bf16 v[52:55], v[100:103], v[80:83], v[52:55]
    v_mfma_f32_16x16x32_bf16 v[56:59], v[104:107], v[80:83], v[56:59]
    v_mfma_f32_16x16x32_bf16 v[60:63], v[108:111], v[80:83], v[60:63]
    v_mfma_f32_16x16x32_bf16 v[64:67], v[112:115], v[80:83], v[64:67]
    s_waitcnt lgkmcnt(9)
    v_mfma_f32_16x16x32_bf16 v[4:7], v[116:119], v[84:87], v[4:7]
    s_waitcnt lgkmcnt(7)
    v_mfma_f32_16x16x32_bf16 v[8:11], v[120:123], v[84:87], v[8:11]
    s_waitcnt lgkmcnt(5)
    v_mfma_f32_16x16x32_bf16 v[12:15], v[124:127], v[84:87], v[12:15]
    s_waitcnt lgkmcnt(3)
    v_mfma_f32_16x16x32_bf16 v[16:19], v[128:131], v[84:87], v[16:19]
    s_waitcnt lgkmcnt(0)
    s_barrier
    ds_read_b64_tr_b16 v[100:101], v158 offset:49152
    v_mfma_f32_16x16x32_bf16 v[20:23], v[116:119], v[88:91], v[20:23]
    ds_read_b64_tr_b16 v[102:103], v158 offset:50176
    v_mfma_f32_16x16x32_bf16 v[24:27], v[120:123], v[88:91], v[24:27]
    ds_read_b128 v[68:71], v156 offset:49152
    v_mfma_f32_16x16x32_bf16 v[28:31], v[124:127], v[88:91], v[28:31]
    ds_read_b64_tr_b16 v[104:105], v159 offset:49152
    v_mfma_f32_16x16x32_bf16 v[32:35], v[128:131], v[88:91], v[32:35]
    ds_read_b64_tr_b16 v[106:107], v159 offset:50176
    v_mfma_f32_16x16x32_bf16 v[36:39], v[116:119], v[92:95], v[36:39]
    ds_read_b64_tr_b16 v[108:109], v160 offset:49152
    v_mfma_f32_16x16x32_bf16 v[40:43], v[120:123], v[92:95], v[40:43]
    ds_read_b64_tr_b16 v[110:111], v160 offset:50176
    v_mfma_f32_16x16x32_bf16 v[44:47], v[124:127], v[92:95], v[44:47]
    ds_read_b64_tr_b16 v[112:113], v161 offset:49152
    v_mfma_f32_16x16x32_bf16 v[48:51], v[128:131], v[92:95], v[48:51]
    ds_read_b64_tr_b16 v[114:115], v161 offset:50176
    v_mfma_f32_16x16x32_bf16 v[52:55], v[116:119], v[96:99], v[52:55]
    ds_read_b128 v[72:75], v156 offset:51200
    v_mfma_f32_16x16x32_bf16 v[56:59], v[120:123], v[96:99], v[56:59]
    ds_read_b128 v[76:79], v156 offset:53248
    v_mfma_f32_16x16x32_bf16 v[60:63], v[124:127], v[96:99], v[60:63]
    ds_read_b128 v[80:83], v156 offset:55296
    v_mfma_f32_16x16x32_bf16 v[64:67], v[128:131], v[96:99], v[64:67]
    s_waitcnt lgkmcnt(9)
    v_mfma_f32_16x16x32_bf16 v[4:7], v[100:103], v[68:71], v[4:7]
    ds_read_b64_tr_b16 v[116:117], v158 offset:57344
    s_waitcnt lgkmcnt(8)
    v_mfma_f32_16x16x32_bf16 v[8:11], v[104:107], v[68:71], v[8:11]
    ds_read_b64_tr_b16 v[118:119], v158 offset:58368
    s_waitcnt lgkmcnt(7)
    v_mfma_f32_16x16x32_bf16 v[12:15], v[108:111], v[68:71], v[12:15]
    ds_read_b128 v[84:87], v157 offset:49152
    s_waitcnt lgkmcnt(6)
    v_mfma_f32_16x16x32_bf16 v[16:19], v[112:115], v[68:71], v[16:19]
    ds_read_b64_tr_b16 v[120:121], v159 offset:57344
    s_waitcnt lgkmcnt(6)
    v_mfma_f32_16x16x32_bf16 v[20:23], v[100:103], v[72:75], v[20:23]
    ds_read_b64_tr_b16 v[122:123], v159 offset:58368
    v_mfma_f32_16x16x32_bf16 v[24:27], v[104:107], v[72:75], v[24:27]
    ds_read_b64_tr_b16 v[124:125], v160 offset:57344
    v_mfma_f32_16x16x32_bf16 v[28:31], v[108:111], v[72:75], v[28:31]
    ds_read_b64_tr_b16 v[126:127], v160 offset:58368
    v_mfma_f32_16x16x32_bf16 v[32:35], v[112:115], v[72:75], v[32:35]
    ds_read_b64_tr_b16 v[128:129], v161 offset:57344
    s_waitcnt lgkmcnt(9)
    v_mfma_f32_16x16x32_bf16 v[36:39], v[100:103], v[76:79], v[36:39]
    ds_read_b64_tr_b16 v[130:131], v161 offset:58368
    v_mfma_f32_16x16x32_bf16 v[40:43], v[104:107], v[76:79], v[40:43]
    ds_read_b128 v[88:91], v157 offset:51200
    v_mfma_f32_16x16x32_bf16 v[44:47], v[108:111], v[76:79], v[44:47]
    ds_read_b128 v[92:95], v157 offset:53248
    v_mfma_f32_16x16x32_bf16 v[48:51], v[112:115], v[76:79], v[48:51]
    ds_read_b128 v[96:99], v157 offset:55296
    s_waitcnt lgkmcnt(12)
    v_mfma_f32_16x16x32_bf16 v[52:55], v[100:103], v[80:83], v[52:55]
    v_mfma_f32_16x16x32_bf16 v[56:59], v[104:107], v[80:83], v[56:59]
    v_mfma_f32_16x16x32_bf16 v[60:63], v[108:111], v[80:83], v[60:63]
    v_mfma_f32_16x16x32_bf16 v[64:67], v[112:115], v[80:83], v[64:67]
    s_waitcnt lgkmcnt(9)
    v_mfma_f32_16x16x32_bf16 v[4:7], v[116:119], v[84:87], v[4:7]
    s_waitcnt lgkmcnt(7)
    v_mfma_f32_16x16x32_bf16 v[8:11], v[120:123], v[84:87], v[8:11]
    s_waitcnt lgkmcnt(5)
    v_mfma_f32_16x16x32_bf16 v[12:15], v[124:127], v[84:87], v[12:15]
    s_waitcnt lgkmcnt(3)
    v_mfma_f32_16x16x32_bf16 v[16:19], v[128:131], v[84:87], v[16:19]
    s_waitcnt lgkmcnt(0)
    s_barrier
    ds_read_b64_tr_b16 v[100:101], v158 offset:0
    v_mfma_f32_16x16x32_bf16 v[20:23], v[116:119], v[88:91], v[20:23]
    ds_read_b64_tr_b16 v[102:103], v158 offset:1024
    v_mfma_f32_16x16x32_bf16 v[24:27], v[120:123], v[88:91], v[24:27]
    ds_read_b128 v[68:71], v156 offset:0
    v_mfma_f32_16x16x32_bf16 v[28:31], v[124:127], v[88:91], v[28:31]
    ds_read_b64_tr_b16 v[104:105], v159 offset:0
    v_mfma_f32_16x16x32_bf16 v[32:35], v[128:131], v[88:91], v[32:35]
    ds_read_b64_tr_b16 v[106:107], v159 offset:1024
    v_mfma_f32_16x16x32_bf16 v[36:39], v[116:119], v[92:95], v[36:39]
    ds_read_b64_tr_b16 v[108:109], v160 offset:0
    v_cvt_pk_bf16_f32 v148, v4, v5
    v_cvt_pk_bf16_f32 v149, v6, v7
    v_cvt_pk_bf16_f32 v150, v8, v9
    v_mfma_f32_16x16x32_bf16 v[40:43], v[120:123], v[92:95], v[40:43]
    ds_read_b64_tr_b16 v[110:111], v160 offset:1024
    v_cvt_pk_bf16_f32 v151, v10, v11
    buffer_store_dwordx4 v[148:151], v163, s[20:23], s40 offen sc1
    v_cvt_pk_bf16_f32 v152, v12, v13
    v_mfma_f32_16x16x32_bf16 v[44:47], v[124:127], v[92:95], v[44:47]
    ds_read_b64_tr_b16 v[112:113], v161 offset:0
    v_cvt_pk_bf16_f32 v153, v14, v15
    v_cvt_pk_bf16_f32 v154, v16, v17
    v_mfma_f32_16x16x32_bf16 v[48:51], v[128:131], v[92:95], v[48:51]
    ds_read_b64_tr_b16 v[114:115], v161 offset:1024
    v_cvt_pk_bf16_f32 v155, v18, v19
    buffer_store_dwordx4 v[152:155], v165, s[20:23], s40 offen sc1
    v_mfma_f32_16x16x32_bf16 v[52:55], v[116:119], v[96:99], v[52:55]
    ds_read_b128 v[72:75], v156 offset:2048
    v_cvt_pk_bf16_f32 v148, v20, v21
    v_cvt_pk_bf16_f32 v149, v22, v23
    v_cvt_pk_bf16_f32 v150, v24, v25
    v_mfma_f32_16x16x32_bf16 v[56:59], v[120:123], v[96:99], v[56:59]
    ds_read_b128 v[76:79], v156 offset:4096
    v_cvt_pk_bf16_f32 v151, v26, v27
    buffer_store_dwordx4 v[148:151], v164, s[20:23], s40 offen sc1
    v_cvt_pk_bf16_f32 v152, v28, v29
    v_mfma_f32_16x16x32_bf16 v[60:63], v[124:127], v[96:99], v[60:63]
    ds_read_b128 v[80:83], v156 offset:6144
    v_cvt_pk_bf16_f32 v153, v30, v31
    v_cvt_pk_bf16_f32 v154, v32, v33
    v_mfma_f32_16x16x32_bf16 v[64:67], v[128:131], v[96:99], v[64:67]
    v_cvt_pk_bf16_f32 v155, v34, v35
    buffer_store_dwordx4 v[152:155], v166, s[20:23], s40 offen sc1
    v_cvt_pk_bf16_f32 v148, v36, v37
    v_cvt_pk_bf16_f32 v149, v38, v39
    v_cvt_pk_bf16_f32 v150, v40, v41
    v_cvt_pk_bf16_f32 v151, v42, v43
    buffer_store_dwordx4 v[148:151], v163, s[20:23], s41 offen sc1
    v_cvt_pk_bf16_f32 v152, v44, v45
    v_cvt_pk_bf16_f32 v153, v46, v47
    v_cvt_pk_bf16_f32 v154, v48, v49
    v_cvt_pk_bf16_f32 v155, v50, v51
    buffer_store_dwordx4 v[152:155], v165, s[20:23], s41 offen sc1
    s_nop 3
    v_cvt_pk_bf16_f32 v148, v52, v53
    v_cvt_pk_bf16_f32 v149, v54, v55
    v_cvt_pk_bf16_f32 v150, v56, v57
    v_cvt_pk_bf16_f32 v151, v58, v59
    buffer_store_dwordx4 v[148:151], v164, s[20:23], s41 offen sc1
    v_cvt_pk_bf16_f32 v152, v60, v61
    v_cvt_pk_bf16_f32 v153, v62, v63
    v_cvt_pk_bf16_f32 v154, v64, v65
    v_cvt_pk_bf16_f32 v155, v66, v67
    buffer_store_dwordx4 v[152:155], v166, s[20:23], s41 offen sc1
    s_cmp_eq_u32 s33, 1
    s_cbranch_scc1 L_att
    s_mov_b32 s33, 1
    s_cmp_lt_u32 s35, 2
    s_mov_b32 s26, 6291456
    s_cselect_b32 s26, s26, 2097152
    s_add_u32 s20, s20, s26
    s_addc_u32 s21, s21, 0
    s_branch L_g1_K_go
L_g1_V:
    s_lshr_b32 s29, s35, 1
    s_lshl_b32 s29, s29, 3
    s_and_b32 s27, s35, 1
    s_lshl_b32 s27, s27, 1
    s_add_u32 s29, s29, s27
    s_lshl_b32 s27, s57, 2
    s_add_u32 s27, s27, s29
    s_mul_i32 s26, s27, 262144
    s_lshl_b32 s27, s34, 2
    s_lshl_b32 s28, s56, 1
    s_add_u32 s27, s27, s28
    s_mul_i32 s27, s27, 4096
    s_add_u32 s26, s26, s27
    s_add_u32 s26, s26, 8388608
    s_add_u32 s20, s4, s26
    s_addc_u32 s21, s5, 0
    s_and_b32 s21, s21, 0xffff
    s_mov_b32 s22, 1048576
    s_mov_b32 s23, 0x20000
    s_mov_b32 s40, 0
    s_mov_b32 s41, 4096
    v_and_b32 v68, 15, v2
    v_lshrrev_b32 v69, 4, v2
    v_and_b32 v71, 1, v69
    v_lshlrev_b32 v71, 9, v71
    v_lshlrev_b32 v72, 4, v68
    v_add_u32 v71, v71, v72
    v_lshrrev_b32 v70, 5, v2
    v_lshlrev_b32 v70, 8, v70
    v_add_u32 v74, v70, v71
    v_add_u32 v163, 2048, v74
    v_add_u32 v164, 3072, v74
    v_add_u32 v165, 264192, v74
    v_add_u32 v166, 265216, v74
    s_barrier
    ds_read_b64_tr_b16 v[100:101], v158 offset:0
    ds_read_b64_tr_b16 v[102:103], v158 offset:1024
    ds_read_b128 v[68:71], v156 offset:0
    ds_read_b64_tr_b16 v[104:105], v159 offset:0
    ds_read_b64_tr_b16 v[106:107], v159 offset:1024
    ds_read_b64_tr_b16 v[108:109], v160 offset:0
    ds_read_b64_tr_b16 v[110:111], v160 offset:1024
    ds_read_b64_tr_b16 v[112:113], v161 offset:0
    ds_read_b64_tr_b16 v[114:115], v161 offset:1024
    ds_read_b128 v[72:75], v156 offset:2048
    ds_read_b128 v[76:79], v156 offset:4096
    ds_read_b128 v[80:83], v156 offset:6144
L_g1_V_go:
    s_waitcnt lgkmcnt(9)
    v_mfma_f32_16x16x32_bf16 v[4:7], v[68:71], v[100:103], 0
    ds_read_b64_tr_b16 v[116:117], v158 offset:8192
    s_waitcnt lgkmcnt(8)
    v_mfma_f32_16x16x32_bf16 v[8:11], v[68:71], v[104:107], 0
    ds_read_b64_tr_b16 v[118:119], v158 offset:9216
    s_waitcnt lgkmcnt(7)
    v_mfma_f32_16x16x32_bf16 v[12:15], v[68:71], v[108:111], 0
    ds_read_b128 v[84:87], v157 offset:0
    s_waitcnt lgkmcnt(6)
    v_mfma_f32_16x16x32_bf16 v[16:19], v[68:71], v[112:115], 0
    ds_read_b64_tr_b16 v[120:121], v159 offset:8192
    s_waitcnt lgkmcnt(6)
    v_mfma_f32_16x16x32_bf16 v[20:23], v[72:75], v[100:103], 0
    ds_read_b64_tr_b16 v[122:123], v159 offset:9216
    v_mfma_f32_16x16x32_bf16 v[24:27], v[72:75], v[104:107], 0
    ds_read_b64_tr_b16 v[124:125], v160 offset:8192
    v_mfma_f32_16x16x32_bf16 v[28:31], v[72:75], v[108:111], 0
    ds_read_b64_tr_b16 v[126:127], v160 offset:9216
    v_mfma_f32_16x16x32_bf16 v[32:35], v[72:75], v[112:115], 0
    ds_read_b64_tr_b16 v[128:129], v161 offset:8192
    s_waitcnt lgkmcnt(9)
    v_mfma_f32_16x16x32_bf16 v[36:39], v[76:79], v[100:103], 0
    ds_read_b64_tr_b16 v[130:131], v161 offset:9216
    v_mfma_f32_16x16x32_bf16 v[40:43], v[76:79], v[104:107], 0
    ds_read_b128 v[88:91], v157 offset:2048
    v_mfma_f32_16x16x32_bf16 v[44:47], v[76:79], v[108:111], 0
    ds_read_b128 v[92:95], v157 offset:4096
    v_mfma_f32_16x16x32_bf16 v[48:51], v[76:79], v[112:115], 0
    ds_read_b128 v[96:99], v157 offset:6144
    s_waitcnt lgkmcnt(12)
    v_mfma_f32_16x16x32_bf16 v[52:55], v[80:83], v[100:103], 0
    v_mfma_f32_16x16x32_bf16 v[56:59], v[80:83], v[104:107], 0
    v_mfma_f32_16x16x32_bf16 v[60:63], v[80:83], v[108:111], 0
    v_mfma_f32_16x16x32_bf16 v[64:67], v[80:83], v[112:115], 0
    s_mov_b32 s58, 0
.p2align 6
L_loop_V:
    s_waitcnt lgkmcnt(9)
    v_mfma_f32_16x16x32_bf16 v[4:7], v[84:87], v[116:119], v[4:7]
    s_waitcnt lgkmcnt(7)
    v_mfma_f32_16x16x32_bf16 v[8:11], v[84:87], v[120:123], v[8:11]
    s_waitcnt lgkmcnt(5)
    v_mfma_f32_16x16x32_bf16 v[12:15], v[84:87], v[124:127], v[12:15]
    s_waitcnt lgkmcnt(3)
    v_mfma_f32_16x16x32_bf16 v[16:19], v[84:87], v[128:131], v[16:19]
    s_waitcnt lgkmcnt(0)
    s_barrier
    ds_read_b64_tr_b16 v[100:101], v158 offset:16384
    v_mfma_f32_16x16x32_bf16 v[20:23], v[88:91], v[116:119], v[20:23]
    ds_read_b64_tr_b16 v[102:103], v158 offset:17408
    v_mfma_f32_16x16x32_bf16 v[24:27], v[88:91], v[120:123], v[24:27]
    ds_read_b128 v[68:71], v156 offset:16384
    v_mfma_f32_16x16x32_bf16 v[28:31], v[88:91], v[124:127], v[28:31]
    ds_read_b64_tr_b16 v[104:105], v159 offset:16384
    v_mfma_f32_16x16x32_bf16 v[32:35], v[88:91], v[128:131], v[32:35]
    ds_read_b64_tr_b16 v[106:107], v159 offset:17408
    v_mfma_f32_16x16x32_bf16 v[36:39], v[92:95], v[116:119], v[36:39]
    ds_read_b64_tr_b16 v[108:109], v160 offset:16384
    v_mfma_f32_16x16x32_bf16 v[40:43], v[92:95], v[120:123], v[40:43]
    ds_read_b64_tr_b16 v[110:111], v160 offset:17408
    v_mfma_f32_16x16x32_bf16 v[44:47], v[92:95], v[124:127], v[44:47]
    ds_read_b64_tr_b16 v[112:113], v161 offset:16384
    v_mfma_f32_16x16x32_bf16 v[48:51], v[92:95], v[128:131], v[48:51]
    ds_read_b64_tr_b16 v[114:115], v161 offset:17408
    v_mfma_f32_16x16x32_bf16 v[52:55], v[96:99], v[116:119], v[52:55]
    ds_read_b128 v[72:75], v156 offset:18432
    v_mfma_f32_16x16x32_bf16 v[56:59], v[96:99], v[120:123], v[56:59]
    ds_read_b128 v[76:79], v156 offset:20480
    v_mfma_f32_16x16x32_bf16 v[60:63], v[96:99], v[124:127], v[60:63]
    ds_read_b128 v[80:83], v156 offset:22528
    v_mfma_f32_16x16x32_bf16 v[64:67], v[96:99], v[128:131], v[64:67]
    s_waitcnt lgkmcnt(9)
    v_mfma_f32_16x16x32_bf16 v[4:7], v[68:71], v[100:103], v[4:7]
    ds_read_b64_tr_b16 v[116:117], v158 offset:24576
    s_waitcnt lgkmcnt(8)
    v_mfma_f32_16x16x32_bf16 v[8:11], v[68:71], v[104:107], v[8:11]
    ds_read_b64_tr_b16 v[118:119], v158 offset:25600
    s_waitcnt lgkmcnt(7)
    v_mfma_f32_16x16x32_bf16 v[12:15], v[68:71], v[108:111], v[12:15]
    ds_read_b128 v[84:87], v157 offset:16384
    s_waitcnt lgkmcnt(6)
    v_mfma_f32_16x16x32_bf16 v[16:19], v[68:71], v[112:115], v[16:19]
    ds_read_b64_tr_b16 v[120:121], v159 offset:24576
    s_waitcnt lgkmcnt(6)
    v_mfma_f32_16x16x32_bf16 v[20:23], v[72:75], v[100:103], v[20:23]
    ds_read_b64_tr_b16 v[122:123], v159 offset:25600
    v_mfma_f32_16x16x32_bf16 v[24:27], v[72:75], v[104:107], v[24:27]
    ds_read_b64_tr_b16 v[124:125], v160 offset:24576
    v_mfma_f32_16x16x32_bf16 v[28:31], v[72:75], v[108:111], v[28:31]
    ds_read_b64_tr_b16 v[126:127], v160 offset:25600
    v_mfma_f32_16x16x32_bf16 v[32:35], v[72:75], v[112:115], v[32:35]
    ds_read_b64_tr_b16 v[128:129], v161 offset:24576
    s_waitcnt lgkmcnt(9)
    v_mfma_f32_16x16x32_bf16 v[36:39], v[76:79], v[100:103], v[36:39]
    ds_read_b64_tr_b16 v[130:131], v161 offset:25600
    v_mfma_f32_16x16x32_bf16 v[40:43], v[76:79], v[104:107], v[40:43]
    ds_read_b128 v[88:91], v157 offset:18432
    v_mfma_f32_16x16x32_bf16 v[44:47], v[76:79], v[108:111], v[44:47]
    ds_read_b128 v[92:95], v157 offset:20480
    v_mfma_f32_16x16x32_bf16 v[48:51], v[76:79], v[112:115], v[48:51]
    ds_read_b128 v[96:99], v157 offset:22528
    s_waitcnt lgkmcnt(12)
    v_mfma_f32_16x16x32_bf16 v[52:55], v[80:83], v[100:103], v[52:55]
    v_mfma_f32_16x16x32_bf16 v[56:59], v[80:83], v[104:107], v[56:59]
    v_mfma_f32_16x16x32_bf16 v[60:63], v[80:83], v[108:111], v[60:63]
    v_mfma_f32_16x16x32_bf16 v[64:67], v[80:83], v[112:115], v[64:67]
    s_waitcnt lgkmcnt(9)
    v_mfma_f32_16x16x32_bf16 v[4:7], v[84:87], v[116:119], v[4:7]
    s_waitcnt lgkmcnt(7)
    v_mfma_f32_16x16x32_bf16 v[8:11], v[84:87], v[120:123], v[8:11]
    s_waitcnt lgkmcnt(5)
    v_mfma_f32_16x16x32_bf16 v[12:15], v[84:87], v[124:127], v[12:15]
    s_waitcnt lgkmcnt(3)
    v_mfma_f32_16x16x32_bf16 v[16:19], v[84:87], v[128:131], v[16:19]
    s_waitcnt lgkmcnt(0)
    s_waitcnt vmcnt(0)
    s_barrier
    ds_read_b64_tr_b16 v[100:101], v158 offset:32768
    v_mfma_f32_16x16x32_bf16 v[20:23], v[88:91], v[116:119], v[20:23]
    ds_read_b64_tr_b16 v[102:103], v158 offset:33792
    v_mfma_f32_16x16x32_bf16 v[24:27], v[88:91], v[120:123], v[24:27]
    ds_read_b128 v[68:71], v156 offset:32768
    v_mfma_f32_16x16x32_bf16 v[28:31], v[88:91], v[124:127], v[28:31]
    ds_read_b64_tr_b16 v[104:105], v159 offset:32768
    v_mfma_f32_16x16x32_bf16 v[32:35], v[88:91], v[128:131], v[32:35]
    ds_read_b64_tr_b16 v[106:107], v159 offset:33792
    v_mfma_f32_16x16x32_bf16 v[36:39], v[92:95], v[116:119], v[36:39]
    ds_read_b64_tr_b16 v[108:109], v160 offset:32768
    v_mfma_f32_16x16x32_bf16 v[40:43], v[92:95], v[120:123], v[40:43]
    ds_read_b64_tr_b16 v[110:111], v160 offset:33792
    v_mfma_f32_16x16x32_bf16 v[44:47], v[92:95], v[124:127], v[44:47]
    ds_read_b64_tr_b16 v[112:113], v161 offset:32768
    v_mfma_f32_16x16x32_bf16 v[48:51], v[92:95], v[128:131], v[48:51]
    ds_read_b64_tr_b16 v[114:115], v161 offset:33792
    v_mfma_f32_16x16x32_bf16 v[52:55], v[96:99], v[116:119], v[52:55]
    ds_read_b128 v[72:75], v156 offset:34816
    v_mfma_f32_16x16x32_bf16 v[56:59], v[96:99], v[120:123], v[56:59]
    ds_read_b128 v[76:79], v156 offset:36864
    v_mfma_f32_16x16x32_bf16 v[60:63], v[96:99], v[124:127], v[60:63]
    ds_read_b128 v[80:83], v156 offset:38912
    v_mfma_f32_16x16x32_bf16 v[64:67], v[96:99], v[128:131], v[64:67]
    s_waitcnt lgkmcnt(9)
    v_mfma_f32_16x16x32_bf16 v[4:7], v[68:71], v[100:103], v[4:7]
    ds_read_b64_tr_b16 v[116:117], v158 offset:40960
    s_waitcnt lgkmcnt(8)
    v_mfma_f32_16x16x32_bf16 v[8:11], v[68:71], v[104:107], v[8:11]
    ds_read_b64_tr_b16 v[118:119], v158 offset:41984
    s_waitcnt lgkmcnt(7)
    v_mfma_f32_16x16x32_bf16 v[12:15], v[68:71], v[108:111], v[12:15]
    ds_read_b128 v[84:87], v157 offset:32768
    s_waitcnt lgkmcnt(6)
    v_mfma_f32_16x16x32_bf16 v[16:19], v[68:71], v[112:115], v[16:19]
    ds_read_b64_tr_b16 v[120:121], v159 offset:40960
    s_waitcnt lgkmcnt(6)
    v_mfma_f32_16x16x32_bf16 v[20:23], v[72:75], v[100:103], v[20:23]
    ds_read_b64_tr_b16 v[122:123], v159 offset:41984
    v_mfma_f32_16x16x32_bf16 v[24:27], v[72:75], v[104:107], v[24:27]
    ds_read_b64_tr_b16 v[124:125], v160 offset:40960
    v_mfma_f32_16x16x32_bf16 v[28:31], v[72:75], v[108:111], v[28:31]
    ds_read_b64_tr_b16 v[126:127], v160 offset:41984
    v_mfma_f32_16x16x32_bf16 v[32:35], v[72:75], v[112:115], v[32:35]
    ds_read_b64_tr_b16 v[128:129], v161 offset:40960
    s_waitcnt lgkmcnt(9)
    v_mfma_f32_16x16x32_bf16 v[36:39], v[76:79], v[100:103], v[36:39]
    ds_read_b64_tr_b16 v[130:131], v161 offset:41984
    v_mfma_f32_16x16x32_bf16 v[40:43], v[76:79], v[104:107], v[40:43]
    ds_read_b128 v[88:91], v157 offset:34816
    v_mfma_f32_16x16x32_bf16 v[44:47], v[76:79], v[108:111], v[44:47]
    ds_read_b128 v[92:95], v157 offset:36864
    v_mfma_f32_16x16x32_bf16 v[48:51], v[76:79], v[112:115], v[48:51]
    ds_read_b128 v[96:99], v157 offset:38912
    s_waitcnt lgkmcnt(12)
    v_mfma_f32_16x16x32_bf16 v[52:55], v[80:83], v[100:103], v[52:55]
    v_mfma_f32_16x16x32_bf16 v[56:59], v[80:83], v[104:107], v[56:59]
    v_mfma_f32_16x16x32_bf16 v[60:63], v[80:83], v[108:111], v[60:63]
    v_mfma_f32_16x16x32_bf16 v[64:67], v[80:83], v[112:115], v[64:67]
    s_waitcnt lgkmcnt(9)
    v_mfma_f32_16x16x32_bf16 v[4:7], v[84:87], v[116:119], v[4:7]
    s_waitcnt lgkmcnt(7)
    v_mfma_f32_16x16x32_bf16 v[8:11], v[84:87], v[120:123], v[8:11]
    s_waitcnt lgkmcnt(5)
    v_mfma_f32_16x16x32_bf16 v[12:15], v[84:87], v[124:127], v[12:15]
    s_waitcnt lgkmcnt(3)
    v_mfma_f32_16x16x32_bf16 v[16:19], v[84:87], v[128:131], v[16:19]
    s_waitcnt lgkmcnt(0)
    s_barrier
    ds_read_b64_tr_b16 v[100:101], v158 offset:49152
    v_mfma_f32_16x16x32_bf16 v[20:23], v[88:91], v[116:119], v[20:23]
    ds_read_b64_tr_b16 v[102:103], v158 offset:50176
    v_mfma_f32_16x16x32_bf16 v[24:27], v[88:91], v[120:123], v[24:27]
    ds_read_b128 v[68:71], v156 offset:49152
    v_mfma_f32_16x16x32_bf16 v[28:31], v[88:91], v[124:127], v[28:31]
    ds_read_b64_tr_b16 v[104:105], v159 offset:49152
    v_mfma_f32_16x16x32_bf16 v[32:35], v[88:91], v[128:131], v[32:35]
    ds_read_b64_tr_b16 v[106:107], v159 offset:50176
    v_mfma_f32_16x16x32_bf16 v[36:39], v[92:95], v[116:119], v[36:39]
    ds_read_b64_tr_b16 v[108:109], v160 offset:49152
    v_mfma_f32_16x16x32_bf16 v[40:43], v[92:95], v[120:123], v[40:43]
    ds_read_b64_tr_b16 v[110:111], v160 offset:50176
    v_mfma_f32_16x16x32_bf16 v[44:47], v[92:95], v[124:127], v[44:47]
    ds_read_b64_tr_b16 v[112:113], v161 offset:49152
    v_mfma_f32_16x16x32_bf16 v[48:51], v[92:95], v[128:131], v[48:51]
    ds_read_b64_tr_b16 v[114:115], v161 offset:50176
    v_mfma_f32_16x16x32_bf16 v[52:55], v[96:99], v[116:119], v[52:55]
    ds_read_b128 v[72:75], v156 offset:51200
    v_mfma_f32_16x16x32_bf16 v[56:59], v[96:99], v[120:123], v[56:59]
    ds_read_b128 v[76:79], v156 offset:53248
    v_mfma_f32_16x16x32_bf16 v[60:63], v[96:99], v[124:127], v[60:63]
    ds_read_b128 v[80:83], v156 offset:55296
    v_mfma_f32_16x16x32_bf16 v[64:67], v[96:99], v[128:131], v[64:67]
    s_waitcnt lgkmcnt(9)
    v_mfma_f32_16x16x32_bf16 v[4:7], v[68:71], v[100:103], v[4:7]
    ds_read_b64_tr_b16 v[116:117], v158 offset:57344
    s_waitcnt lgkmcnt(8)
    v_mfma_f32_16x16x32_bf16 v[8:11], v[68:71], v[104:107], v[8:11]
    ds_read_b64_tr_b16 v[118:119], v158 offset:58368
    s_waitcnt lgkmcnt(7)
    v_mfma_f32_16x16x32_bf16 v[12:15], v[68:71], v[108:111], v[12:15]
    ds_read_b128 v[84:87], v157 offset:49152
    s_waitcnt lgkmcnt(6)
    v_mfma_f32_16x16x32_bf16 v[16:19], v[68:71], v[112:115], v[16:19]
    ds_read_b64_tr_b16 v[120:121], v159 offset:57344
    s_waitcnt lgkmcnt(6)
    v_mfma_f32_16x16x32_bf16 v[20:23], v[72:75], v[100:103], v[20:23]
    ds_read_b64_tr_b16 v[122:123], v159 offset:58368
    v_mfma_f32_16x16x32_bf16 v[24:27], v[72:75], v[104:107], v[24:27]
    ds_read_b64_tr_b16 v[124:125], v160 offset:57344
    v_mfma_f32_16x16x32_bf16 v[28:31], v[72:75], v[108:111], v[28:31]
    ds_read_b64_tr_b16 v[126:127], v160 offset:58368
    v_mfma_f32_16x16x32_bf16 v[32:35], v[72:75], v[112:115], v[32:35]
    ds_read_b64_tr_b16 v[128:129], v161 offset:57344
    s_waitcnt lgkmcnt(9)
    v_mfma_f32_16x16x32_bf16 v[36:39], v[76:79], v[100:103], v[36:39]
    ds_read_b64_tr_b16 v[130:131], v161 offset:58368
    v_mfma_f32_16x16x32_bf16 v[40:43], v[76:79], v[104:107], v[40:43]
    ds_read_b128 v[88:91], v157 offset:51200
    v_mfma_f32_16x16x32_bf16 v[44:47], v[76:79], v[108:111], v[44:47]
    ds_read_b128 v[92:95], v157 offset:53248
    v_mfma_f32_16x16x32_bf16 v[48:51], v[76:79], v[112:115], v[48:51]
    ds_read_b128 v[96:99], v157 offset:55296
    s_waitcnt lgkmcnt(12)
    v_mfma_f32_16x16x32_bf16 v[52:55], v[80:83], v[100:103], v[52:55]
    v_mfma_f32_16x16x32_bf16 v[56:59], v[80:83], v[104:107], v[56:59]
    v_mfma_f32_16x16x32_bf16 v[60:63], v[80:83], v[108:111], v[60:63]
    v_mfma_f32_16x16x32_bf16 v[64:67], v[80:83], v[112:115], v[64:67]
    s_waitcnt lgkmcnt(9)
    v_mfma_f32_16x16x32_bf16 v[4:7], v[84:87], v[116:119], v[4:7]
    s_waitcnt lgkmcnt(7)
    v_mfma_f32_16x16x32_bf16 v[8:11], v[84:87], v[120:123], v[8:11]
    s_waitcnt lgkmcnt(5)
    v_mfma_f32_16x16x32_bf16 v[12:15], v[84:87], v[124:127], v[12:15]
    s_waitcnt lgkmcnt(3)
    v_mfma_f32_16x16x32_bf16 v[16:19], v[84:87], v[128:131], v[16:19]
    s_waitcnt lgkmcnt(0)
    s_barrier
    ds_read_b64_tr_b16 v[100:101], v158 offset:0
    v_mfma_f32_16x16x32_bf16 v[20:23], v[88:91], v[116:119], v[20:23]
    ds_read_b64_tr_b16 v[102:103], v158 offset:1024
    v_mfma_f32_16x16x32_bf16 v[24:27], v[88:91], v[120:123], v[24:27]
    ds_read_b128 v[68:71], v156 offset:0
    v_mfma_f32_16x16x32_bf16 v[28:31], v[88:91], v[124:127], v[28:31]
    ds_read_b64_tr_b16 v[104:105], v159 offset:0
    v_mfma_f32_16x16x32_bf16 v[32:35], v[88:91], v[128:131], v[32:35]
    ds_read_b64_tr_b16 v[106:107], v159 offset:1024
    v_mfma_f32_16x16x32_bf16 v[36:39], v[92:95], v[116:119], v[36:39]
    ds_read_b64_tr_b16 v[108:109], v160 offset:0
    v_mfma_f32_16x16x32_bf16 v[40:43], v[92:95], v[120:123], v[40:43]
    ds_read_b64_tr_b16 v[110:111], v160 offset:1024
    v_mfma_f32_16x16x32_bf16 v[44:47], v[92:95], v[124:127], v[44:47]
    ds_read_b64_tr_b16 v[112:113], v161 offset:0
    v_mfma_f32_16x16x32_bf16 v[48:51], v[92:95], v[128:131], v[48:51]
    ds_read_b64_tr_b16 v[114:115], v161 offset:1024
    v_mfma_f32_16x16x32_bf16 v[52:55], v[96:99], v[116:119], v[52:55]
    ds_read_b128 v[72:75], v156 offset:2048
    v_mfma_f32_16x16x32_bf16 v[56:59], v[96:99], v[120:123], v[56:59]
    ds_read_b128 v[76:79], v156 offset:4096
    v_mfma_f32_16x16x32_bf16 v[60:63], v[96:99], v[124:127], v[60:63]
    ds_read_b128 v[80:83], v156 offset:6144
    v_mfma_f32_16x16x32_bf16 v[64:67], v[96:99], v[128:131], v[64:67]
    s_waitcnt lgkmcnt(9)
    v_mfma_f32_16x16x32_bf16 v[4:7], v[68:71], v[100:103], v[4:7]
    ds_read_b64_tr_b16 v[116:117], v158 offset:8192
    s_waitcnt lgkmcnt(8)
    v_mfma_f32_16x16x32_bf16 v[8:11], v[68:71], v[104:107], v[8:11]
    ds_read_b64_tr_b16 v[118:119], v158 offset:9216
    s_waitcnt lgkmcnt(7)
    v_mfma_f32_16x16x32_bf16 v[12:15], v[68:71], v[108:111], v[12:15]
    ds_read_b128 v[84:87], v157 offset:0
    s_waitcnt lgkmcnt(6)
    v_mfma_f32_16x16x32_bf16 v[16:19], v[68:71], v[112:115], v[16:19]
    ds_read_b64_tr_b16 v[120:121], v159 offset:8192
    s_waitcnt lgkmcnt(6)
    v_mfma_f32_16x16x32_bf16 v[20:23], v[72:75], v[100:103], v[20:23]
    ds_read_b64_tr_b16 v[122:123], v159 offset:9216
    v_mfma_f32_16x16x32_bf16 v[24:27], v[72:75], v[104:107], v[24:27]
    ds_read_b64_tr_b16 v[124:125], v160 offset:8192
    v_mfma_f32_16x16x32_bf16 v[28:31], v[72:75], v[108:111], v[28:31]
    ds_read_b64_tr_b16 v[126:127], v160 offset:9216
    v_mfma_f32_16x16x32_bf16 v[32:35], v[72:75], v[112:115], v[32:35]
    ds_read_b64_tr_b16 v[128:129], v161 offset:8192
    s_waitcnt lgkmcnt(9)
    v_mfma_f32_16x16x32_bf16 v[36:39], v[76:79], v[100:103], v[36:39]
    ds_read_b64_tr_b16 v[130:131], v161 offset:9216
    v_mfma_f32_16x16x32_bf16 v[40:43], v[76:79], v[104:107], v[40:43]
    ds_read_b128 v[88:91], v157 offset:2048
    v_mfma_f32_16x16x32_bf16 v[44:47], v[76:79], v[108:111], v[44:47]
    ds_read_b128 v[92:95], v157 offset:4096
    v_mfma_f32_16x16x32_bf16 v[48:51], v[76:79], v[112:115], v[48:51]
    ds_read_b128 v[96:99], v157 offset:6144
    s_waitcnt lgkmcnt(12)
    v_mfma_f32_16x16x32_bf16 v[52:55], v[80:83], v[100:103], v[52:55]
    v_mfma_f32_16x16x32_bf16 v[56:59], v[80:83], v[104:107], v[56:59]
    v_mfma_f32_16x16x32_bf16 v[60:63], v[80:83], v[108:111], v[60:63]
    v_mfma_f32_16x16x32_bf16 v[64:67], v[80:83], v[112:115], v[64:67]
    s_add_u32 s58, s58, 1
    s_cmp_lt_u32 s58, 3
    s_cbranch_scc1 L_loop_V
    s_waitcnt lgkmcnt(9)
    v_mfma_f32_16x16x32_bf16 v[4:7], v[84:87], v[116:119], v[4:7]
    s_waitcnt lgkmcnt(7)
    v_mfma_f32_16x16x32_bf16 v[8:11], v[84:87], v[120:123], v[8:11]
    s_waitcnt lgkmcnt(5)
    v_mfma_f32_16x16x32_bf16 v[12:15], v[84:87], v[124:127], v[12:15]
    s_waitcnt lgkmcnt(3)
    v_mfma_f32_16x16x32_bf16 v[16:19], v[84:87], v[128:131], v[16:19]
    s_waitcnt lgkmcnt(0)
    s_barrier
    ds_read_b64_tr_b16 v[100:101], v158 offset:16384
    v_mfma_f32_16x16x32_bf16 v[20:23], v[88:91], v[116:119], v[20:23]
    ds_read_b64_tr_b16 v[102:103], v158 offset:17408
    v_mfma_f32_16x16x32_bf16 v[24:27], v[88:91], v[120:123], v[24:27]
    ds_read_b128 v[68:71], v156 offset:16384
    v_mfma_f32_16x16x32_bf16 v[28:31], v[88:91], v[124:127], v[28:31]
    ds_read_b64_tr_b16 v[104:105], v159 offset:16384
    v_mfma_f32_16x16x32_bf16 v[32:35], v[88:91], v[128:131], v[32:35]
    ds_read_b64_tr_b16 v[106:107], v159 offset:17408
    v_mfma_f32_16x16x32_bf16 v[36:39], v[92:95], v[116:119], v[36:39]
    ds_read_b64_tr_b16 v[108:109], v160 offset:16384
    v_mfma_f32_16x16x32_bf16 v[40:43], v[92:95], v[120:123], v[40:43]
    ds_read_b64_tr_b16 v[110:111], v160 offset:17408
    v_mfma_f32_16x16x32_bf16 v[44:47], v[92:95], v[124:127], v[44:47]
    ds_read_b64_tr_b16 v[112:113], v161 offset:16384
    v_mfma_f32_16x16x32_bf16 v[48:51], v[92:95], v[128:131], v[48:51]
    ds_read_b64_tr_b16 v[114:115], v161 offset:17408
    v_mfma_f32_16x16x32_bf16 v[52:55], v[96:99], v[116:119], v[52:55]
    ds_read_b128 v[72:75], v156 offset:18432
    v_mfma_f32_16x16x32_bf16 v[56:59], v[96:99], v[120:123], v[56:59]
    ds_read_b128 v[76:79], v156 offset:20480
    v_mfma_f32_16x16x32_bf16 v[60:63], v[96:99], v[124:127], v[60:63]
    ds_read_b128 v[80:83], v156 offset:22528
    v_mfma_f32_16x16x32_bf16 v[64:67], v[96:99], v[128:131], v[64:67]
    s_waitcnt lgkmcnt(9)
    v_mfma_f32_16x16x32_bf16 v[4:7], v[68:71], v[100:103], v[4:7]
    ds_read_b64_tr_b16 v[116:117], v158 offset:24576
    s_waitcnt lgkmcnt(8)
    v_mfma_f32_16x16x32_bf16 v[8:11], v[68:71], v[104:107], v[8:11]
    ds_read_b64_tr_b16 v[118:119], v158 offset:25600
    s_waitcnt lgkmcnt(7)
    v_mfma_f32_16x16x32_bf16 v[12:15], v[68:71], v[108:111], v[12:15]
    ds_read_b128 v[84:87], v157 offset:16384
    s_waitcnt lgkmcnt(6)
    v_mfma_f32_16x16x32_bf16 v[16:19], v[68:71], v[112:115], v[16:19]
    ds_read_b64_tr_b16 v[120:121], v159 offset:24576
    s_waitcnt lgkmcnt(6)
    v_mfma_f32_16x16x32_bf16 v[20:23], v[72:75], v[100:103], v[20:23]
    ds_read_b64_tr_b16 v[122:123], v159 offset:25600
    v_mfma_f32_16x16x32_bf16 v[24:27], v[72:75], v[104:107], v[24:27]
    ds_read_b64_tr_b16 v[124:125], v160 offset:24576
    v_mfma_f32_16x16x32_bf16 v[28:31], v[72:75], v[108:111], v[28:31]
    ds_read_b64_tr_b16 v[126:127], v160 offset:25600
    v_mfma_f32_16x16x32_bf16 v[32:35], v[72:75], v[112:115], v[32:35]
    ds_read_b64_tr_b16 v[128:129], v161 offset:24576
    s_waitcnt lgkmcnt(9)
    v_mfma_f32_16x16x32_bf16 v[36:39], v[76:79], v[100:103], v[36:39]
    ds_read_b64_tr_b16 v[130:131], v161 offset:25600
    v_mfma_f32_16x16x32_bf16 v[40:43], v[76:79], v[104:107], v[40:43]
    ds_read_b128 v[88:91], v157 offset:18432
    v_mfma_f32_16x16x32_bf16 v[44:47], v[76:79], v[108:111], v[44:47]
    ds_read_b128 v[92:95], v157 offset:20480
    v_mfma_f32_16x16x32_bf16 v[48:51], v[76:79], v[112:115], v[48:51]
    ds_read_b128 v[96:99], v157 offset:22528
    s_waitcnt lgkmcnt(12)
    v_mfma_f32_16x16x32_bf16 v[52:55], v[80:83], v[100:103], v[52:55]
    v_mfma_f32_16x16x32_bf16 v[56:59], v[80:83], v[104:107], v[56:59]
    v_mfma_f32_16x16x32_bf16 v[60:63], v[80:83], v[108:111], v[60:63]
    v_mfma_f32_16x16x32_bf16 v[64:67], v[80:83], v[112:115], v[64:67]
    s_waitcnt lgkmcnt(9)
    v_mfma_f32_16x16x32_bf16 v[4:7], v[84:87], v[116:119], v[4:7]
    s_waitcnt lgkmcnt(7)
    v_mfma_f32_16x16x32_bf16 v[8:11], v[84:87], v[120:123], v[8:11]
    s_waitcnt lgkmcnt(5)
    v_mfma_f32_16x16x32_bf16 v[12:15], v[84:87], v[124:127], v[12:15]
    s_waitcnt lgkmcnt(3)
    v_mfma_f32_16x16x32_bf16 v[16:19], v[84:87], v[128:131], v[16:19]
    s_waitcnt lgkmcnt(0)
    s_waitcnt vmcnt(0)
    s_barrier
    ds_read_b64_tr_b16 v[100:101], v158 offset:32768
    v_mfma_f32_16x16x32_bf16 v[20:23], v[88:91], v[116:119], v[20:23]
    ds_read_b64_tr_b16 v[102:103], v158 offset:33792
    v_mfma_f32_16x16x32_bf16 v[24:27], v[88:91], v[120:123], v[24:27]
    ds_read_b128 v[68:71], v156 offset:32768
    v_mfma_f32_16x16x32_bf16 v[28:31], v[88:91], v[124:127], v[28:31]
    ds_read_b64_tr_b16 v[104:105], v159 offset:32768
    v_mfma_f32_16x16x32_bf16 v[32:35], v[88:91], v[128:131], v[32:35]
    ds_read_b64_tr_b16 v[106:107], v159 offset:33792
    v_mfma_f32_16x16x32_bf16 v[36:39], v[92:95], v[116:119], v[36:39]
    ds_read_b64_tr_b16 v[108:109], v160 offset:32768
    v_mfma_f32_16x16x32_bf16 v[40:43], v[92:95], v[120:123], v[40:43]
    ds_read_b64_tr_b16 v[110:111], v160 offset:33792
    v_mfma_f32_16x16x32_bf16 v[44:47], v[92:95], v[124:127], v[44:47]
    ds_read_b64_tr_b16 v[112:113], v161 offset:32768
    v_mfma_f32_16x16x32_bf16 v[48:51], v[92:95], v[128:131], v[48:51]
    ds_read_b64_tr_b16 v[114:115], v161 offset:33792
    v_mfma_f32_16x16x32_bf16 v[52:55], v[96:99], v[116:119], v[52:55]
    ds_read_b128 v[72:75], v156 offset:34816
    v_mfma_f32_16x16x32_bf16 v[56:59], v[96:99], v[120:123], v[56:59]
    ds_read_b128 v[76:79], v156 offset:36864
    v_mfma_f32_16x16x32_bf16 v[60:63], v[96:99], v[124:127], v[60:63]
    ds_read_b128 v[80:83], v156 offset:38912
    v_mfma_f32_16x16x32_bf16 v[64:67], v[96:99], v[128:131], v[64:67]
    s_waitcnt lgkmcnt(9)
    v_mfma_f32_16x16x32_bf16 v[4:7], v[68:71], v[100:103], v[4:7]
    ds_read_b64_tr_b16 v[116:117], v158 offset:40960
    s_waitcnt lgkmcnt(8)
    v_mfma_f32_16x16x32_bf16 v[8:11], v[68:71], v[104:107], v[8:11]
    ds_read_b64_tr_b16 v[118:119], v158 offset:41984
    s_waitcnt lgkmcnt(7)
    v_mfma_f32_16x16x32_bf16 v[12:15], v[68:71], v[108:111], v[12:15]
    ds_read_b128 v[84:87], v157 offset:32768
    s_waitcnt lgkmcnt(6)
    v_mfma_f32_16x16x32_bf16 v[16:19], v[68:71], v[112:115], v[16:19]
    ds_read_b64_tr_b16 v[120:121], v159 offset:40960
    s_waitcnt lgkmcnt(6)
    v_mfma_f32_16x16x32_bf16 v[20:23], v[72:75], v[100:103], v[20:23]
    ds_read_b64_tr_b16 v[122:123], v159 offset:41984
    v_mfma_f32_16x16x32_bf16 v[24:27], v[72:75], v[104:107], v[24:27]
    ds_read_b64_tr_b16 v[124:125], v160 offset:40960
    v_mfma_f32_16x16x32_bf16 v[28:31], v[72:75], v[108:111], v[28:31]
    ds_read_b64_tr_b16 v[126:127], v160 offset:41984
    v_mfma_f32_16x16x32_bf16 v[32:35], v[72:75], v[112:115], v[32:35]
    ds_read_b64_tr_b16 v[128:129], v161 offset:40960
    s_waitcnt lgkmcnt(9)
    v_mfma_f32_16x16x32_bf16 v[36:39], v[76:79], v[100:103], v[36:39]
    ds_read_b64_tr_b16 v[130:131], v161 offset:41984
    v_mfma_f32_16x16x32_bf16 v[40:43], v[76:79], v[104:107], v[40:43]
    ds_read_b128 v[88:91], v157 offset:34816
    v_mfma_f32_16x16x32_bf16 v[44:47], v[76:79], v[108:111], v[44:47]
    ds_read_b128 v[92:95], v157 offset:36864
    v_mfma_f32_16x16x32_bf16 v[48:51], v[76:79], v[112:115], v[48:51]
    ds_read_b128 v[96:99], v157 offset:38912
    s_waitcnt lgkmcnt(12)
    v_mfma_f32_16x16x32_bf16 v[52:55], v[80:83], v[100:103], v[52:55]
    v_mfma_f32_16x16x32_bf16 v[56:59], v[80:83], v[104:107], v[56:59]
    v_mfma_f32_16x16x32_bf16 v[60:63], v[80:83], v[108:111], v[60:63]
    v_mfma_f32_16x16x32_bf16 v[64:67], v[80:83], v[112:115], v[64:67]
    s_waitcnt lgkmcnt(9)
    v_mfma_f32_16x16x32_bf16 v[4:7], v[84:87], v[116:119], v[4:7]
    s_waitcnt lgkmcnt(7)
    v_mfma_f32_16x16x32_bf16 v[8:11], v[84:87], v[120:123], v[8:11]
    s_waitcnt lgkmcnt(5)
    v_mfma_f32_16x16x32_bf16 v[12:15], v[84:87], v[124:127], v[12:15]
    s_waitcnt lgkmcnt(3)
    v_mfma_f32_16x16x32_bf16 v[16:19], v[84:87], v[128:131], v[16:19]
    s_waitcnt lgkmcnt(0)
    s_barrier
    ds_read_b64_tr_b16 v[100:101], v158 offset:49152
    v_mfma_f32_16x16x32_bf16 v[20:23], v[88:91], v[116:119], v[20:23]
    ds_read_b64_tr_b16 v[102:103], v158 offset:50176
    v_mfma_f32_16x16x32_bf16 v[24:27], v[88:91], v[120:123], v[24:27]
    ds_read_b128 v[68:71], v156 offset:49152
    v_mfma_f32_16x16x32_bf16 v[28:31], v[88:91], v[124:127], v[28:31]
    ds_read_b64_tr_b16 v[104:105], v159 offset:49152
    v_mfma_f32_16x16x32_bf16 v[32:35], v[88:91], v[128:131], v[32:35]
    ds_read_b64_tr_b16 v[106:107], v159 offset:50176
    v_mfma_f32_16x16x32_bf16 v[36:39], v[92:95], v[116:119], v[36:39]
    ds_read_b64_tr_b16 v[108:109], v160 offset:49152
    v_mfma_f32_16x16x32_bf16 v[40:43], v[92:95], v[120:123], v[40:43]
    ds_read_b64_tr_b16 v[110:111], v160 offset:50176
    v_mfma_f32_16x16x32_bf16 v[44:47], v[92:95], v[124:127], v[44:47]
    ds_read_b64_tr_b16 v[112:113], v161 offset:49152
    v_mfma_f32_16x16x32_bf16 v[48:51], v[92:95], v[128:131], v[48:51]
    ds_read_b64_tr_b16 v[114:115], v161 offset:50176
    v_mfma_f32_16x16x32_bf16 v[52:55], v[96:99], v[116:119], v[52:55]
    ds_read_b128 v[72:75], v156 offset:51200
    v_mfma_f32_16x16x32_bf16 v[56:59], v[96:99], v[120:123], v[56:59]
    ds_read_b128 v[76:79], v156 offset:53248
    v_mfma_f32_16x16x32_bf16 v[60:63], v[96:99], v[124:127], v[60:63]
    ds_read_b128 v[80:83], v156 offset:55296
    v_mfma_f32_16x16x32_bf16 v[64:67], v[96:99], v[128:131], v[64:67]
    s_waitcnt lgkmcnt(9)
    v_mfma_f32_16x16x32_bf16 v[4:7], v[68:71], v[100:103], v[4:7]
    ds_read_b64_tr_b16 v[116:117], v158 offset:57344
    s_waitcnt lgkmcnt(8)
    v_mfma_f32_16x16x32_bf16 v[8:11], v[68:71], v[104:107], v[8:11]
    ds_read_b64_tr_b16 v[118:119], v158 offset:58368
    s_waitcnt lgkmcnt(7)
    v_mfma_f32_16x16x32_bf16 v[12:15], v[68:71], v[108:111], v[12:15]
    ds_read_b128 v[84:87], v157 offset:49152
    s_waitcnt lgkmcnt(6)
    v_mfma_f32_16x16x32_bf16 v[16:19], v[68:71], v[112:115], v[16:19]
    ds_read_b64_tr_b16 v[120:121], v159 offset:57344
    s_waitcnt lgkmcnt(6)
    v_mfma_f32_16x16x32_bf16 v[20:23], v[72:75], v[100:103], v[20:23]
    ds_read_b64_tr_b16 v[122:123], v159 offset:58368
    v_mfma_f32_16x16x32_bf16 v[24:27], v[72:75], v[104:107], v[24:27]
    ds_read_b64_tr_b16 v[124:125], v160 offset:57344
    v_mfma_f32_16x16x32_bf16 v[28:31], v[72:75], v[108:111], v[28:31]
    ds_read_b64_tr_b16 v[126:127], v160 offset:58368
    v_mfma_f32_16x16x32_bf16 v[32:35], v[72:75], v[112:115], v[32:35]
    ds_read_b64_tr_b16 v[128:129], v161 offset:57344
    s_waitcnt lgkmcnt(9)
    v_mfma_f32_16x16x32_bf16 v[36:39], v[76:79], v[100:103], v[36:39]
    ds_read_b64_tr_b16 v[130:131], v161 offset:58368
    v_mfma_f32_16x16x32_bf16 v[40:43], v[76:79], v[104:107], v[40:43]
    ds_read_b128 v[88:91], v157 offset:51200
    v_mfma_f32_16x16x32_bf16 v[44:47], v[76:79], v[108:111], v[44:47]
    ds_read_b128 v[92:95], v157 offset:53248
    v_mfma_f32_16x16x32_bf16 v[48:51], v[76:79], v[112:115], v[48:51]
    ds_read_b128 v[96:99], v157 offset:55296
    s_waitcnt lgkmcnt(12)
    v_mfma_f32_16x16x32_bf16 v[52:55], v[80:83], v[100:103], v[52:55]
    v_mfma_f32_16x16x32_bf16 v[56:59], v[80:83], v[104:107], v[56:59]
    v_mfma_f32_16x16x32_bf16 v[60:63], v[80:83], v[108:111], v[60:63]
    v_mfma_f32_16x16x32_bf16 v[64:67], v[80:83], v[112:115], v[64:67]
    s_waitcnt lgkmcnt(9)
    v_mfma_f32_16x16x32_bf16 v[4:7], v[84:87], v[116:119], v[4:7]
    s_waitcnt lgkmcnt(7)
    v_mfma_f32_16x16x32_bf16 v[8:11], v[84:87], v[120:123], v[8:11]
    s_waitcnt lgkmcnt(5)
    v_mfma_f32_16x16x32_bf16 v[12:15], v[84:87], v[124:127], v[12:15]
    s_waitcnt lgkmcnt(3)
    v_mfma_f32_16x16x32_bf16 v[16:19], v[84:87], v[128:131], v[16:19]
    s_waitcnt lgkmcnt(0)
    s_barrier
    ds_read_b64_tr_b16 v[100:101], v158 offset:0
    v_mfma_f32_16x16x32_bf16 v[20:23], v[88:91], v[116:119], v[20:23]
    ds_read_b64_tr_b16 v[102:103], v158 offset:1024
    v_mfma_f32_16x16x32_bf16 v[24:27], v[88:91], v[120:123], v[24:27]
    ds_read_b128 v[68:71], v156 offset:0
    v_mfma_f32_16x16x32_bf16 v[28:31], v[88:91], v[124:127], v[28:31]
    ds_read_b64_tr_b16 v[104:105], v159 offset:0
    v_mfma_f32_16x16x32_bf16 v[32:35], v[88:91], v[128:131], v[32:35]
    ds_read_b64_tr_b16 v[106:107], v159 offset:1024
    v_mfma_f32_16x16x32_bf16 v[36:39], v[92:95], v[116:119], v[36:39]
    ds_read_b64_tr_b16 v[108:109], v160 offset:0
    v_cvt_pk_bf16_f32 v148, v4, v5
    v_cvt_pk_bf16_f32 v149, v6, v7
    v_cvt_pk_bf16_f32 v150, v8, v9
    v_cvt_pk_bf16_f32 v151, v10, v11
    v_mfma_f32_16x16x32_bf16 v[40:43], v[92:95], v[120:123], v[40:43]
    ds_read_b64_tr_b16 v[110:111], v160 offset:1024
    s_nop 1
    v_permlane32_swap_b32 v148, v150
    v_permlane32_swap_b32 v149, v151
    buffer_store_dwordx4 v[148:151], v163, s[20:23], s40 offen sc1
    v_mfma_f32_16x16x32_bf16 v[44:47], v[92:95], v[124:127], v[44:47]
    ds_read_b64_tr_b16 v[112:113], v161 offset:0
    v_cvt_pk_bf16_f32 v152, v12, v13
    v_cvt_pk_bf16_f32 v153, v14, v15
    v_cvt_pk_bf16_f32 v154, v16, v17
    v_cvt_pk_bf16_f32 v155, v18, v19
    v_mfma_f32_16x16x32_bf16 v[48:51], v[92:95], v[128:131], v[48:51]
    ds_read_b64_tr_b16 v[114:115], v161 offset:1024
    s_nop 1
    v_permlane32_swap_b32 v152, v154
    v_permlane32_swap_b32 v153, v155
    buffer_store_dwordx4 v[152:155], v165, s[20:23], s40 offen sc1
    v_mfma_f32_16x16x32_bf16 v[52:55], v[96:99], v[116:119], v[52:55]
    ds_read_b128 v[72:75], v156 offset:2048
    v_cvt_pk_bf16_f32 v148, v20, v21
    v_cvt_pk_bf16_f32 v149, v22, v23
    v_cvt_pk_bf16_f32 v150, v24, v25
    v_cvt_pk_bf16_f32 v151, v26, v27
    v_mfma_f32_16x16x32_bf16 v[56:59], v[96:99], v[120:123], v[56:59]
    ds_read_b128 v[76:79], v156 offset:4096
    s_nop 1
    v_permlane32_swap_b32 v148, v150
    v_permlane32_swap_b32 v149, v151
    buffer_store_dwordx4 v[148:151], v164, s[20:23], s40 offen sc1
    v_mfma_f32_16x16x32_bf16 v[60:63], v[96:99], v[124:127], v[60:63]
    ds_read_b128 v[80:83], v156 offset:6144
    v_cvt_pk_bf16_f32 v152, v28, v29
    v_cvt_pk_bf16_f32 v153, v30, v31
    v_cvt_pk_bf16_f32 v154, v32, v33
    v_cvt_pk_bf16_f32 v155, v34, v35
    v_mfma_f32_16x16x32_bf16 v[64:67], v[96:99], v[128:131], v[64:67]
    s_nop 1
    v_permlane32_swap_b32 v152, v154
    v_permlane32_swap_b32 v153, v155
    buffer_store_dwordx4 v[152:155], v166, s[20:23], s40 offen sc1
    v_cvt_pk_bf16_f32 v148, v36, v37
    v_cvt_pk_bf16_f32 v149, v38, v39
    v_cvt_pk_bf16_f32 v150, v40, v41
    v_cvt_pk_bf16_f32 v151, v42, v43
    s_nop 1
    v_permlane32_swap_b32 v148, v150
    v_permlane32_swap_b32 v149, v151
    buffer_store_dwordx4 v[148:151], v163, s[20:23], s41 offen sc1
    v_cvt_pk_bf16_f32 v152, v44, v45
    v_cvt_pk_bf16_f32 v153, v46, v47
    v_cvt_pk_bf16_f32 v154, v48, v49
    v_cvt_pk_bf16_f32 v155, v50, v51
    s_nop 1
    v_permlane32_swap_b32 v152, v154
    v_permlane32_swap_b32 v153, v155
    buffer_store_dwordx4 v[152:155], v165, s[20:23], s41 offen sc1
    s_nop 3
    v_cvt_pk_bf16_f32 v148, v52, v53
    v_cvt_pk_bf16_f32 v149, v54, v55
    v_cvt_pk_bf16_f32 v150, v56, v57
    v_cvt_pk_bf16_f32 v151, v58, v59
    s_nop 1
    v_permlane32_swap_b32 v148, v150
    v_permlane32_swap_b32 v149, v151
    buffer_store_dwordx4 v[148:151], v164, s[20:23], s41 offen sc1
    v_cvt_pk_bf16_f32 v152, v60, v61
    v_cvt_pk_bf16_f32 v153, v62, v63
    v_cvt_pk_bf16_f32 v154, v64, v65
    v_cvt_pk_bf16_f32 v155, v66, v67
    s_nop 1
    v_permlane32_swap_b32 v152, v154
    v_permlane32_swap_b32 v153, v155
    buffer_store_dwordx4 v[152:155], v166, s[20:23], s41 offen sc1
    s_cmp_eq_u32 s33, 1
    s_cbranch_scc1 L_att
    s_mov_b32 s33, 1
    s_cmp_lt_u32 s35, 2
    s_mov_b32 s26, 6291456
    s_cselect_b32 s26, s26, 2097152
    s_add_u32 s20, s20, s26
    s_addc_u32 s21, s21, 0
    s_branch L_g1_V_go
L_g1_A:
    s_cmp_eq_u32 s38, 0
    s_cbranch_scc0 L_g1_AV
L_g1_AK:
    s_lshr_b32 s29, s35, 1
    s_lshl_b32 s29, s29, 3
    s_and_b32 s27, s35, 1
    s_lshl_b32 s27, s27, 1
    s_add_u32 s29, s29, s27
    s_lshl_b32 s27, s57, 2
    s_add_u32 s27, s27, s29
    s_mul_i32 s26, s27, 131072
    s_lshl_b32 s27, s34, 2
    s_lshl_b32 s28, s56, 1
    s_add_u32 s27, s27, s28
    s_mul_i32 s27, s27, 2048
    s_add_u32 s26, s26, s27
    s_add_u32 s26, s26, 0
    s_add_u32 s20, s4, s26
    s_addc_u32 s21, s5, 0
    s_and_b32 s21, s21, 0xffff
    s_mov_b32 s22, 1048576
    s_mov_b32 s23, 0x20000
    s_add_u32 s27, s37, 0
    s_and_b32 s27, s27, 1
    s_mul_i32 s40, s27, 2048
    s_add_u32 s27, s37, 1
    s_and_b32 s27, s27, 1
    s_mul_i32 s41, s27, 2048
    v_and_b32 v68, 15, v2
    v_lshrrev_b32 v69, 4, v2
    v_and_b32 v71, 1, v69
    v_lshlrev_b32 v71, 9, v71
    v_lshlrev_b32 v72, 4, v68
    v_add_u32 v71, v71, v72
    v_lshrrev_b32 v70, 1, v69
    v_lshlrev_b32 v70, 10, v70
    v_add_u32 v74, v70, v71
    v_add_u32 v163, 0, v74
    v_add_u32 v164, 256, v74
    v_add_u32 v165, 131072, v74
    v_add_u32 v166, 131328, v74
    s_lshl_b32 s26, s34, 2
    s_lshl_b32 s27, s56, 1
    s_add_u32 s26, s26, s27
    s_add_u32 s26, s26, s37
    s_lshl_b32 s26, s26, 12
    s_add_u32 s26, s26, 16777216
    s_add_u32 s12, s4, s26
    s_addc_u32 s13, s5, 0
    s_and_b32 s13, s13, 0xffff
    s_mov_b32 s14, 4096
    s_mov_b32 s15, 0x20000
    v_and_b32 v68, 15, v2
    v_lshrrev_b32 v69, 4, v2
    v_and_b32 v71, 1, v69
    v_lshlrev_b32 v71, 9, v71
    v_lshlrev_b32 v72, 4, v68
    v_add_u32 v71, v71, v72
    v_lshrrev_b32 v70, 1, v69
    v_lshlrev_b32 v70, 10, v70
    v_add_u32 v0, v70, v71
    s_lshl_b32 s27, s57, 3
    v_add_u32 v0, s27, v0
    s_barrier
    ds_read_b64_tr_b16 v[100:101], v158 offset:0
    ds_read_b64_tr_b16 v[102:103], v158 offset:1024
    ds_read_b128 v[68:71], v156 offset:0
    ds_read_b64_tr_b16 v[104:105], v159 offset:0
    ds_read_b64_tr_b16 v[106:107], v159 offset:1024
    ds_read_b64_tr_b16 v[108:109], v160 offset:0
    ds_read_b64_tr_b16 v[110:111], v160 offset:1024
    ds_read_b64_tr_b16 v[112:113], v161 offset:0
    ds_read_b64_tr_b16 v[114:115], v161 offset:1024
    ds_read_b128 v[72:75], v156 offset:2048
    ds_read_b128 v[76:79], v156 offset:4096
    ds_read_b128 v[80:83], v156 offset:6144
    ds_read_b64_tr_b16 v[132:133], v162 offset:0
    ds_read_b64_tr_b16 v[134:135], v162 offset:256
    s_waitcnt lgkmcnt(11)
    v_mfma_f32_16x16x32_bf16 v[4:7], v[100:103], v[68:71], 0
    ds_read_b64_tr_b16 v[116:117], v158 offset:8192
    s_waitcnt lgkmcnt(10)
    v_mfma_f32_16x16x32_bf16 v[8:11], v[104:107], v[68:71], 0
    ds_read_b64_tr_b16 v[118:119], v158 offset:9216
    s_waitcnt lgkmcnt(9)
    v_mfma_f32_16x16x32_bf16 v[12:15], v[108:111], v[68:71], 0
    ds_read_b128 v[84:87], v157 offset:0
    s_waitcnt lgkmcnt(8)
    v_mfma_f32_16x16x32_bf16 v[16:19], v[112:115], v[68:71], 0
    ds_read_b64_tr_b16 v[120:121], v159 offset:8192
    s_waitcnt lgkmcnt(4)
    v_mfma_f32_16x16x32_bf16 v[140:143], v[132:135], v[68:71], 0
    v_mfma_f32_16x16x32_bf16 v[20:23], v[100:103], v[72:75], 0
    ds_read_b64_tr_b16 v[122:123], v159 offset:9216
    v_mfma_f32_16x16x32_bf16 v[24:27], v[104:107], v[72:75], 0
    ds_read_b64_tr_b16 v[124:125], v160 offset:8192
    v_mfma_f32_16x16x32_bf16 v[28:31], v[108:111], v[72:75], 0
    ds_read_b64_tr_b16 v[126:127], v160 offset:9216
    v_mfma_f32_16x16x32_bf16 v[32:35], v[112:115], v[72:75], 0
    ds_read_b64_tr_b16 v[128:129], v161 offset:8192
    v_mfma_f32_16x16x32_bf16 v[144:147], v[132:135], v[72:75], 0
    v_mfma_f32_16x16x32_bf16 v[36:39], v[100:103], v[76:79], 0
    ds_read_b64_tr_b16 v[130:131], v161 offset:9216
    v_mfma_f32_16x16x32_bf16 v[40:43], v[104:107], v[76:79], 0
    ds_read_b128 v[88:91], v157 offset:2048
    v_mfma_f32_16x16x32_bf16 v[44:47], v[108:111], v[76:79], 0
    ds_read_b128 v[92:95], v157 offset:4096
    v_mfma_f32_16x16x32_bf16 v[48:51], v[112:115], v[76:79], 0
    ds_read_b128 v[96:99], v157 offset:6144
    v_mfma_f32_16x16x32_bf16 v[52:55], v[100:103], v[80:83], 0
    ds_read_b64_tr_b16 v[136:137], v162 offset:2048
    v_mfma_f32_16x16x32_bf16 v[56:59], v[104:107], v[80:83], 0
    ds_read_b64_tr_b16 v[138:139], v162 offset:2304
    v_mfma_f32_16x16x32_bf16 v[60:63], v[108:111], v[80:83], 0
    v_mfma_f32_16x16x32_bf16 v[64:67], v[112:115], v[80:83], 0
    s_mov_b32 s58, 0
.p2align 6
L_loop_AK:
    s_waitcnt lgkmcnt(11)
    v_mfma_f32_16x16x32_bf16 v[4:7], v[116:119], v[84:87], v[4:7]
    s_waitcnt lgkmcnt(9)
    v_mfma_f32_16x16x32_bf16 v[8:11], v[120:123], v[84:87], v[8:11]
    s_waitcnt lgkmcnt(7)
    v_mfma_f32_16x16x32_bf16 v[12:15], v[124:127], v[84:87], v[12:15]
    s_waitcnt lgkmcnt(5)
    v_mfma_f32_16x16x32_bf16 v[16:19], v[128:131], v[84:87], v[16:19]
    s_waitcnt lgkmcnt(0)
    s_barrier
    ds_read_b64_tr_b16 v[100:101], v158 offset:16384
    ds_read_b64_tr_b16 v[102:103], v158 offset:17408
    v_mfma_f32_16x16x32_bf16 v[140:143], v[136:139], v[84:87], v[140:143]
    v_mfma_f32_16x16x32_bf16 v[20:23], v[116:119], v[88:91], v[20:23]
    ds_read_b128 v[68:71], v156 offset:16384
    v_mfma_f32_16x16x32_bf16 v[24:27], v[120:123], v[88:91], v[24:27]
    ds_read_b64_tr_b16 v[104:105], v159 offset:16384
    v_mfma_f32_16x16x32_bf16 v[28:31], v[124:127], v[88:91], v[28:31]
    ds_read_b64_tr_b16 v[106:107], v159 offset:17408
    v_mfma_f32_16x16x32_bf16 v[32:35], v[128:131], v[88:91], v[32:35]
    ds_read_b64_tr_b16 v[108:109], v160 offset:16384
    v_mfma_f32_16x16x32_bf16 v[144:147], v[136:139], v[88:91], v[144:147]
    v_mfma_f32_16x16x32_bf16 v[36:39], v[116:119], v[92:95], v[36:39]
    ds_read_b64_tr_b16 v[110:111], v160 offset:17408
    v_mfma_f32_16x16x32_bf16 v[40:43], v[120:123], v[92:95], v[40:43]
    ds_read_b64_tr_b16 v[112:113], v161 offset:16384
    v_mfma_f32_16x16x32_bf16 v[44:47], v[124:127], v[92:95], v[44:47]
    ds_read_b64_tr_b16 v[114:115], v161 offset:17408
    v_mfma_f32_16x16x32_bf16 v[48:51], v[128:131], v[92:95], v[48:51]
    ds_read_b128 v[72:75], v156 offset:18432
    v_mfma_f32_16x16x32_bf16 v[52:55], v[116:119], v[96:99], v[52:55]
    ds_read_b128 v[76:79], v156 offset:20480
    v_mfma_f32_16x16x32_bf16 v[56:59], v[120:123], v[96:99], v[56:59]
    ds_read_b128 v[80:83], v156 offset:22528
    v_mfma_f32_16x16x32_bf16 v[60:63], v[124:127], v[96:99], v[60:63]
    ds_read_b64_tr_b16 v[132:133], v162 offset:4096
    v_mfma_f32_16x16x32_bf16 v[64:67], v[128:131], v[96:99], v[64:67]
    ds_read_b64_tr_b16 v[134:135], v162 offset:4352
    s_waitcnt lgkmcnt(11)
    v_mfma_f32_16x16x32_bf16 v[4:7], v[100:103], v[68:71], v[4:7]
    ds_read_b64_tr_b16 v[116:117], v158 offset:24576
    s_waitcnt lgkmcnt(10)
    v_mfma_f32_16x16x32_bf16 v[8:11], v[104:107], v[68:71], v[8:11]
    ds_read_b64_tr_b16 v[118:119], v158 offset:25600
    s_waitcnt lgkmcnt(9)
    v_mfma_f32_16x16x32_bf16 v[12:15], v[108:111], v[68:71], v[12:15]
    ds_read_b128 v[84:87], v157 offset:16384
    s_waitcnt lgkmcnt(8)
    v_mfma_f32_16x16x32_bf16 v[16:19], v[112:115], v[68:71], v[16:19]
    ds_read_b64_tr_b16 v[120:121], v159 offset:24576
    s_waitcnt lgkmcnt(4)
    v_mfma_f32_16x16x32_bf16 v[140:143], v[132:135], v[68:71], v[140:143]
    v_mfma_f32_16x16x32_bf16 v[20:23], v[100:103], v[72:75], v[20:23]
    ds_read_b64_tr_b16 v[122:123], v159 offset:25600
    v_mfma_f32_16x16x32_bf16 v[24:27], v[104:107], v[72:75], v[24:27]
    ds_read_b64_tr_b16 v[124:125], v160 offset:24576
    v_mfma_f32_16x16x32_bf16 v[28:31], v[108:111], v[72:75], v[28:31]
    ds_read_b64_tr_b16 v[126:127], v160 offset:25600
    v_mfma_f32_16x16x32_bf16 v[32:35], v[112:115], v[72:75], v[32:35]
    ds_read_b64_tr_b16 v[128:129], v161 offset:24576
    v_mfma_f32_16x16x32_bf16 v[144:147], v[132:135], v[72:75], v[144:147]
    v_mfma_f32_16x16x32_bf16 v[36:39], v[100:103], v[76:79], v[36:39]
    ds_read_b64_tr_b16 v[130:131], v161 offset:25600
    v_mfma_f32_16x16x32_bf16 v[40:43], v[104:107], v[76:79], v[40:43]
    ds_read_b128 v[88:91], v157 offset:18432
    v_mfma_f32_16x16x32_bf16 v[44:47], v[108:111], v[76:79], v[44:47]
    ds_read_b128 v[92:95], v157 offset:20480
    v_mfma_f32_16x16x32_bf16 v[48:51], v[112:115], v[76:79], v[48:51]
    ds_read_b128 v[96:99], v157 offset:22528
    v_mfma_f32_16x16x32_bf16 v[52:55], v[100:103], v[80:83], v[52:55]
    ds_read_b64_tr_b16 v[136:137], v162 offset:6144
    v_mfma_f32_16x16x32_bf16 v[56:59], v[104:107], v[80:83], v[56:59]
    ds_read_b64_tr_b16 v[138:139], v162 offset:6400
    v_mfma_f32_16x16x32_bf16 v[60:63], v[108:111], v[80:83], v[60:63]
    v_mfma_f32_16x16x32_bf16 v[64:67], v[112:115], v[80:83], v[64:67]
    s_waitcnt lgkmcnt(11)
    v_mfma_f32_16x16x32_bf16 v[4:7], v[116:119], v[84:87], v[4:7]
    s_waitcnt lgkmcnt(9)
    v_mfma_f32_16x16x32_bf16 v[8:11], v[120:123], v[84:87], v[8:11]
    s_waitcnt lgkmcnt(7)
    v_mfma_f32_16x16x32_bf16 v[12:15], v[124:127], v[84:87], v[12:15]
    s_waitcnt lgkmcnt(5)
    v_mfma_f32_16x16x32_bf16 v[16:19], v[128:131], v[84:87], v[16:19]
    s_waitcnt lgkmcnt(0)
    s_waitcnt vmcnt(0)
    s_barrier
    ds_read_b64_tr_b16 v[100:101], v158 offset:32768
    ds_read_b64_tr_b16 v[102:103], v158 offset:33792
    v_mfma_f32_16x16x32_bf16 v[140:143], v[136:139], v[84:87], v[140:143]
    v_mfma_f32_16x16x32_bf16 v[20:23], v[116:119], v[88:91], v[20:23]
    ds_read_b128 v[68:71], v156 offset:32768
    v_mfma_f32_16x16x32_bf16 v[24:27], v[120:123], v[88:91], v[24:27]
    ds_read_b64_tr_b16 v[104:105], v159 offset:32768
    v_mfma_f32_16x16x32_bf16 v[28:31], v[124:127], v[88:91], v[28:31]
    ds_read_b64_tr_b16 v[106:107], v159 offset:33792
    v_mfma_f32_16x16x32_bf16 v[32:35], v[128:131], v[88:91], v[32:35]
    ds_read_b64_tr_b16 v[108:109], v160 offset:32768
    v_mfma_f32_16x16x32_bf16 v[144:147], v[136:139], v[88:91], v[144:147]
    v_mfma_f32_16x16x32_bf16 v[36:39], v[116:119], v[92:95], v[36:39]
    ds_read_b64_tr_b16 v[110:111], v160 offset:33792
    v_mfma_f32_16x16x32_bf16 v[40:43], v[120:123], v[92:95], v[40:43]
    ds_read_b64_tr_b16 v[112:113], v161 offset:32768
    v_mfma_f32_16x16x32_bf16 v[44:47], v[124:127], v[92:95], v[44:47]
    ds_read_b64_tr_b16 v[114:115], v161 offset:33792
    v_mfma_f32_16x16x32_bf16 v[48:51], v[128:131], v[92:95], v[48:51]
    ds_read_b128 v[72:75], v156 offset:34816
    v_mfma_f32_16x16x32_bf16 v[52:55], v[116:119], v[96:99], v[52:55]
    ds_read_b128 v[76:79], v156 offset:36864
    v_mfma_f32_16x16x32_bf16 v[56:59], v[120:123], v[96:99], v[56:59]
    ds_read_b128 v[80:83], v156 offset:38912
    v_mfma_f32_16x16x32_bf16 v[60:63], v[124:127], v[96:99], v[60:63]
    ds_read_b64_tr_b16 v[132:133], v162 offset:8192
    v_mfma_f32_16x16x32_bf16 v[64:67], v[128:131], v[96:99], v[64:67]
    ds_read_b64_tr_b16 v[134:135], v162 offset:8448
    s_waitcnt lgkmcnt(11)
    v_mfma_f32_16x16x32_bf16 v[4:7], v[100:103], v[68:71], v[4:7]
    ds_read_b64_tr_b16 v[116:117], v158 offset:40960
    s_waitcnt lgkmcnt(10)
    v_mfma_f32_16x16x32_bf16 v[8:11], v[104:107], v[68:71], v[8:11]
    ds_read_b64_tr_b16 v[118:119], v158 offset:41984
    s_waitcnt lgkmcnt(9)
    v_mfma_f32_16x16x32_bf16 v[12:15], v[108:111], v[68:71], v[12:15]
    ds_read_b128 v[84:87], v157 offset:32768
    s_waitcnt lgkmcnt(8)
    v_mfma_f32_16x16x32_bf16 v[16:19], v[112:115], v[68:71], v[16:19]
    ds_read_b64_tr_b16 v[120:121], v159 offset:40960
    s_waitcnt lgkmcnt(4)
    v_mfma_f32_16x16x32_bf16 v[140:143], v[132:135], v[68:71], v[140:143]
    v_mfma_f32_16x16x32_bf16 v[20:23], v[100:103], v[72:75], v[20:23]
    ds_read_b64_tr_b16 v[122:123], v159 offset:41984
    v_mfma_f32_16x16x32_bf16 v[24:27], v[104:107], v[72:75], v[24:27]
    ds_read_b64_tr_b16 v[124:125], v160 offset:40960
    v_mfma_f32_16x16x32_bf16 v[28:31], v[108:111], v[72:75], v[28:31]
    ds_read_b64_tr_b16 v[126:127], v160 offset:41984
    v_mfma_f32_16x16x32_bf16 v[32:35], v[112:115], v[72:75], v[32:35]
    ds_read_b64_tr_b16 v[128:129], v161 offset:40960
    v_mfma_f32_16x16x32_bf16 v[144:147], v[132:135], v[72:75], v[144:147]
    v_mfma_f32_16x16x32_bf16 v[36:39], v[100:103], v[76:79], v[36:39]
    ds_read_b64_tr_b16 v[130:131], v161 offset:41984
    v_mfma_f32_16x16x32_bf16 v[40:43], v[104:107], v[76:79], v[40:43]
    ds_read_b128 v[88:91], v157 offset:34816
    v_mfma_f32_16x16x32_bf16 v[44:47], v[108:111], v[76:79], v[44:47]
    ds_read_b128 v[92:95], v157 offset:36864
    v_mfma_f32_16x16x32_bf16 v[48:51], v[112:115], v[76:79], v[48:51]
    ds_read_b128 v[96:99], v157 offset:38912
    v_mfma_f32_16x16x32_bf16 v[52:55], v[100:103], v[80:83], v[52:55]
    ds_read_b64_tr_b16 v[136:137], v162 offset:10240
    v_mfma_f32_16x16x32_bf16 v[56:59], v[104:107], v[80:83], v[56:59]
    ds_read_b64_tr_b16 v[138:139], v162 offset:10496
    v_mfma_f32_16x16x32_bf16 v[60:63], v[108:111], v[80:83], v[60:63]
    v_mfma_f32_16x16x32_bf16 v[64:67], v[112:115], v[80:83], v[64:67]
    s_waitcnt lgkmcnt(11)
    v_mfma_f32_16x16x32_bf16 v[4:7], v[116:119], v[84:87], v[4:7]
    s_waitcnt lgkmcnt(9)
    v_mfma_f32_16x16x32_bf16 v[8:11], v[120:123], v[84:87], v[8:11]
    s_waitcnt lgkmcnt(7)
    v_mfma_f32_16x16x32_bf16 v[12:15], v[124:127], v[84:87], v[12:15]
    s_waitcnt lgkmcnt(5)
    v_mfma_f32_16x16x32_bf16 v[16:19], v[128:131], v[84:87], v[16:19]
    s_waitcnt lgkmcnt(0)
    s_barrier
    ds_read_b64_tr_b16 v[100:101], v158 offset:49152
    ds_read_b64_tr_b16 v[102:103], v158 offset:50176
    v_mfma_f32_16x16x32_bf16 v[140:143], v[136:139], v[84:87], v[140:143]
    v_mfma_f32_16x16x32_bf16 v[20:23], v[116:119], v[88:91], v[20:23]
    ds_read_b128 v[68:71], v156 offset:49152
    v_mfma_f32_16x16x32_bf16 v[24:27], v[120:123], v[88:91], v[24:27]
    ds_read_b64_tr_b16 v[104:105], v159 offset:49152
    v_mfma_f32_16x16x32_bf16 v[28:31], v[124:127], v[88:91], v[28:31]
    ds_read_b64_tr_b16 v[106:107], v159 offset:50176
    v_mfma_f32_16x16x32_bf16 v[32:35], v[128:131], v[88:91], v[32:35]
    ds_read_b64_tr_b16 v[108:109], v160 offset:49152
    v_mfma_f32_16x16x32_bf16 v[144:147], v[136:139], v[88:91], v[144:147]
    v_mfma_f32_16x16x32_bf16 v[36:39], v[116:119], v[92:95], v[36:39]
    ds_read_b64_tr_b16 v[110:111], v160 offset:50176
    v_mfma_f32_16x16x32_bf16 v[40:43], v[120:123], v[92:95], v[40:43]
    ds_read_b64_tr_b16 v[112:113], v161 offset:49152
    v_mfma_f32_16x16x32_bf16 v[44:47], v[124:127], v[92:95], v[44:47]
    ds_read_b64_tr_b16 v[114:115], v161 offset:50176
    v_mfma_f32_16x16x32_bf16 v[48:51], v[128:131], v[92:95], v[48:51]
    ds_read_b128 v[72:75], v156 offset:51200
    v_mfma_f32_16x16x32_bf16 v[52:55], v[116:119], v[96:99], v[52:55]
    ds_read_b128 v[76:79], v156 offset:53248
    v_mfma_f32_16x16x32_bf16 v[56:59], v[120:123], v[96:99], v[56:59]
    ds_read_b128 v[80:83], v156 offset:55296
    v_mfma_f32_16x16x32_bf16 v[60:63], v[124:127], v[96:99], v[60:63]
    ds_read_b64_tr_b16 v[132:133], v162 offset:12288
    v_mfma_f32_16x16x32_bf16 v[64:67], v[128:131], v[96:99], v[64:67]
    ds_read_b64_tr_b16 v[134:135], v162 offset:12544
    s_waitcnt lgkmcnt(11)
    v_mfma_f32_16x16x32_bf16 v[4:7], v[100:103], v[68:71], v[4:7]
    ds_read_b64_tr_b16 v[116:117], v158 offset:57344
    s_waitcnt lgkmcnt(10)
    v_mfma_f32_16x16x32_bf16 v[8:11], v[104:107], v[68:71], v[8:11]
    ds_read_b64_tr_b16 v[118:119], v158 offset:58368
    s_waitcnt lgkmcnt(9)
    v_mfma_f32_16x16x32_bf16 v[12:15], v[108:111], v[68:71], v[12:15]
    ds_read_b128 v[84:87], v157 offset:49152
    s_waitcnt lgkmcnt(8)
    v_mfma_f32_16x16x32_bf16 v[16:19], v[112:115], v[68:71], v[16:19]
    ds_read_b64_tr_b16 v[120:121], v159 offset:57344
    s_waitcnt lgkmcnt(4)
    v_mfma_f32_16x16x32_bf16 v[140:143], v[132:135], v[68:71], v[140:143]
    v_mfma_f32_16x16x32_bf16 v[20:23], v[100:103], v[72:75], v[20:23]
    ds_read_b64_tr_b16 v[122:123], v159 offset:58368
    v_mfma_f32_16x16x32_bf16 v[24:27], v[104:107], v[72:75], v[24:27]
    ds_read_b64_tr_b16 v[124:125], v160 offset:57344
    v_mfma_f32_16x16x32_bf16 v[28:31], v[108:111], v[72:75], v[28:31]
    ds_read_b64_tr_b16 v[126:127], v160 offset:58368
    v_mfma_f32_16x16x32_bf16 v[32:35], v[112:115], v[72:75], v[32:35]
    ds_read_b64_tr_b16 v[128:129], v161 offset:57344
    v_mfma_f32_16x16x32_bf16 v[144:147], v[132:135], v[72:75], v[144:147]
    v_mfma_f32_16x16x32_bf16 v[36:39], v[100:103], v[76:79], v[36:39]
    ds_read_b64_tr_b16 v[130:131], v161 offset:58368
    v_mfma_f32_16x16x32_bf16 v[40:43], v[104:107], v[76:79], v[40:43]
    ds_read_b128 v[88:91], v157 offset:51200
    v_mfma_f32_16x16x32_bf16 v[44:47], v[108:111], v[76:79], v[44:47]
    ds_read_b128 v[92:95], v157 offset:53248
    v_mfma_f32_16x16x32_bf16 v[48:51], v[112:115], v[76:79], v[48:51]
    ds_read_b128 v[96:99], v157 offset:55296
    v_mfma_f32_16x16x32_bf16 v[52:55], v[100:103], v[80:83], v[52:55]
    ds_read_b64_tr_b16 v[136:137], v162 offset:14336
    v_mfma_f32_16x16x32_bf16 v[56:59], v[104:107], v[80:83], v[56:59]
    ds_read_b64_tr_b16 v[138:139], v162 offset:14592
    v_mfma_f32_16x16x32_bf16 v[60:63], v[108:111], v[80:83], v[60:63]
    v_mfma_f32_16x16x32_bf16 v[64:67], v[112:115], v[80:83], v[64:67]
    s_waitcnt lgkmcnt(11)
    v_mfma_f32_16x16x32_bf16 v[4:7], v[116:119], v[84:87], v[4:7]
    s_waitcnt lgkmcnt(9)
    v_mfma_f32_16x16x32_bf16 v[8:11], v[120:123], v[84:87], v[8:11]
    s_waitcnt lgkmcnt(7)
    v_mfma_f32_16x16x32_bf16 v[12:15], v[124:127], v[84:87], v[12:15]
    s_waitcnt lgkmcnt(5)
    v_mfma_f32_16x16x32_bf16 v[16:19], v[128:131], v[84:87], v[16:19]
    s_waitcnt lgkmcnt(0)
    s_barrier
    ds_read_b64_tr_b16 v[100:101], v158 offset:0
    ds_read_b64_tr_b16 v[102:103], v158 offset:1024
    v_mfma_f32_16x16x32_bf16 v[140:143], v[136:139], v[84:87], v[140:143]
    v_mfma_f32_16x16x32_bf16 v[20:23], v[116:119], v[88:91], v[20:23]
    ds_read_b128 v[68:71], v156 offset:0
    v_mfma_f32_16x16x32_bf16 v[24:27], v[120:123], v[88:91], v[24:27]
    ds_read_b64_tr_b16 v[104:105], v159 offset:0
    v_mfma_f32_16x16x32_bf16 v[28:31], v[124:127], v[88:91], v[28:31]
    ds_read_b64_tr_b16 v[106:107], v159 offset:1024
    v_mfma_f32_16x16x32_bf16 v[32:35], v[128:131], v[88:91], v[32:35]
    ds_read_b64_tr_b16 v[108:109], v160 offset:0
    v_mfma_f32_16x16x32_bf16 v[144:147], v[136:139], v[88:91], v[144:147]
    v_mfma_f32_16x16x32_bf16 v[36:39], v[116:119], v[92:95], v[36:39]
    ds_read_b64_tr_b16 v[110:111], v160 offset:1024
    v_mfma_f32_16x16x32_bf16 v[40:43], v[120:123], v[92:95], v[40:43]
    ds_read_b64_tr_b16 v[112:113], v161 offset:0
    v_mfma_f32_16x16x32_bf16 v[44:47], v[124:127], v[92:95], v[44:47]
    ds_read_b64_tr_b16 v[114:115], v161 offset:1024
    v_mfma_f32_16x16x32_bf16 v[48:51], v[128:131], v[92:95], v[48:51]
    ds_read_b128 v[72:75], v156 offset:2048
    v_mfma_f32_16x16x32_bf16 v[52:55], v[116:119], v[96:99], v[52:55]
    ds_read_b128 v[76:79], v156 offset:4096
    v_mfma_f32_16x16x32_bf16 v[56:59], v[120:123], v[96:99], v[56:59]
    ds_read_b128 v[80:83], v156 offset:6144
    v_mfma_f32_16x16x32_bf16 v[60:63], v[124:127], v[96:99], v[60:63]
    ds_read_b64_tr_b16 v[132:133], v162 offset:0
    v_mfma_f32_16x16x32_bf16 v[64:67], v[128:131], v[96:99], v[64:67]
    ds_read_b64_tr_b16 v[134:135], v162 offset:256
    s_waitcnt lgkmcnt(11)
    v_mfma_f32_16x16x32_bf16 v[4:7], v[100:103], v[68:71], v[4:7]
    ds_read_b64_tr_b16 v[116:117], v158 offset:8192
    s_waitcnt lgkmcnt(10)
    v_mfma_f32_16x16x32_bf16 v[8:11], v[104:107], v[68:71], v[8:11]
    ds_read_b64_tr_b16 v[118:119], v158 offset:9216
    s_waitcnt lgkmcnt(9)
    v_mfma_f32_16x16x32_bf16 v[12:15], v[108:111], v[68:71], v[12:15]
    ds_read_b128 v[84:87], v157 offset:0
    s_waitcnt lgkmcnt(8)
    v_mfma_f32_16x16x32_bf16 v[16:19], v[112:115], v[68:71], v[16:19]
    ds_read_b64_tr_b16 v[120:121], v159 offset:8192
    s_waitcnt lgkmcnt(4)
    v_mfma_f32_16x16x32_bf16 v[140:143], v[132:135], v[68:71], v[140:143]
    v_mfma_f32_16x16x32_bf16 v[20:23], v[100:103], v[72:75], v[20:23]
    ds_read_b64_tr_b16 v[122:123], v159 offset:9216
    v_mfma_f32_16x16x32_bf16 v[24:27], v[104:107], v[72:75], v[24:27]
    ds_read_b64_tr_b16 v[124:125], v160 offset:8192
    v_mfma_f32_16x16x32_bf16 v[28:31], v[108:111], v[72:75], v[28:31]
    ds_read_b64_tr_b16 v[126:127], v160 offset:9216
    v_mfma_f32_16x16x32_bf16 v[32:35], v[112:115], v[72:75], v[32:35]
    ds_read_b64_tr_b16 v[128:129], v161 offset:8192
    v_mfma_f32_16x16x32_bf16 v[144:147], v[132:135], v[72:75], v[144:147]
    v_mfma_f32_16x16x32_bf16 v[36:39], v[100:103], v[76:79], v[36:39]
    ds_read_b64_tr_b16 v[130:131], v161 offset:9216
    v_mfma_f32_16x16x32_bf16 v[40:43], v[104:107], v[76:79], v[40:43]
    ds_read_b128 v[88:91], v157 offset:2048
    v_mfma_f32_16x16x32_bf16 v[44:47], v[108:111], v[76:79], v[44:47]
    ds_read_b128 v[92:95], v157 offset:4096
    v_mfma_f32_16x16x32_bf16 v[48:51], v[112:115], v[76:79], v[48:51]
    ds_read_b128 v[96:99], v157 offset:6144
    v_mfma_f32_16x16x32_bf16 v[52:55], v[100:103], v[80:83], v[52:55]
    ds_read_b64_tr_b16 v[136:137], v162 offset:2048
    v_mfma_f32_16x16x32_bf16 v[56:59], v[104:107], v[80:83], v[56:59]
    ds_read_b64_tr_b16 v[138:139], v162 offset:2304
    v_mfma_f32_16x16x32_bf16 v[60:63], v[108:111], v[80:83], v[60:63]
    v_mfma_f32_16x16x32_bf16 v[64:67], v[112:115], v[80:83], v[64:67]
    s_add_u32 s58, s58, 1
    s_cmp_lt_u32 s58, 3
    s_cbranch_scc1 L_loop_AK
    s_waitcnt lgkmcnt(11)
    v_mfma_f32_16x16x32_bf16 v[4:7], v[116:119], v[84:87], v[4:7]
    s_waitcnt lgkmcnt(9)
    v_mfma_f32_16x16x32_bf16 v[8:11], v[120:123], v[84:87], v[8:11]
    s_waitcnt lgkmcnt(7)
    v_mfma_f32_16x16x32_bf16 v[12:15], v[124:127], v[84:87], v[12:15]
    s_waitcnt lgkmcnt(5)
    v_mfma_f32_16x16x32_bf16 v[16:19], v[128:131], v[84:87], v[16:19]
    s_waitcnt lgkmcnt(0)
    s_barrier
    ds_read_b64_tr_b16 v[100:101], v158 offset:16384
    ds_read_b64_tr_b16 v[102:103], v158 offset:17408
    v_mfma_f32_16x16x32_bf16 v[140:143], v[136:139], v[84:87], v[140:143]
    v_mfma_f32_16x16x32_bf16 v[20:23], v[116:119], v[88:91], v[20:23]
    ds_read_b128 v[68:71], v156 offset:16384
    v_mfma_f32_16x16x32_bf16 v[24:27], v[120:123], v[88:91], v[24:27]
    ds_read_b64_tr_b16 v[104:105], v159 offset:16384
    v_mfma_f32_16x16x32_bf16 v[28:31], v[124:127], v[88:91], v[28:31]
    ds_read_b64_tr_b16 v[106:107], v159 offset:17408
    v_mfma_f32_16x16x32_bf16 v[32:35], v[128:131], v[88:91], v[32:35]
    ds_read_b64_tr_b16 v[108:109], v160 offset:16384
    v_mfma_f32_16x16x32_bf16 v[144:147], v[136:139], v[88:91], v[144:147]
    v_mfma_f32_16x16x32_bf16 v[36:39], v[116:119], v[92:95], v[36:39]
    ds_read_b64_tr_b16 v[110:111], v160 offset:17408
    v_mfma_f32_16x16x32_bf16 v[40:43], v[120:123], v[92:95], v[40:43]
    ds_read_b64_tr_b16 v[112:113], v161 offset:16384
    v_mfma_f32_16x16x32_bf16 v[44:47], v[124:127], v[92:95], v[44:47]
    ds_read_b64_tr_b16 v[114:115], v161 offset:17408
    v_mfma_f32_16x16x32_bf16 v[48:51], v[128:131], v[92:95], v[48:51]
    ds_read_b128 v[72:75], v156 offset:18432
    v_mfma_f32_16x16x32_bf16 v[52:55], v[116:119], v[96:99], v[52:55]
    ds_read_b128 v[76:79], v156 offset:20480
    v_mfma_f32_16x16x32_bf16 v[56:59], v[120:123], v[96:99], v[56:59]
    ds_read_b128 v[80:83], v156 offset:22528
    v_mfma_f32_16x16x32_bf16 v[60:63], v[124:127], v[96:99], v[60:63]
    ds_read_b64_tr_b16 v[132:133], v162 offset:4096
    v_mfma_f32_16x16x32_bf16 v[64:67], v[128:131], v[96:99], v[64:67]
    ds_read_b64_tr_b16 v[134:135], v162 offset:4352
    s_waitcnt lgkmcnt(11)
    v_mfma_f32_16x16x32_bf16 v[4:7], v[100:103], v[68:71], v[4:7]
    ds_read_b64_tr_b16 v[116:117], v158 offset:24576
    s_waitcnt lgkmcnt(10)
    v_mfma_f32_16x16x32_bf16 v[8:11], v[104:107], v[68:71], v[8:11]
    ds_read_b64_tr_b16 v[118:119], v158 offset:25600
    s_waitcnt lgkmcnt(9)
    v_mfma_f32_16x16x32_bf16 v[12:15], v[108:111], v[68:71], v[12:15]
    ds_read_b128 v[84:87], v157 offset:16384
    s_waitcnt lgkmcnt(8)
    v_mfma_f32_16x16x32_bf16 v[16:19], v[112:115], v[68:71], v[16:19]
    ds_read_b64_tr_b16 v[120:121], v159 offset:24576
    s_waitcnt lgkmcnt(4)
    v_mfma_f32_16x16x32_bf16 v[140:143], v[132:135], v[68:71], v[140:143]
    v_mfma_f32_16x16x32_bf16 v[20:23], v[100:103], v[72:75], v[20:23]
    ds_read_b64_tr_b16 v[122:123], v159 offset:25600
    v_mfma_f32_16x16x32_bf16 v[24:27], v[104:107], v[72:75], v[24:27]
    ds_read_b64_tr_b16 v[124:125], v160 offset:24576
    v_mfma_f32_16x16x32_bf16 v[28:31], v[108:111], v[72:75], v[28:31]
    ds_read_b64_tr_b16 v[126:127], v160 offset:25600
    v_mfma_f32_16x16x32_bf16 v[32:35], v[112:115], v[72:75], v[32:35]
    ds_read_b64_tr_b16 v[128:129], v161 offset:24576
    v_mfma_f32_16x16x32_bf16 v[144:147], v[132:135], v[72:75], v[144:147]
    v_mfma_f32_16x16x32_bf16 v[36:39], v[100:103], v[76:79], v[36:39]
    ds_read_b64_tr_b16 v[130:131], v161 offset:25600
    v_mfma_f32_16x16x32_bf16 v[40:43], v[104:107], v[76:79], v[40:43]
    ds_read_b128 v[88:91], v157 offset:18432
    v_mfma_f32_16x16x32_bf16 v[44:47], v[108:111], v[76:79], v[44:47]
    ds_read_b128 v[92:95], v157 offset:20480
    v_mfma_f32_16x16x32_bf16 v[48:51], v[112:115], v[76:79], v[48:51]
    ds_read_b128 v[96:99], v157 offset:22528
    v_mfma_f32_16x16x32_bf16 v[52:55], v[100:103], v[80:83], v[52:55]
    ds_read_b64_tr_b16 v[136:137], v162 offset:6144
    v_mfma_f32_16x16x32_bf16 v[56:59], v[104:107], v[80:83], v[56:59]
    ds_read_b64_tr_b16 v[138:139], v162 offset:6400
    v_mfma_f32_16x16x32_bf16 v[60:63], v[108:111], v[80:83], v[60:63]
    v_mfma_f32_16x16x32_bf16 v[64:67], v[112:115], v[80:83], v[64:67]
    s_waitcnt lgkmcnt(11)
    v_mfma_f32_16x16x32_bf16 v[4:7], v[116:119], v[84:87], v[4:7]
    s_waitcnt lgkmcnt(9)
    v_mfma_f32_16x16x32_bf16 v[8:11], v[120:123], v[84:87], v[8:11]
    s_waitcnt lgkmcnt(7)
    v_mfma_f32_16x16x32_bf16 v[12:15], v[124:127], v[84:87], v[12:15]
    s_waitcnt lgkmcnt(5)
    v_mfma_f32_16x16x32_bf16 v[16:19], v[128:131], v[84:87], v[16:19]
    s_waitcnt lgkmcnt(0)
    s_waitcnt vmcnt(0)
    s_barrier
    ds_read_b64_tr_b16 v[100:101], v158 offset:32768
    ds_read_b64_tr_b16 v[102:103], v158 offset:33792
    v_mfma_f32_16x16x32_bf16 v[140:143], v[136:139], v[84:87], v[140:143]
    v_mfma_f32_16x16x32_bf16 v[20:23], v[116:119], v[88:91], v[20:23]
    ds_read_b128 v[68:71], v156 offset:32768
    v_mfma_f32_16x16x32_bf16 v[24:27], v[120:123], v[88:91], v[24:27]
    ds_read_b64_tr_b16 v[104:105], v159 offset:32768
    v_mfma_f32_16x16x32_bf16 v[28:31], v[124:127], v[88:91], v[28:31]
    ds_read_b64_tr_b16 v[106:107], v159 offset:33792
    v_mfma_f32_16x16x32_bf16 v[32:35], v[128:131], v[88:91], v[32:35]
    ds_read_b64_tr_b16 v[108:109], v160 offset:32768
    v_mfma_f32_16x16x32_bf16 v[144:147], v[136:139], v[88:91], v[144:147]
    v_mfma_f32_16x16x32_bf16 v[36:39], v[116:119], v[92:95], v[36:39]
    ds_read_b64_tr_b16 v[110:111], v160 offset:33792
    v_mfma_f32_16x16x32_bf16 v[40:43], v[120:123], v[92:95], v[40:43]
    ds_read_b64_tr_b16 v[112:113], v161 offset:32768
    v_mfma_f32_16x16x32_bf16 v[44:47], v[124:127], v[92:95], v[44:47]
    ds_read_b64_tr_b16 v[114:115], v161 offset:33792
    v_mfma_f32_16x16x32_bf16 v[48:51], v[128:131], v[92:95], v[48:51]
    ds_read_b128 v[72:75], v156 offset:34816
    v_mfma_f32_16x16x32_bf16 v[52:55], v[116:119], v[96:99], v[52:55]
    ds_read_b128 v[76:79], v156 offset:36864
    v_mfma_f32_16x16x32_bf16 v[56:59], v[120:123], v[96:99], v[56:59]
    ds_read_b128 v[80:83], v156 offset:38912
    v_mfma_f32_16x16x32_bf16 v[60:63], v[124:127], v[96:99], v[60:63]
    ds_read_b64_tr_b16 v[132:133], v162 offset:8192
    v_mfma_f32_16x16x32_bf16 v[64:67], v[128:131], v[96:99], v[64:67]
    ds_read_b64_tr_b16 v[134:135], v162 offset:8448
    s_waitcnt lgkmcnt(11)
    v_mfma_f32_16x16x32_bf16 v[4:7], v[100:103], v[68:71], v[4:7]
    ds_read_b64_tr_b16 v[116:117], v158 offset:40960
    s_waitcnt lgkmcnt(10)
    v_mfma_f32_16x16x32_bf16 v[8:11], v[104:107], v[68:71], v[8:11]
    ds_read_b64_tr_b16 v[118:119], v158 offset:41984
    s_waitcnt lgkmcnt(9)
    v_mfma_f32_16x16x32_bf16 v[12:15], v[108:111], v[68:71], v[12:15]
    ds_read_b128 v[84:87], v157 offset:32768
    s_waitcnt lgkmcnt(8)
    v_mfma_f32_16x16x32_bf16 v[16:19], v[112:115], v[68:71], v[16:19]
    ds_read_b64_tr_b16 v[120:121], v159 offset:40960
    s_waitcnt lgkmcnt(4)
    v_mfma_f32_16x16x32_bf16 v[140:143], v[132:135], v[68:71], v[140:143]
    v_mfma_f32_16x16x32_bf16 v[20:23], v[100:103], v[72:75], v[20:23]
    ds_read_b64_tr_b16 v[122:123], v159 offset:41984
    v_mfma_f32_16x16x32_bf16 v[24:27], v[104:107], v[72:75], v[24:27]
    ds_read_b64_tr_b16 v[124:125], v160 offset:40960
    v_mfma_f32_16x16x32_bf16 v[28:31], v[108:111], v[72:75], v[28:31]
    ds_read_b64_tr_b16 v[126:127], v160 offset:41984
    v_mfma_f32_16x16x32_bf16 v[32:35], v[112:115], v[72:75], v[32:35]
    ds_read_b64_tr_b16 v[128:129], v161 offset:40960
    v_mfma_f32_16x16x32_bf16 v[144:147], v[132:135], v[72:75], v[144:147]
    v_mfma_f32_16x16x32_bf16 v[36:39], v[100:103], v[76:79], v[36:39]
    ds_read_b64_tr_b16 v[130:131], v161 offset:41984
    v_mfma_f32_16x16x32_bf16 v[40:43], v[104:107], v[76:79], v[40:43]
    ds_read_b128 v[88:91], v157 offset:34816
    v_mfma_f32_16x16x32_bf16 v[44:47], v[108:111], v[76:79], v[44:47]
    ds_read_b128 v[92:95], v157 offset:36864
    v_mfma_f32_16x16x32_bf16 v[48:51], v[112:115], v[76:79], v[48:51]
    ds_read_b128 v[96:99], v157 offset:38912
    v_mfma_f32_16x16x32_bf16 v[52:55], v[100:103], v[80:83], v[52:55]
    ds_read_b64_tr_b16 v[136:137], v162 offset:10240
    v_mfma_f32_16x16x32_bf16 v[56:59], v[104:107], v[80:83], v[56:59]
    ds_read_b64_tr_b16 v[138:139], v162 offset:10496
    v_mfma_f32_16x16x32_bf16 v[60:63], v[108:111], v[80:83], v[60:63]
    v_mfma_f32_16x16x32_bf16 v[64:67], v[112:115], v[80:83], v[64:67]
    s_waitcnt lgkmcnt(11)
    v_mfma_f32_16x16x32_bf16 v[4:7], v[116:119], v[84:87], v[4:7]
    s_waitcnt lgkmcnt(9)
    v_mfma_f32_16x16x32_bf16 v[8:11], v[120:123], v[84:87], v[8:11]
    s_waitcnt lgkmcnt(7)
    v_mfma_f32_16x16x32_bf16 v[12:15], v[124:127], v[84:87], v[12:15]
    s_waitcnt lgkmcnt(5)
    v_mfma_f32_16x16x32_bf16 v[16:19], v[128:131], v[84:87], v[16:19]
    s_waitcnt lgkmcnt(0)
    s_barrier
    ds_read_b64_tr_b16 v[100:101], v158 offset:49152
    ds_read_b64_tr_b16 v[102:103], v158 offset:50176
    v_mfma_f32_16x16x32_bf16 v[140:143], v[136:139], v[84:87], v[140:143]
    v_mfma_f32_16x16x32_bf16 v[20:23], v[116:119], v[88:91], v[20:23]
    ds_read_b128 v[68:71], v156 offset:49152
    v_mfma_f32_16x16x32_bf16 v[24:27], v[120:123], v[88:91], v[24:27]
    ds_read_b64_tr_b16 v[104:105], v159 offset:49152
    v_mfma_f32_16x16x32_bf16 v[28:31], v[124:127], v[88:91], v[28:31]
    ds_read_b64_tr_b16 v[106:107], v159 offset:50176
    v_mfma_f32_16x16x32_bf16 v[32:35], v[128:131], v[88:91], v[32:35]
    ds_read_b64_tr_b16 v[108:109], v160 offset:49152
    v_mfma_f32_16x16x32_bf16 v[144:147], v[136:139], v[88:91], v[144:147]
    v_mfma_f32_16x16x32_bf16 v[36:39], v[116:119], v[92:95], v[36:39]
    ds_read_b64_tr_b16 v[110:111], v160 offset:50176
    v_mfma_f32_16x16x32_bf16 v[40:43], v[120:123], v[92:95], v[40:43]
    ds_read_b64_tr_b16 v[112:113], v161 offset:49152
    v_mfma_f32_16x16x32_bf16 v[44:47], v[124:127], v[92:95], v[44:47]
    ds_read_b64_tr_b16 v[114:115], v161 offset:50176
    v_mfma_f32_16x16x32_bf16 v[48:51], v[128:131], v[92:95], v[48:51]
    ds_read_b128 v[72:75], v156 offset:51200
    v_mfma_f32_16x16x32_bf16 v[52:55], v[116:119], v[96:99], v[52:55]
    ds_read_b128 v[76:79], v156 offset:53248
    v_mfma_f32_16x16x32_bf16 v[56:59], v[120:123], v[96:99], v[56:59]
    ds_read_b128 v[80:83], v156 offset:55296
    v_mfma_f32_16x16x32_bf16 v[60:63], v[124:127], v[96:99], v[60:63]
    ds_read_b64_tr_b16 v[132:133], v162 offset:12288
    v_mfma_f32_16x16x32_bf16 v[64:67], v[128:131], v[96:99], v[64:67]
    ds_read_b64_tr_b16 v[134:135], v162 offset:12544
    s_waitcnt lgkmcnt(11)
    v_mfma_f32_16x16x32_bf16 v[4:7], v[100:103], v[68:71], v[4:7]
    ds_read_b64_tr_b16 v[116:117], v158 offset:57344
    s_waitcnt lgkmcnt(10)
    v_mfma_f32_16x16x32_bf16 v[8:11], v[104:107], v[68:71], v[8:11]
    ds_read_b64_tr_b16 v[118:119], v158 offset:58368
    s_waitcnt lgkmcnt(9)
    v_mfma_f32_16x16x32_bf16 v[12:15], v[108:111], v[68:71], v[12:15]
    ds_read_b128 v[84:87], v157 offset:49152
    s_waitcnt lgkmcnt(8)
    v_mfma_f32_16x16x32_bf16 v[16:19], v[112:115], v[68:71], v[16:19]
    ds_read_b64_tr_b16 v[120:121], v159 offset:57344
    s_waitcnt lgkmcnt(4)
    v_mfma_f32_16x16x32_bf16 v[140:143], v[132:135], v[68:71], v[140:143]
    v_mfma_f32_16x16x32_bf16 v[20:23], v[100:103], v[72:75], v[20:23]
    ds_read_b64_tr_b16 v[122:123], v159 offset:58368
    v_mfma_f32_16x16x32_bf16 v[24:27], v[104:107], v[72:75], v[24:27]
    ds_read_b64_tr_b16 v[124:125], v160 offset:57344
    v_mfma_f32_16x16x32_bf16 v[28:31], v[108:111], v[72:75], v[28:31]
    ds_read_b64_tr_b16 v[126:127], v160 offset:58368
    v_mfma_f32_16x16x32_bf16 v[32:35], v[112:115], v[72:75], v[32:35]
    ds_read_b64_tr_b16 v[128:129], v161 offset:57344
    v_mfma_f32_16x16x32_bf16 v[144:147], v[132:135], v[72:75], v[144:147]
    v_mfma_f32_16x16x32_bf16 v[36:39], v[100:103], v[76:79], v[36:39]
    ds_read_b64_tr_b16 v[130:131], v161 offset:58368
    v_mfma_f32_16x16x32_bf16 v[40:43], v[104:107], v[76:79], v[40:43]
    ds_read_b128 v[88:91], v157 offset:51200
    v_mfma_f32_16x16x32_bf16 v[44:47], v[108:111], v[76:79], v[44:47]
    ds_read_b128 v[92:95], v157 offset:53248
    v_mfma_f32_16x16x32_bf16 v[48:51], v[112:115], v[76:79], v[48:51]
    ds_read_b128 v[96:99], v157 offset:55296
    v_mfma_f32_16x16x32_bf16 v[52:55], v[100:103], v[80:83], v[52:55]
    ds_read_b64_tr_b16 v[136:137], v162 offset:14336
    v_mfma_f32_16x16x32_bf16 v[56:59], v[104:107], v[80:83], v[56:59]
    ds_read_b64_tr_b16 v[138:139], v162 offset:14592
    v_mfma_f32_16x16x32_bf16 v[60:63], v[108:111], v[80:83], v[60:63]
    v_mfma_f32_16x16x32_bf16 v[64:67], v[112:115], v[80:83], v[64:67]
    s_waitcnt lgkmcnt(11)
    v_mfma_f32_16x16x32_bf16 v[4:7], v[116:119], v[84:87], v[4:7]
    s_waitcnt lgkmcnt(9)
    v_mfma_f32_16x16x32_bf16 v[8:11], v[120:123], v[84:87], v[8:11]
    s_waitcnt lgkmcnt(7)
    v_mfma_f32_16x16x32_bf16 v[12:15], v[124:127], v[84:87], v[12:15]
    s_waitcnt lgkmcnt(5)
    v_mfma_f32_16x16x32_bf16 v[16:19], v[128:131], v[84:87], v[16:19]
    s_waitcnt lgkmcnt(0)
    s_barrier
    ds_read_b64_tr_b16 v[100:101], v158 offset:0
    v_mfma_f32_16x16x32_bf16 v[140:143], v[136:139], v[84:87], v[140:143]
    v_mfma_f32_16x16x32_bf16 v[20:23], v[116:119], v[88:91], v[20:23]
    ds_read_b64_tr_b16 v[102:103], v158 offset:1024
    v_mfma_f32_16x16x32_bf16 v[24:27], v[120:123], v[88:91], v[24:27]
    ds_read_b128 v[68:71], v156 offset:0
    v_mfma_f32_16x16x32_bf16 v[28:31], v[124:127], v[88:91], v[28:31]
    ds_read_b64_tr_b16 v[104:105], v159 offset:0
    v_mfma_f32_16x16x32_bf16 v[32:35], v[128:131], v[88:91], v[32:35]
    ds_read_b64_tr_b16 v[106:107], v159 offset:1024
    v_mfma_f32_16x16x32_bf16 v[144:147], v[136:139], v[88:91], v[144:147]
    v_mfma_f32_16x16x32_bf16 v[36:39], v[116:119], v[92:95], v[36:39]
    ds_read_b64_tr_b16 v[108:109], v160 offset:0
    v_cvt_pk_bf16_f32 v148, v4, v5
    v_cvt_pk_bf16_f32 v149, v6, v7
    v_cvt_pk_bf16_f32 v150, v8, v9
    v_mfma_f32_16x16x32_bf16 v[40:43], v[120:123], v[92:95], v[40:43]
    ds_read_b64_tr_b16 v[110:111], v160 offset:1024
    v_cvt_pk_bf16_f32 v151, v10, v11
    buffer_store_dwordx4 v[148:151], v163, s[20:23], s40 offen sc1
    v_cvt_pk_bf16_f32 v152, v12, v13
    v_mfma_f32_16x16x32_bf16 v[44:47], v[124:127], v[92:95], v[44:47]
    ds_read_b64_tr_b16 v[112:113], v161 offset:0
    v_cvt_pk_bf16_f32 v153, v14, v15
    v_cvt_pk_bf16_f32 v154, v16, v17
    v_mfma_f32_16x16x32_bf16 v[48:51], v[128:131], v[92:95], v[48:51]
    ds_read_b64_tr_b16 v[114:115], v161 offset:1024
    v_cvt_pk_bf16_f32 v155, v18, v19
    buffer_store_dwordx4 v[152:155], v165, s[20:23], s40 offen sc1
    v_mfma_f32_16x16x32_bf16 v[52:55], v[116:119], v[96:99], v[52:55]
    ds_read_b128 v[72:75], v156 offset:2048
    v_cvt_pk_bf16_f32 v148, v20, v21
    v_cvt_pk_bf16_f32 v149, v22, v23
    v_cvt_pk_bf16_f32 v150, v24, v25
    v_mfma_f32_16x16x32_bf16 v[56:59], v[120:123], v[96:99], v[56:59]
    ds_read_b128 v[76:79], v156 offset:4096
    v_cvt_pk_bf16_f32 v151, v26, v27
    buffer_store_dwordx4 v[148:151], v164, s[20:23], s40 offen sc1
    v_cvt_pk_bf16_f32 v152, v28, v29
    v_mfma_f32_16x16x32_bf16 v[60:63], v[124:127], v[96:99], v[60:63]
    ds_read_b128 v[80:83], v156 offset:6144
    v_cvt_pk_bf16_f32 v153, v30, v31
    v_cvt_pk_bf16_f32 v154, v32, v33
    v_mfma_f32_16x16x32_bf16 v[64:67], v[128:131], v[96:99], v[64:67]
    v_cvt_pk_bf16_f32 v155, v34, v35
    buffer_store_dwordx4 v[152:155], v166, s[20:23], s40 offen sc1
    v_pk_mul_f32 v[140:141], v[140:141], s[92:93]
    v_pk_mul_f32 v[142:143], v[142:143], s[92:93]
    v_cvt_pk_bf16_f32 v132, v140, v141
    v_cvt_pk_bf16_f32 v133, v142, v143
    buffer_store_dwordx2 v[132:133], v0, s[12:15], 0 offen offset:0 sc1
    v_pk_mul_f32 v[144:145], v[144:145], s[92:93]
    v_pk_mul_f32 v[146:147], v[146:147], s[92:93]
    v_cvt_pk_bf16_f32 v134, v144, v145
    v_cvt_pk_bf16_f32 v135, v146, v147
    buffer_store_dwordx2 v[134:135], v0, s[12:15], 0 offen offset:256 sc1
    v_cvt_pk_bf16_f32 v148, v36, v37
    v_cvt_pk_bf16_f32 v149, v38, v39
    v_cvt_pk_bf16_f32 v150, v40, v41
    v_cvt_pk_bf16_f32 v151, v42, v43
    buffer_store_dwordx4 v[148:151], v163, s[20:23], s41 offen sc1
    v_cvt_pk_bf16_f32 v152, v44, v45
    v_cvt_pk_bf16_f32 v153, v46, v47
    v_cvt_pk_bf16_f32 v154, v48, v49
    v_cvt_pk_bf16_f32 v155, v50, v51
    buffer_store_dwordx4 v[152:155], v165, s[20:23], s41 offen sc1
    s_nop 3
    v_cvt_pk_bf16_f32 v148, v52, v53
    v_cvt_pk_bf16_f32 v149, v54, v55
    v_cvt_pk_bf16_f32 v150, v56, v57
    v_cvt_pk_bf16_f32 v151, v58, v59
    buffer_store_dwordx4 v[148:151], v164, s[20:23], s41 offen sc1
    v_cvt_pk_bf16_f32 v152, v60, v61
    v_cvt_pk_bf16_f32 v153, v62, v63
    v_cvt_pk_bf16_f32 v154, v64, v65
    v_cvt_pk_bf16_f32 v155, v66, v67
    buffer_store_dwordx4 v[152:155], v166, s[20:23], s41 offen sc1
    s_branch L_g1_A2
L_g1_AV:
    s_lshr_b32 s29, s35, 1
    s_lshl_b32 s29, s29, 3
    s_and_b32 s27, s35, 1
    s_lshl_b32 s27, s27, 1
    s_add_u32 s29, s29, s27
    s_lshl_b32 s27, s57, 2
    s_add_u32 s27, s27, s29
    s_mul_i32 s26, s27, 131072
    s_lshl_b32 s27, s34, 2
    s_lshl_b32 s28, s56, 1
    s_add_u32 s27, s27, s28
    s_mul_i32 s27, s27, 2048
    s_add_u32 s26, s26, s27
    s_add_u32 s26, s26, 0
    s_add_u32 s20, s4, s26
    s_addc_u32 s21, s5, 0
    s_and_b32 s21, s21, 0xffff
    s_mov_b32 s22, 1048576
    s_mov_b32 s23, 0x20000
    s_add_u32 s27, s37, 0
    s_and_b32 s27, s27, 1
    s_mul_i32 s40, s27, 2048
    s_add_u32 s27, s37, 1
    s_and_b32 s27, s27, 1
    s_mul_i32 s41, s27, 2048
    v_and_b32 v68, 15, v2
    v_lshrrev_b32 v69, 4, v2
    v_and_b32 v71, 1, v69
    v_lshlrev_b32 v71, 9, v71
    v_lshlrev_b32 v72, 4, v68
    v_add_u32 v71, v71, v72
    v_lshrrev_b32 v70, 1, v69
    v_lshlrev_b32 v70, 10, v70
    v_add_u32 v74, v70, v71
    v_add_u32 v163, 0, v74
    v_add_u32 v164, 256, v74
    v_add_u32 v165, 131072, v74
    v_add_u32 v166, 131328, v74
    s_lshl_b32 s26, s34, 2
    s_lshl_b32 s27, s56, 1
    s_add_u32 s26, s26, s27
    s_add_u32 s26, s26, s37
    s_lshl_b32 s26, s26, 12
    s_add_u32 s26, s26, 16777216
    s_add_u32 s12, s4, s26
    s_addc_u32 s13, s5, 0
    s_and_b32 s13, s13, 0xffff
    s_mov_b32 s14, 4096
    s_mov_b32 s15, 0x20000
    v_and_b32 v68, 15, v2
    v_lshrrev_b32 v69, 4, v2
    v_and_b32 v71, 1, v69
    v_lshlrev_b32 v71, 9, v71
    v_lshlrev_b32 v72, 4, v68
    v_add_u32 v71, v71, v72
    v_lshrrev_b32 v70, 1, v69
    v_lshlrev_b32 v70, 3, v70
    v_add_u32 v0, v70, v71
    s_lshl_b32 s27, s57, 8
    s_add_u32 s27, s27, 2048
    v_add_u32 v0, s27, v0
    s_barrier
    ds_read_b64_tr_b16 v[100:101], v158 offset:0
    ds_read_b64_tr_b16 v[102:103], v158 offset:1024
    ds_read_b128 v[68:71], v156 offset:0
    ds_read_b64_tr_b16 v[104:105], v159 offset:0
    ds_read_b64_tr_b16 v[106:107], v159 offset:1024
    ds_read_b64_tr_b16 v[108:109], v160 offset:0
    ds_read_b64_tr_b16 v[110:111], v160 offset:1024
    ds_read_b64_tr_b16 v[112:113], v161 offset:0
    ds_read_b64_tr_b16 v[114:115], v161 offset:1024
    ds_read_b128 v[72:75], v156 offset:2048
    ds_read_b128 v[76:79], v156 offset:4096
    ds_read_b128 v[80:83], v156 offset:6144
    ds_read_b64_tr_b16 v[132:133], v162 offset:0
    ds_read_b64_tr_b16 v[134:135], v162 offset:256
    s_waitcnt lgkmcnt(11)
    v_mfma_f32_16x16x32_bf16 v[4:7], v[100:103], v[68:71], 0
    ds_read_b64_tr_b16 v[116:117], v158 offset:8192
    s_waitcnt lgkmcnt(10)
    v_mfma_f32_16x16x32_bf16 v[8:11], v[104:107], v[68:71], 0
    ds_read_b64_tr_b16 v[118:119], v158 offset:9216
    s_waitcnt lgkmcnt(9)
    v_mfma_f32_16x16x32_bf16 v[12:15], v[108:111], v[68:71], 0
    ds_read_b128 v[84:87], v157 offset:0
    s_waitcnt lgkmcnt(8)
    v_mfma_f32_16x16x32_bf16 v[16:19], v[112:115], v[68:71], 0
    ds_read_b64_tr_b16 v[120:121], v159 offset:8192
    s_waitcnt lgkmcnt(4)
    v_mfma_f32_16x16x32_bf16 v[140:143], v[68:71], v[132:135], 0
    v_mfma_f32_16x16x32_bf16 v[20:23], v[100:103], v[72:75], 0
    ds_read_b64_tr_b16 v[122:123], v159 offset:9216
    v_mfma_f32_16x16x32_bf16 v[24:27], v[104:107], v[72:75], 0
    ds_read_b64_tr_b16 v[124:125], v160 offset:8192
    v_mfma_f32_16x16x32_bf16 v[28:31], v[108:111], v[72:75], 0
    ds_read_b64_tr_b16 v[126:127], v160 offset:9216
    v_mfma_f32_16x16x32_bf16 v[32:35], v[112:115], v[72:75], 0
    ds_read_b64_tr_b16 v[128:129], v161 offset:8192
    v_mfma_f32_16x16x32_bf16 v[144:147], v[72:75], v[132:135], 0
    v_mfma_f32_16x16x32_bf16 v[36:39], v[100:103], v[76:79], 0
    ds_read_b64_tr_b16 v[130:131], v161 offset:9216
    v_mfma_f32_16x16x32_bf16 v[40:43], v[104:107], v[76:79], 0
    ds_read_b128 v[88:91], v157 offset:2048
    v_mfma_f32_16x16x32_bf16 v[44:47], v[108:111], v[76:79], 0
    ds_read_b128 v[92:95], v157 offset:4096
    v_mfma_f32_16x16x32_bf16 v[48:51], v[112:115], v[76:79], 0
    ds_read_b128 v[96:99], v157 offset:6144
    v_mfma_f32_16x16x32_bf16 v[52:55], v[100:103], v[80:83], 0
    ds_read_b64_tr_b16 v[136:137], v162 offset:2048
    v_mfma_f32_16x16x32_bf16 v[56:59], v[104:107], v[80:83], 0
    ds_read_b64_tr_b16 v[138:139], v162 offset:2304
    v_mfma_f32_16x16x32_bf16 v[60:63], v[108:111], v[80:83], 0
    v_mfma_f32_16x16x32_bf16 v[64:67], v[112:115], v[80:83], 0
    s_mov_b32 s58, 0
.p2align 6
L_loop_AV:
    s_waitcnt lgkmcnt(11)
    v_mfma_f32_16x16x32_bf16 v[4:7], v[116:119], v[84:87], v[4:7]
    s_waitcnt lgkmcnt(9)
    v_mfma_f32_16x16x32_bf16 v[8:11], v[120:123], v[84:87], v[8:11]
    s_waitcnt lgkmcnt(7)
    v_mfma_f32_16x16x32_bf16 v[12:15], v[124:127], v[84:87], v[12:15]
    s_waitcnt lgkmcnt(5)
    v_mfma_f32_16x16x32_bf16 v[16:19], v[128:131], v[84:87], v[16:19]
    s_waitcnt lgkmcnt(0)
    s_barrier
    ds_read_b64_tr_b16 v[100:101], v158 offset:16384
    ds_read_b64_tr_b16 v[102:103], v158 offset:17408
    v_mfma_f32_16x16x32_bf16 v[140:143], v[84:87], v[136:139], v[140:143]
    v_mfma_f32_16x16x32_bf16 v[20:23], v[116:119], v[88:91], v[20:23]
    ds_read_b128 v[68:71], v156 offset:16384
    v_mfma_f32_16x16x32_bf16 v[24:27], v[120:123], v[88:91], v[24:27]
    ds_read_b64_tr_b16 v[104:105], v159 offset:16384
    v_mfma_f32_16x16x32_bf16 v[28:31], v[124:127], v[88:91], v[28:31]
    ds_read_b64_tr_b16 v[106:107], v159 offset:17408
    v_mfma_f32_16x16x32_bf16 v[32:35], v[128:131], v[88:91], v[32:35]
    ds_read_b64_tr_b16 v[108:109], v160 offset:16384
    v_mfma_f32_16x16x32_bf16 v[144:147], v[88:91], v[136:139], v[144:147]
    v_mfma_f32_16x16x32_bf16 v[36:39], v[116:119], v[92:95], v[36:39]
    ds_read_b64_tr_b16 v[110:111], v160 offset:17408
    v_mfma_f32_16x16x32_bf16 v[40:43], v[120:123], v[92:95], v[40:43]
    ds_read_b64_tr_b16 v[112:113], v161 offset:16384
    v_mfma_f32_16x16x32_bf16 v[44:47], v[124:127], v[92:95], v[44:47]
    ds_read_b64_tr_b16 v[114:115], v161 offset:17408
    v_mfma_f32_16x16x32_bf16 v[48:51], v[128:131], v[92:95], v[48:51]
    ds_read_b128 v[72:75], v156 offset:18432
    v_mfma_f32_16x16x32_bf16 v[52:55], v[116:119], v[96:99], v[52:55]
    ds_read_b128 v[76:79], v156 offset:20480
    v_mfma_f32_16x16x32_bf16 v[56:59], v[120:123], v[96:99], v[56:59]
    ds_read_b128 v[80:83], v156 offset:22528
    v_mfma_f32_16x16x32_bf16 v[60:63], v[124:127], v[96:99], v[60:63]
    ds_read_b64_tr_b16 v[132:133], v162 offset:4096
    v_mfma_f32_16x16x32_bf16 v[64:67], v[128:131], v[96:99], v[64:67]
    ds_read_b64_tr_b16 v[134:135], v162 offset:4352
    s_waitcnt lgkmcnt(11)
    v_mfma_f32_16x16x32_bf16 v[4:7], v[100:103], v[68:71], v[4:7]
    ds_read_b64_tr_b16 v[116:117], v158 offset:24576
    s_waitcnt lgkmcnt(10)
    v_mfma_f32_16x16x32_bf16 v[8:11], v[104:107], v[68:71], v[8:11]
    ds_read_b64_tr_b16 v[118:119], v158 offset:25600
    s_waitcnt lgkmcnt(9)
    v_mfma_f32_16x16x32_bf16 v[12:15], v[108:111], v[68:71], v[12:15]
    ds_read_b128 v[84:87], v157 offset:16384
    s_waitcnt lgkmcnt(8)
    v_mfma_f32_16x16x32_bf16 v[16:19], v[112:115], v[68:71], v[16:19]
    ds_read_b64_tr_b16 v[120:121], v159 offset:24576
    s_waitcnt lgkmcnt(4)
    v_mfma_f32_16x16x32_bf16 v[140:143], v[68:71], v[132:135], v[140:143]
    v_mfma_f32_16x16x32_bf16 v[20:23], v[100:103], v[72:75], v[20:23]
    ds_read_b64_tr_b16 v[122:123], v159 offset:25600
    v_mfma_f32_16x16x32_bf16 v[24:27], v[104:107], v[72:75], v[24:27]
    ds_read_b64_tr_b16 v[124:125], v160 offset:24576
    v_mfma_f32_16x16x32_bf16 v[28:31], v[108:111], v[72:75], v[28:31]
    ds_read_b64_tr_b16 v[126:127], v160 offset:25600
    v_mfma_f32_16x16x32_bf16 v[32:35], v[112:115], v[72:75], v[32:35]
    ds_read_b64_tr_b16 v[128:129], v161 offset:24576
    v_mfma_f32_16x16x32_bf16 v[144:147], v[72:75], v[132:135], v[144:147]
    v_mfma_f32_16x16x32_bf16 v[36:39], v[100:103], v[76:79], v[36:39]
    ds_read_b64_tr_b16 v[130:131], v161 offset:25600
    v_mfma_f32_16x16x32_bf16 v[40:43], v[104:107], v[76:79], v[40:43]
    ds_read_b128 v[88:91], v157 offset:18432
    v_mfma_f32_16x16x32_bf16 v[44:47], v[108:111], v[76:79], v[44:47]
    ds_read_b128 v[92:95], v157 offset:20480
    v_mfma_f32_16x16x32_bf16 v[48:51], v[112:115], v[76:79], v[48:51]
    ds_read_b128 v[96:99], v157 offset:22528
    v_mfma_f32_16x16x32_bf16 v[52:55], v[100:103], v[80:83], v[52:55]
    ds_read_b64_tr_b16 v[136:137], v162 offset:6144
    v_mfma_f32_16x16x32_bf16 v[56:59], v[104:107], v[80:83], v[56:59]
    ds_read_b64_tr_b16 v[138:139], v162 offset:6400
    v_mfma_f32_16x16x32_bf16 v[60:63], v[108:111], v[80:83], v[60:63]
    v_mfma_f32_16x16x32_bf16 v[64:67], v[112:115], v[80:83], v[64:67]
    s_waitcnt lgkmcnt(11)
    v_mfma_f32_16x16x32_bf16 v[4:7], v[116:119], v[84:87], v[4:7]
    s_waitcnt lgkmcnt(9)
    v_mfma_f32_16x16x32_bf16 v[8:11], v[120:123], v[84:87], v[8:11]
    s_waitcnt lgkmcnt(7)
    v_mfma_f32_16x16x32_bf16 v[12:15], v[124:127], v[84:87], v[12:15]
    s_waitcnt lgkmcnt(5)
    v_mfma_f32_16x16x32_bf16 v[16:19], v[128:131], v[84:87], v[16:19]
    s_waitcnt lgkmcnt(0)
    s_waitcnt vmcnt(0)
    s_barrier
    ds_read_b64_tr_b16 v[100:101], v158 offset:32768
    ds_read_b64_tr_b16 v[102:103], v158 offset:33792
    v_mfma_f32_16x16x32_bf16 v[140:143], v[84:87], v[136:139], v[140:143]
    v_mfma_f32_16x16x32_bf16 v[20:23], v[116:119], v[88:91], v[20:23]
    ds_read_b128 v[68:71], v156 offset:32768
    v_mfma_f32_16x16x32_bf16 v[24:27], v[120:123], v[88:91], v[24:27]
    ds_read_b64_tr_b16 v[104:105], v159 offset:32768
    v_mfma_f32_16x16x32_bf16 v[28:31], v[124:127], v[88:91], v[28:31]
    ds_read_b64_tr_b16 v[106:107], v159 offset:33792
    v_mfma_f32_16x16x32_bf16 v[32:35], v[128:131], v[88:91], v[32:35]
    ds_read_b64_tr_b16 v[108:109], v160 offset:32768
    v_mfma_f32_16x16x32_bf16 v[144:147], v[88:91], v[136:139], v[144:147]
    v_mfma_f32_16x16x32_bf16 v[36:39], v[116:119], v[92:95], v[36:39]
    ds_read_b64_tr_b16 v[110:111], v160 offset:33792
    v_mfma_f32_16x16x32_bf16 v[40:43], v[120:123], v[92:95], v[40:43]
    ds_read_b64_tr_b16 v[112:113], v161 offset:32768
    v_mfma_f32_16x16x32_bf16 v[44:47], v[124:127], v[92:95], v[44:47]
    ds_read_b64_tr_b16 v[114:115], v161 offset:33792
    v_mfma_f32_16x16x32_bf16 v[48:51], v[128:131], v[92:95], v[48:51]
    ds_read_b128 v[72:75], v156 offset:34816
    v_mfma_f32_16x16x32_bf16 v[52:55], v[116:119], v[96:99], v[52:55]
    ds_read_b128 v[76:79], v156 offset:36864
    v_mfma_f32_16x16x32_bf16 v[56:59], v[120:123], v[96:99], v[56:59]
    ds_read_b128 v[80:83], v156 offset:38912
    v_mfma_f32_16x16x32_bf16 v[60:63], v[124:127], v[96:99], v[60:63]
    ds_read_b64_tr_b16 v[132:133], v162 offset:8192
    v_mfma_f32_16x16x32_bf16 v[64:67], v[128:131], v[96:99], v[64:67]
    ds_read_b64_tr_b16 v[134:135], v162 offset:8448
    s_waitcnt lgkmcnt(11)
    v_mfma_f32_16x16x32_bf16 v[4:7], v[100:103], v[68:71], v[4:7]
    ds_read_b64_tr_b16 v[116:117], v158 offset:40960
    s_waitcnt lgkmcnt(10)
    v_mfma_f32_16x16x32_bf16 v[8:11], v[104:107], v[68:71], v[8:11]
    ds_read_b64_tr_b16 v[118:119], v158 offset:41984
    s_waitcnt lgkmcnt(9)
    v_mfma_f32_16x16x32_bf16 v[12:15], v[108:111], v[68:71], v[12:15]
    ds_read_b128 v[84:87], v157 offset:32768
    s_waitcnt lgkmcnt(8)
    v_mfma_f32_16x16x32_bf16 v[16:19], v[112:115], v[68:71], v[16:19]
    ds_read_b64_tr_b16 v[120:121], v159 offset:40960
    s_waitcnt lgkmcnt(4)
    v_mfma_f32_16x16x32_bf16 v[140:143], v[68:71], v[132:135], v[140:143]
    v_mfma_f32_16x16x32_bf16 v[20:23], v[100:103], v[72:75], v[20:23]
    ds_read_b64_tr_b16 v[122:123], v159 offset:41984
    v_mfma_f32_16x16x32_bf16 v[24:27], v[104:107], v[72:75], v[24:27]
    ds_read_b64_tr_b16 v[124:125], v160 offset:40960
    v_mfma_f32_16x16x32_bf16 v[28:31], v[108:111], v[72:75], v[28:31]
    ds_read_b64_tr_b16 v[126:127], v160 offset:41984
    v_mfma_f32_16x16x32_bf16 v[32:35], v[112:115], v[72:75], v[32:35]
    ds_read_b64_tr_b16 v[128:129], v161 offset:40960
    v_mfma_f32_16x16x32_bf16 v[144:147], v[72:75], v[132:135], v[144:147]
    v_mfma_f32_16x16x32_bf16 v[36:39], v[100:103], v[76:79], v[36:39]
    ds_read_b64_tr_b16 v[130:131], v161 offset:41984
    v_mfma_f32_16x16x32_bf16 v[40:43], v[104:107], v[76:79], v[40:43]
    ds_read_b128 v[88:91], v157 offset:34816
    v_mfma_f32_16x16x32_bf16 v[44:47], v[108:111], v[76:79], v[44:47]
    ds_read_b128 v[92:95], v157 offset:36864
    v_mfma_f32_16x16x32_bf16 v[48:51], v[112:115], v[76:79], v[48:51]
    ds_read_b128 v[96:99], v157 offset:38912
    v_mfma_f32_16x16x32_bf16 v[52:55], v[100:103], v[80:83], v[52:55]
    ds_read_b64_tr_b16 v[136:137], v162 offset:10240
    v_mfma_f32_16x16x32_bf16 v[56:59], v[104:107], v[80:83], v[56:59]
    ds_read_b64_tr_b16 v[138:139], v162 offset:10496
    v_mfma_f32_16x16x32_bf16 v[60:63], v[108:111], v[80:83], v[60:63]
    v_mfma_f32_16x16x32_bf16 v[64:67], v[112:115], v[80:83], v[64:67]
    s_waitcnt lgkmcnt(11)
    v_mfma_f32_16x16x32_bf16 v[4:7], v[116:119], v[84:87], v[4:7]
    s_waitcnt lgkmcnt(9)
    v_mfma_f32_16x16x32_bf16 v[8:11], v[120:123], v[84:87], v[8:11]
    s_waitcnt lgkmcnt(7)
    v_mfma_f32_16x16x32_bf16 v[12:15], v[124:127], v[84:87], v[12:15]
    s_waitcnt lgkmcnt(5)
    v_mfma_f32_16x16x32_bf16 v[16:19], v[128:131], v[84:87], v[16:19]
    s_waitcnt lgkmcnt(0)
    s_barrier
    ds_read_b64_tr_b16 v[100:101], v158 offset:49152
    ds_read_b64_tr_b16 v[102:103], v158 offset:50176
    v_mfma_f32_16x16x32_bf16 v[140:143], v[84:87], v[136:139], v[140:143]
    v_mfma_f32_16x16x32_bf16 v[20:23], v[116:119], v[88:91], v[20:23]
    ds_read_b128 v[68:71], v156 offset:49152
    v_mfma_f32_16x16x32_bf16 v[24:27], v[120:123], v[88:91], v[24:27]
    ds_read_b64_tr_b16 v[104:105], v159 offset:49152
    v_mfma_f32_16x16x32_bf16 v[28:31], v[124:127], v[88:91], v[28:31]
    ds_read_b64_tr_b16 v[106:107], v159 offset:50176
    v_mfma_f32_16x16x32_bf16 v[32:35], v[128:131], v[88:91], v[32:35]
    ds_read_b64_tr_b16 v[108:109], v160 offset:49152
    v_mfma_f32_16x16x32_bf16 v[144:147], v[88:91], v[136:139], v[144:147]
    v_mfma_f32_16x16x32_bf16 v[36:39], v[116:119], v[92:95], v[36:39]
    ds_read_b64_tr_b16 v[110:111], v160 offset:50176
    v_mfma_f32_16x16x32_bf16 v[40:43], v[120:123], v[92:95], v[40:43]
    ds_read_b64_tr_b16 v[112:113], v161 offset:49152
    v_mfma_f32_16x16x32_bf16 v[44:47], v[124:127], v[92:95], v[44:47]
    ds_read_b64_tr_b16 v[114:115], v161 offset:50176
    v_mfma_f32_16x16x32_bf16 v[48:51], v[128:131], v[92:95], v[48:51]
    ds_read_b128 v[72:75], v156 offset:51200
    v_mfma_f32_16x16x32_bf16 v[52:55], v[116:119], v[96:99], v[52:55]
    ds_read_b128 v[76:79], v156 offset:53248
    v_mfma_f32_16x16x32_bf16 v[56:59], v[120:123], v[96:99], v[56:59]
    ds_read_b128 v[80:83], v156 offset:55296
    v_mfma_f32_16x16x32_bf16 v[60:63], v[124:127], v[96:99], v[60:63]
    ds_read_b64_tr_b16 v[132:133], v162 offset:12288
    v_mfma_f32_16x16x32_bf16 v[64:67], v[128:131], v[96:99], v[64:67]
    ds_read_b64_tr_b16 v[134:135], v162 offset:12544
    s_waitcnt lgkmcnt(11)
    v_mfma_f32_16x16x32_bf16 v[4:7], v[100:103], v[68:71], v[4:7]
    ds_read_b64_tr_b16 v[116:117], v158 offset:57344
    s_waitcnt lgkmcnt(10)
    v_mfma_f32_16x16x32_bf16 v[8:11], v[104:107], v[68:71], v[8:11]
    ds_read_b64_tr_b16 v[118:119], v158 offset:58368
    s_waitcnt lgkmcnt(9)
    v_mfma_f32_16x16x32_bf16 v[12:15], v[108:111], v[68:71], v[12:15]
    ds_read_b128 v[84:87], v157 offset:49152
    s_waitcnt lgkmcnt(8)
    v_mfma_f32_16x16x32_bf16 v[16:19], v[112:115], v[68:71], v[16:19]
    ds_read_b64_tr_b16 v[120:121], v159 offset:57344
    s_waitcnt lgkmcnt(4)
    v_mfma_f32_16x16x32_bf16 v[140:143], v[68:71], v[132:135], v[140:143]
    v_mfma_f32_16x16x32_bf16 v[20:23], v[100:103], v[72:75], v[20:23]
    ds_read_b64_tr_b16 v[122:123], v159 offset:58368
    v_mfma_f32_16x16x32_bf16 v[24:27], v[104:107], v[72:75], v[24:27]
    ds_read_b64_tr_b16 v[124:125], v160 offset:57344
    v_mfma_f32_16x16x32_bf16 v[28:31], v[108:111], v[72:75], v[28:31]
    ds_read_b64_tr_b16 v[126:127], v160 offset:58368
    v_mfma_f32_16x16x32_bf16 v[32:35], v[112:115], v[72:75], v[32:35]
    ds_read_b64_tr_b16 v[128:129], v161 offset:57344
    v_mfma_f32_16x16x32_bf16 v[144:147], v[72:75], v[132:135], v[144:147]
    v_mfma_f32_16x16x32_bf16 v[36:39], v[100:103], v[76:79], v[36:39]
    ds_read_b64_tr_b16 v[130:131], v161 offset:58368
    v_mfma_f32_16x16x32_bf16 v[40:43], v[104:107], v[76:79], v[40:43]
    ds_read_b128 v[88:91], v157 offset:51200
    v_mfma_f32_16x16x32_bf16 v[44:47], v[108:111], v[76:79], v[44:47]
    ds_read_b128 v[92:95], v157 offset:53248
    v_mfma_f32_16x16x32_bf16 v[48:51], v[112:115], v[76:79], v[48:51]
    ds_read_b128 v[96:99], v157 offset:55296
    v_mfma_f32_16x16x32_bf16 v[52:55], v[100:103], v[80:83], v[52:55]
    ds_read_b64_tr_b16 v[136:137], v162 offset:14336
    v_mfma_f32_16x16x32_bf16 v[56:59], v[104:107], v[80:83], v[56:59]
    ds_read_b64_tr_b16 v[138:139], v162 offset:14592
    v_mfma_f32_16x16x32_bf16 v[60:63], v[108:111], v[80:83], v[60:63]
    v_mfma_f32_16x16x32_bf16 v[64:67], v[112:115], v[80:83], v[64:67]
    s_waitcnt lgkmcnt(11)
    v_mfma_f32_16x16x32_bf16 v[4:7], v[116:119], v[84:87], v[4:7]
    s_waitcnt lgkmcnt(9)
    v_mfma_f32_16x16x32_bf16 v[8:11], v[120:123], v[84:87], v[8:11]
    s_waitcnt lgkmcnt(7)
    v_mfma_f32_16x16x32_bf16 v[12:15], v[124:127], v[84:87], v[12:15]
    s_waitcnt lgkmcnt(5)
    v_mfma_f32_16x16x32_bf16 v[16:19], v[128:131], v[84:87], v[16:19]
    s_waitcnt lgkmcnt(0)
    s_barrier
    ds_read_b64_tr_b16 v[100:101], v158 offset:0
    ds_read_b64_tr_b16 v[102:103], v158 offset:1024
    v_mfma_f32_16x16x32_bf16 v[140:143], v[84:87], v[136:139], v[140:143]
    v_mfma_f32_16x16x32_bf16 v[20:23], v[116:119], v[88:91], v[20:23]
    ds_read_b128 v[68:71], v156 offset:0
    v_mfma_f32_16x16x32_bf16 v[24:27], v[120:123], v[88:91], v[24:27]
    ds_read_b64_tr_b16 v[104:105], v159 offset:0
    v_mfma_f32_16x16x32_bf16 v[28:31], v[124:127], v[88:91], v[28:31]
    ds_read_b64_tr_b16 v[106:107], v159 offset:1024
    v_mfma_f32_16x16x32_bf16 v[32:35], v[128:131], v[88:91], v[32:35]
    ds_read_b64_tr_b16 v[108:109], v160 offset:0
    v_mfma_f32_16x16x32_bf16 v[144:147], v[88:91], v[136:139], v[144:147]
    v_mfma_f32_16x16x32_bf16 v[36:39], v[116:119], v[92:95], v[36:39]
    ds_read_b64_tr_b16 v[110:111], v160 offset:1024
    v_mfma_f32_16x16x32_bf16 v[40:43], v[120:123], v[92:95], v[40:43]
    ds_read_b64_tr_b16 v[112:113], v161 offset:0
    v_mfma_f32_16x16x32_bf16 v[44:47], v[124:127], v[92:95], v[44:47]
    ds_read_b64_tr_b16 v[114:115], v161 offset:1024
    v_mfma_f32_16x16x32_bf16 v[48:51], v[128:131], v[92:95], v[48:51]
    ds_read_b128 v[72:75], v156 offset:2048
    v_mfma_f32_16x16x32_bf16 v[52:55], v[116:119], v[96:99], v[52:55]
    ds_read_b128 v[76:79], v156 offset:4096
    v_mfma_f32_16x16x32_bf16 v[56:59], v[120:123], v[96:99], v[56:59]
    ds_read_b128 v[80:83], v156 offset:6144
    v_mfma_f32_16x16x32_bf16 v[60:63], v[124:127], v[96:99], v[60:63]
    ds_read_b64_tr_b16 v[132:133], v162 offset:0
    v_mfma_f32_16x16x32_bf16 v[64:67], v[128:131], v[96:99], v[64:67]
    ds_read_b64_tr_b16 v[134:135], v162 offset:256
    s_waitcnt lgkmcnt(11)
    v_mfma_f32_16x16x32_bf16 v[4:7], v[100:103], v[68:71], v[4:7]
    ds_read_b64_tr_b16 v[116:117], v158 offset:8192
    s_waitcnt lgkmcnt(10)
    v_mfma_f32_16x16x32_bf16 v[8:11], v[104:107], v[68:71], v[8:11]
    ds_read_b64_tr_b16 v[118:119], v158 offset:9216
    s_waitcnt lgkmcnt(9)
    v_mfma_f32_16x16x32_bf16 v[12:15], v[108:111], v[68:71], v[12:15]
    ds_read_b128 v[84:87], v157 offset:0
    s_waitcnt lgkmcnt(8)
    v_mfma_f32_16x16x32_bf16 v[16:19], v[112:115], v[68:71], v[16:19]
    ds_read_b64_tr_b16 v[120:121], v159 offset:8192
    s_waitcnt lgkmcnt(4)
    v_mfma_f32_16x16x32_bf16 v[140:143], v[68:71], v[132:135], v[140:143]
    v_mfma_f32_16x16x32_bf16 v[20:23], v[100:103], v[72:75], v[20:23]
    ds_read_b64_tr_b16 v[122:123], v159 offset:9216
    v_mfma_f32_16x16x32_bf16 v[24:27], v[104:107], v[72:75], v[24:27]
    ds_read_b64_tr_b16 v[124:125], v160 offset:8192
    v_mfma_f32_16x16x32_bf16 v[28:31], v[108:111], v[72:75], v[28:31]
    ds_read_b64_tr_b16 v[126:127], v160 offset:9216
    v_mfma_f32_16x16x32_bf16 v[32:35], v[112:115], v[72:75], v[32:35]
    ds_read_b64_tr_b16 v[128:129], v161 offset:8192
    v_mfma_f32_16x16x32_bf16 v[144:147], v[72:75], v[132:135], v[144:147]
    v_mfma_f32_16x16x32_bf16 v[36:39], v[100:103], v[76:79], v[36:39]
    ds_read_b64_tr_b16 v[130:131], v161 offset:9216
    v_mfma_f32_16x16x32_bf16 v[40:43], v[104:107], v[76:79], v[40:43]
    ds_read_b128 v[88:91], v157 offset:2048
    v_mfma_f32_16x16x32_bf16 v[44:47], v[108:111], v[76:79], v[44:47]
    ds_read_b128 v[92:95], v157 offset:4096
    v_mfma_f32_16x16x32_bf16 v[48:51], v[112:115], v[76:79], v[48:51]
    ds_read_b128 v[96:99], v157 offset:6144
    v_mfma_f32_16x16x32_bf16 v[52:55], v[100:103], v[80:83], v[52:55]
    ds_read_b64_tr_b16 v[136:137], v162 offset:2048
    v_mfma_f32_16x16x32_bf16 v[56:59], v[104:107], v[80:83], v[56:59]
    ds_read_b64_tr_b16 v[138:139], v162 offset:2304
    v_mfma_f32_16x16x32_bf16 v[60:63], v[108:111], v[80:83], v[60:63]
    v_mfma_f32_16x16x32_bf16 v[64:67], v[112:115], v[80:83], v[64:67]
    s_add_u32 s58, s58, 1
    s_cmp_lt_u32 s58, 3
    s_cbranch_scc1 L_loop_AV
    s_waitcnt lgkmcnt(11)
    v_mfma_f32_16x16x32_bf16 v[4:7], v[116:119], v[84:87], v[4:7]
    s_waitcnt lgkmcnt(9)
    v_mfma_f32_16x16x32_bf16 v[8:11], v[120:123], v[84:87], v[8:11]
    s_waitcnt lgkmcnt(7)
    v_mfma_f32_16x16x32_bf16 v[12:15], v[124:127], v[84:87], v[12:15]
    s_waitcnt lgkmcnt(5)
    v_mfma_f32_16x16x32_bf16 v[16:19], v[128:131], v[84:87], v[16:19]
    s_waitcnt lgkmcnt(0)
    s_barrier
    ds_read_b64_tr_b16 v[100:101], v158 offset:16384
    ds_read_b64_tr_b16 v[102:103], v158 offset:17408
    v_mfma_f32_16x16x32_bf16 v[140:143], v[84:87], v[136:139], v[140:143]
    v_mfma_f32_16x16x32_bf16 v[20:23], v[116:119], v[88:91], v[20:23]
    ds_read_b128 v[68:71], v156 offset:16384
    v_mfma_f32_16x16x32_bf16 v[24:27], v[120:123], v[88:91], v[24:27]
    ds_read_b64_tr_b16 v[104:105], v159 offset:16384
    v_mfma_f32_16x16x32_bf16 v[28:31], v[124:127], v[88:91], v[28:31]
    ds_read_b64_tr_b16 v[106:107], v159 offset:17408
    v_mfma_f32_16x16x32_bf16 v[32:35], v[128:131], v[88:91], v[32:35]
    ds_read_b64_tr_b16 v[108:109], v160 offset:16384
    v_mfma_f32_16x16x32_bf16 v[144:147], v[88:91], v[136:139], v[144:147]
    v_mfma_f32_16x16x32_bf16 v[36:39], v[116:119], v[92:95], v[36:39]
    ds_read_b64_tr_b16 v[110:111], v160 offset:17408
    v_mfma_f32_16x16x32_bf16 v[40:43], v[120:123], v[92:95], v[40:43]
    ds_read_b64_tr_b16 v[112:113], v161 offset:16384
    v_mfma_f32_16x16x32_bf16 v[44:47], v[124:127], v[92:95], v[44:47]
    ds_read_b64_tr_b16 v[114:115], v161 offset:17408
    v_mfma_f32_16x16x32_bf16 v[48:51], v[128:131], v[92:95], v[48:51]
    ds_read_b128 v[72:75], v156 offset:18432
    v_mfma_f32_16x16x32_bf16 v[52:55], v[116:119], v[96:99], v[52:55]
    ds_read_b128 v[76:79], v156 offset:20480
    v_mfma_f32_16x16x32_bf16 v[56:59], v[120:123], v[96:99], v[56:59]
    ds_read_b128 v[80:83], v156 offset:22528
    v_mfma_f32_16x16x32_bf16 v[60:63], v[124:127], v[96:99], v[60:63]
    ds_read_b64_tr_b16 v[132:133], v162 offset:4096
    v_mfma_f32_16x16x32_bf16 v[64:67], v[128:131], v[96:99], v[64:67]
    ds_read_b64_tr_b16 v[134:135], v162 offset:4352
    s_waitcnt lgkmcnt(11)
    v_mfma_f32_16x16x32_bf16 v[4:7], v[100:103], v[68:71], v[4:7]
    ds_read_b64_tr_b16 v[116:117], v158 offset:24576
    s_waitcnt lgkmcnt(10)
    v_mfma_f32_16x16x32_bf16 v[8:11], v[104:107], v[68:71], v[8:11]
    ds_read_b64_tr_b16 v[118:119], v158 offset:25600
    s_waitcnt lgkmcnt(9)
    v_mfma_f32_16x16x32_bf16 v[12:15], v[108:111], v[68:71], v[12:15]
    ds_read_b128 v[84:87], v157 offset:16384
    s_waitcnt lgkmcnt(8)
    v_mfma_f32_16x16x32_bf16 v[16:19], v[112:115], v[68:71], v[16:19]
    ds_read_b64_tr_b16 v[120:121], v159 offset:24576
    s_waitcnt lgkmcnt(4)
    v_mfma_f32_16x16x32_bf16 v[140:143], v[68:71], v[132:135], v[140:143]
    v_mfma_f32_16x16x32_bf16 v[20:23], v[100:103], v[72:75], v[20:23]
    ds_read_b64_tr_b16 v[122:123], v159 offset:25600
    v_mfma_f32_16x16x32_bf16 v[24:27], v[104:107], v[72:75], v[24:27]
    ds_read_b64_tr_b16 v[124:125], v160 offset:24576
    v_mfma_f32_16x16x32_bf16 v[28:31], v[108:111], v[72:75], v[28:31]
    ds_read_b64_tr_b16 v[126:127], v160 offset:25600
    v_mfma_f32_16x16x32_bf16 v[32:35], v[112:115], v[72:75], v[32:35]
    ds_read_b64_tr_b16 v[128:129], v161 offset:24576
    v_mfma_f32_16x16x32_bf16 v[144:147], v[72:75], v[132:135], v[144:147]
    v_mfma_f32_16x16x32_bf16 v[36:39], v[100:103], v[76:79], v[36:39]
    ds_read_b64_tr_b16 v[130:131], v161 offset:25600
    v_mfma_f32_16x16x32_bf16 v[40:43], v[104:107], v[76:79], v[40:43]
    ds_read_b128 v[88:91], v157 offset:18432
    v_mfma_f32_16x16x32_bf16 v[44:47], v[108:111], v[76:79], v[44:47]
    ds_read_b128 v[92:95], v157 offset:20480
    v_mfma_f32_16x16x32_bf16 v[48:51], v[112:115], v[76:79], v[48:51]
    ds_read_b128 v[96:99], v157 offset:22528
    v_mfma_f32_16x16x32_bf16 v[52:55], v[100:103], v[80:83], v[52:55]
    ds_read_b64_tr_b16 v[136:137], v162 offset:6144
    v_mfma_f32_16x16x32_bf16 v[56:59], v[104:107], v[80:83], v[56:59]
    ds_read_b64_tr_b16 v[138:139], v162 offset:6400
    v_mfma_f32_16x16x32_bf16 v[60:63], v[108:111], v[80:83], v[60:63]
    v_mfma_f32_16x16x32_bf16 v[64:67], v[112:115], v[80:83], v[64:67]
    s_waitcnt lgkmcnt(11)
    v_mfma_f32_16x16x32_bf16 v[4:7], v[116:119], v[84:87], v[4:7]
    s_waitcnt lgkmcnt(9)
    v_mfma_f32_16x16x32_bf16 v[8:11], v[120:123], v[84:87], v[8:11]
    s_waitcnt lgkmcnt(7)
    v_mfma_f32_16x16x32_bf16 v[12:15], v[124:127], v[84:87], v[12:15]
    s_waitcnt lgkmcnt(5)
    v_mfma_f32_16x16x32_bf16 v[16:19], v[128:131], v[84:87], v[16:19]
    s_waitcnt lgkmcnt(0)
    s_waitcnt vmcnt(0)
    s_barrier
    ds_read_b64_tr_b16 v[100:101], v158 offset:32768
    ds_read_b64_tr_b16 v[102:103], v158 offset:33792
    v_mfma_f32_16x16x32_bf16 v[140:143], v[84:87], v[136:139], v[140:143]
    v_mfma_f32_16x16x32_bf16 v[20:23], v[116:119], v[88:91], v[20:23]
    ds_read_b128 v[68:71], v156 offset:32768
    v_mfma_f32_16x16x32_bf16 v[24:27], v[120:123], v[88:91], v[24:27]
    ds_read_b64_tr_b16 v[104:105], v159 offset:32768
    v_mfma_f32_16x16x32_bf16 v[28:31], v[124:127], v[88:91], v[28:31]
    ds_read_b64_tr_b16 v[106:107], v159 offset:33792
    v_mfma_f32_16x16x32_bf16 v[32:35], v[128:131], v[88:91], v[32:35]
    ds_read_b64_tr_b16 v[108:109], v160 offset:32768
    v_mfma_f32_16x16x32_bf16 v[144:147], v[88:91], v[136:139], v[144:147]
    v_mfma_f32_16x16x32_bf16 v[36:39], v[116:119], v[92:95], v[36:39]
    ds_read_b64_tr_b16 v[110:111], v160 offset:33792
    v_mfma_f32_16x16x32_bf16 v[40:43], v[120:123], v[92:95], v[40:43]
    ds_read_b64_tr_b16 v[112:113], v161 offset:32768
    v_mfma_f32_16x16x32_bf16 v[44:47], v[124:127], v[92:95], v[44:47]
    ds_read_b64_tr_b16 v[114:115], v161 offset:33792
    v_mfma_f32_16x16x32_bf16 v[48:51], v[128:131], v[92:95], v[48:51]
    ds_read_b128 v[72:75], v156 offset:34816
    v_mfma_f32_16x16x32_bf16 v[52:55], v[116:119], v[96:99], v[52:55]
    ds_read_b128 v[76:79], v156 offset:36864
    v_mfma_f32_16x16x32_bf16 v[56:59], v[120:123], v[96:99], v[56:59]
    ds_read_b128 v[80:83], v156 offset:38912
    v_mfma_f32_16x16x32_bf16 v[60:63], v[124:127], v[96:99], v[60:63]
    ds_read_b64_tr_b16 v[132:133], v162 offset:8192
    v_mfma_f32_16x16x32_bf16 v[64:67], v[128:131], v[96:99], v[64:67]
    ds_read_b64_tr_b16 v[134:135], v162 offset:8448
    s_waitcnt lgkmcnt(11)
    v_mfma_f32_16x16x32_bf16 v[4:7], v[100:103], v[68:71], v[4:7]
    ds_read_b64_tr_b16 v[116:117], v158 offset:40960
    s_waitcnt lgkmcnt(10)
    v_mfma_f32_16x16x32_bf16 v[8:11], v[104:107], v[68:71], v[8:11]
    ds_read_b64_tr_b16 v[118:119], v158 offset:41984
    s_waitcnt lgkmcnt(9)
    v_mfma_f32_16x16x32_bf16 v[12:15], v[108:111], v[68:71], v[12:15]
    ds_read_b128 v[84:87], v157 offset:32768
    s_waitcnt lgkmcnt(8)
    v_mfma_f32_16x16x32_bf16 v[16:19], v[112:115], v[68:71], v[16:19]
    ds_read_b64_tr_b16 v[120:121], v159 offset:40960
    s_waitcnt lgkmcnt(4)
    v_mfma_f32_16x16x32_bf16 v[140:143], v[68:71], v[132:135], v[140:143]
    v_mfma_f32_16x16x32_bf16 v[20:23], v[100:103], v[72:75], v[20:23]
    ds_read_b64_tr_b16 v[122:123], v159 offset:41984
    v_mfma_f32_16x16x32_bf16 v[24:27], v[104:107], v[72:75], v[24:27]
    ds_read_b64_tr_b16 v[124:125], v160 offset:40960
    v_mfma_f32_16x16x32_bf16 v[28:31], v[108:111], v[72:75], v[28:31]
    ds_read_b64_tr_b16 v[126:127], v160 offset:41984
    v_mfma_f32_16x16x32_bf16 v[32:35], v[112:115], v[72:75], v[32:35]
    ds_read_b64_tr_b16 v[128:129], v161 offset:40960
    v_mfma_f32_16x16x32_bf16 v[144:147], v[72:75], v[132:135], v[144:147]
    v_mfma_f32_16x16x32_bf16 v[36:39], v[100:103], v[76:79], v[36:39]
    ds_read_b64_tr_b16 v[130:131], v161 offset:41984
    v_mfma_f32_16x16x32_bf16 v[40:43], v[104:107], v[76:79], v[40:43]
    ds_read_b128 v[88:91], v157 offset:34816
    v_mfma_f32_16x16x32_bf16 v[44:47], v[108:111], v[76:79], v[44:47]
    ds_read_b128 v[92:95], v157 offset:36864
    v_mfma_f32_16x16x32_bf16 v[48:51], v[112:115], v[76:79], v[48:51]
    ds_read_b128 v[96:99], v157 offset:38912
    v_mfma_f32_16x16x32_bf16 v[52:55], v[100:103], v[80:83], v[52:55]
    ds_read_b64_tr_b16 v[136:137], v162 offset:10240
    v_mfma_f32_16x16x32_bf16 v[56:59], v[104:107], v[80:83], v[56:59]
    ds_read_b64_tr_b16 v[138:139], v162 offset:10496
    v_mfma_f32_16x16x32_bf16 v[60:63], v[108:111], v[80:83], v[60:63]
    v_mfma_f32_16x16x32_bf16 v[64:67], v[112:115], v[80:83], v[64:67]
    s_waitcnt lgkmcnt(11)
    v_mfma_f32_16x16x32_bf16 v[4:7], v[116:119], v[84:87], v[4:7]
    s_waitcnt lgkmcnt(9)
    v_mfma_f32_16x16x32_bf16 v[8:11], v[120:123], v[84:87], v[8:11]
    s_waitcnt lgkmcnt(7)
    v_mfma_f32_16x16x32_bf16 v[12:15], v[124:127], v[84:87], v[12:15]
    s_waitcnt lgkmcnt(5)
    v_mfma_f32_16x16x32_bf16 v[16:19], v[128:131], v[84:87], v[16:19]
    s_waitcnt lgkmcnt(0)
    s_barrier
    ds_read_b64_tr_b16 v[100:101], v158 offset:49152
    ds_read_b64_tr_b16 v[102:103], v158 offset:50176
    v_mfma_f32_16x16x32_bf16 v[140:143], v[84:87], v[136:139], v[140:143]
    v_mfma_f32_16x16x32_bf16 v[20:23], v[116:119], v[88:91], v[20:23]
    ds_read_b128 v[68:71], v156 offset:49152
    v_mfma_f32_16x16x32_bf16 v[24:27], v[120:123], v[88:91], v[24:27]
    ds_read_b64_tr_b16 v[104:105], v159 offset:49152
    v_mfma_f32_16x16x32_bf16 v[28:31], v[124:127], v[88:91], v[28:31]
    ds_read_b64_tr_b16 v[106:107], v159 offset:50176
    v_mfma_f32_16x16x32_bf16 v[32:35], v[128:131], v[88:91], v[32:35]
    ds_read_b64_tr_b16 v[108:109], v160 offset:49152
    v_mfma_f32_16x16x32_bf16 v[144:147], v[88:91], v[136:139], v[144:147]
    v_mfma_f32_16x16x32_bf16 v[36:39], v[116:119], v[92:95], v[36:39]
    ds_read_b64_tr_b16 v[110:111], v160 offset:50176
    v_mfma_f32_16x16x32_bf16 v[40:43], v[120:123], v[92:95], v[40:43]
    ds_read_b64_tr_b16 v[112:113], v161 offset:49152
    v_mfma_f32_16x16x32_bf16 v[44:47], v[124:127], v[92:95], v[44:47]
    ds_read_b64_tr_b16 v[114:115], v161 offset:50176
    v_mfma_f32_16x16x32_bf16 v[48:51], v[128:131], v[92:95], v[48:51]
    ds_read_b128 v[72:75], v156 offset:51200
    v_mfma_f32_16x16x32_bf16 v[52:55], v[116:119], v[96:99], v[52:55]
    ds_read_b128 v[76:79], v156 offset:53248
    v_mfma_f32_16x16x32_bf16 v[56:59], v[120:123], v[96:99], v[56:59]
    ds_read_b128 v[80:83], v156 offset:55296
    v_mfma_f32_16x16x32_bf16 v[60:63], v[124:127], v[96:99], v[60:63]
    ds_read_b64_tr_b16 v[132:133], v162 offset:12288
    v_mfma_f32_16x16x32_bf16 v[64:67], v[128:131], v[96:99], v[64:67]
    ds_read_b64_tr_b16 v[134:135], v162 offset:12544
    s_waitcnt lgkmcnt(11)
    v_mfma_f32_16x16x32_bf16 v[4:7], v[100:103], v[68:71], v[4:7]
    ds_read_b64_tr_b16 v[116:117], v158 offset:57344
    s_waitcnt lgkmcnt(10)
    v_mfma_f32_16x16x32_bf16 v[8:11], v[104:107], v[68:71], v[8:11]
    ds_read_b64_tr_b16 v[118:119], v158 offset:58368
    s_waitcnt lgkmcnt(9)
    v_mfma_f32_16x16x32_bf16 v[12:15], v[108:111], v[68:71], v[12:15]
    ds_read_b128 v[84:87], v157 offset:49152
    s_waitcnt lgkmcnt(8)
    v_mfma_f32_16x16x32_bf16 v[16:19], v[112:115], v[68:71], v[16:19]
    ds_read_b64_tr_b16 v[120:121], v159 offset:57344
    s_waitcnt lgkmcnt(4)
    v_mfma_f32_16x16x32_bf16 v[140:143], v[68:71], v[132:135], v[140:143]
    v_mfma_f32_16x16x32_bf16 v[20:23], v[100:103], v[72:75], v[20:23]
    ds_read_b64_tr_b16 v[122:123], v159 offset:58368
    v_mfma_f32_16x16x32_bf16 v[24:27], v[104:107], v[72:75], v[24:27]
    ds_read_b64_tr_b16 v[124:125], v160 offset:57344
    v_mfma_f32_16x16x32_bf16 v[28:31], v[108:111], v[72:75], v[28:31]
    ds_read_b64_tr_b16 v[126:127], v160 offset:58368
    v_mfma_f32_16x16x32_bf16 v[32:35], v[112:115], v[72:75], v[32:35]
    ds_read_b64_tr_b16 v[128:129], v161 offset:57344
    v_mfma_f32_16x16x32_bf16 v[144:147], v[72:75], v[132:135], v[144:147]
    v_mfma_f32_16x16x32_bf16 v[36:39], v[100:103], v[76:79], v[36:39]
    ds_read_b64_tr_b16 v[130:131], v161 offset:58368
    v_mfma_f32_16x16x32_bf16 v[40:43], v[104:107], v[76:79], v[40:43]
    ds_read_b128 v[88:91], v157 offset:51200
    v_mfma_f32_16x16x32_bf16 v[44:47], v[108:111], v[76:79], v[44:47]
    ds_read_b128 v[92:95], v157 offset:53248
    v_mfma_f32_16x16x32_bf16 v[48:51], v[112:115], v[76:79], v[48:51]
    ds_read_b128 v[96:99], v157 offset:55296
    v_mfma_f32_16x16x32_bf16 v[52:55], v[100:103], v[80:83], v[52:55]
    ds_read_b64_tr_b16 v[136:137], v162 offset:14336
    v_mfma_f32_16x16x32_bf16 v[56:59], v[104:107], v[80:83], v[56:59]
    ds_read_b64_tr_b16 v[138:139], v162 offset:14592
    v_mfma_f32_16x16x32_bf16 v[60:63], v[108:111], v[80:83], v[60:63]
    v_mfma_f32_16x16x32_bf16 v[64:67], v[112:115], v[80:83], v[64:67]
    s_waitcnt lgkmcnt(11)
    v_mfma_f32_16x16x32_bf16 v[4:7], v[116:119], v[84:87], v[4:7]
    s_waitcnt lgkmcnt(9)
    v_mfma_f32_16x16x32_bf16 v[8:11], v[120:123], v[84:87], v[8:11]
    s_waitcnt lgkmcnt(7)
    v_mfma_f32_16x16x32_bf16 v[12:15], v[124:127], v[84:87], v[12:15]
    s_waitcnt lgkmcnt(5)
    v_mfma_f32_16x16x32_bf16 v[16:19], v[128:131], v[84:87], v[16:19]
    s_waitcnt lgkmcnt(0)
    s_barrier
    ds_read_b64_tr_b16 v[100:101], v158 offset:0
    v_mfma_f32_16x16x32_bf16 v[140:143], v[84:87], v[136:139], v[140:143]
    v_mfma_f32_16x16x32_bf16 v[20:23], v[116:119], v[88:91], v[20:23]
    ds_read_b64_tr_b16 v[102:103], v158 offset:1024
    v_mfma_f32_16x16x32_bf16 v[24:27], v[120:123], v[88:91], v[24:27]
    ds_read_b128 v[68:71], v156 offset:0
    v_mfma_f32_16x16x32_bf16 v[28:31], v[124:127], v[88:91], v[28:31]
    ds_read_b64_tr_b16 v[104:105], v159 offset:0
    v_mfma_f32_16x16x32_bf16 v[32:35], v[128:131], v[88:91], v[32:35]
    ds_read_b64_tr_b16 v[106:107], v159 offset:1024
    v_mfma_f32_16x16x32_bf16 v[144:147], v[88:91], v[136:139], v[144:147]
    v_mfma_f32_16x16x32_bf16 v[36:39], v[116:119], v[92:95], v[36:39]
    ds_read_b64_tr_b16 v[108:109], v160 offset:0
    v_cvt_pk_bf16_f32 v148, v4, v5
    v_cvt_pk_bf16_f32 v149, v6, v7
    v_cvt_pk_bf16_f32 v150, v8, v9
    v_mfma_f32_16x16x32_bf16 v[40:43], v[120:123], v[92:95], v[40:43]
    ds_read_b64_tr_b16 v[110:111], v160 offset:1024
    v_cvt_pk_bf16_f32 v151, v10, v11
    buffer_store_dwordx4 v[148:151], v163, s[20:23], s40 offen sc1
    v_cvt_pk_bf16_f32 v152, v12, v13
    v_mfma_f32_16x16x32_bf16 v[44:47], v[124:127], v[92:95], v[44:47]
    ds_read_b64_tr_b16 v[112:113], v161 offset:0
    v_cvt_pk_bf16_f32 v153, v14, v15
    v_cvt_pk_bf16_f32 v154, v16, v17
    v_mfma_f32_16x16x32_bf16 v[48:51], v[128:131], v[92:95], v[48:51]
    ds_read_b64_tr_b16 v[114:115], v161 offset:1024
    v_cvt_pk_bf16_f32 v155, v18, v19
    buffer_store_dwordx4 v[152:155], v165, s[20:23], s40 offen sc1
    v_mfma_f32_16x16x32_bf16 v[52:55], v[116:119], v[96:99], v[52:55]
    ds_read_b128 v[72:75], v156 offset:2048
    v_cvt_pk_bf16_f32 v148, v20, v21
    v_cvt_pk_bf16_f32 v149, v22, v23
    v_cvt_pk_bf16_f32 v150, v24, v25
    v_mfma_f32_16x16x32_bf16 v[56:59], v[120:123], v[96:99], v[56:59]
    ds_read_b128 v[76:79], v156 offset:4096
    v_cvt_pk_bf16_f32 v151, v26, v27
    buffer_store_dwordx4 v[148:151], v164, s[20:23], s40 offen sc1
    v_cvt_pk_bf16_f32 v152, v28, v29
    v_mfma_f32_16x16x32_bf16 v[60:63], v[124:127], v[96:99], v[60:63]
    ds_read_b128 v[80:83], v156 offset:6144
    v_cvt_pk_bf16_f32 v153, v30, v31
    v_cvt_pk_bf16_f32 v154, v32, v33
    v_mfma_f32_16x16x32_bf16 v[64:67], v[128:131], v[96:99], v[64:67]
    v_cvt_pk_bf16_f32 v155, v34, v35
    buffer_store_dwordx4 v[152:155], v166, s[20:23], s40 offen sc1
    v_cvt_pk_bf16_f32 v132, v140, v141
    v_cvt_pk_bf16_f32 v133, v142, v143
    buffer_store_dwordx2 v[132:133], v0, s[12:15], 0 offen offset:0 sc1
    v_cvt_pk_bf16_f32 v134, v144, v145
    v_cvt_pk_bf16_f32 v135, v146, v147
    buffer_store_dwordx2 v[134:135], v0, s[12:15], 0 offen offset:1024 sc1
    v_cvt_pk_bf16_f32 v148, v36, v37
    v_cvt_pk_bf16_f32 v149, v38, v39
    v_cvt_pk_bf16_f32 v150, v40, v41
    v_cvt_pk_bf16_f32 v151, v42, v43
    buffer_store_dwordx4 v[148:151], v163, s[20:23], s41 offen sc1
    v_cvt_pk_bf16_f32 v152, v44, v45
    v_cvt_pk_bf16_f32 v153, v46, v47
    v_cvt_pk_bf16_f32 v154, v48, v49
    v_cvt_pk_bf16_f32 v155, v50, v51
    buffer_store_dwordx4 v[152:155], v165, s[20:23], s41 offen sc1
    s_nop 3
    v_cvt_pk_bf16_f32 v148, v52, v53
    v_cvt_pk_bf16_f32 v149, v54, v55
    v_cvt_pk_bf16_f32 v150, v56, v57
    v_cvt_pk_bf16_f32 v151, v58, v59
    buffer_store_dwordx4 v[148:151], v164, s[20:23], s41 offen sc1
    v_cvt_pk_bf16_f32 v152, v60, v61
    v_cvt_pk_bf16_f32 v153, v62, v63
    v_cvt_pk_bf16_f32 v154, v64, v65
    v_cvt_pk_bf16_f32 v155, v66, v67
    buffer_store_dwordx4 v[152:155], v166, s[20:23], s41 offen sc1
L_g1_A2:
    s_mov_b32 s33, 1
    s_mov_b32 s40, 0
    s_mov_b32 s41, 2048
    s_cmp_lt_u32 s35, 2
    s_mov_b32 s26, 3145728
    s_cselect_b32 s26, s26, 1048576
    s_add_u32 s20, s20, s26
    s_addc_u32 s21, s21, 0
    s_waitcnt lgkmcnt(9)
    v_mfma_f32_16x16x32_bf16 v[4:7], v[100:103], v[68:71], 0
    ds_read_b64_tr_b16 v[116:117], v158 offset:8192
    s_waitcnt lgkmcnt(8)
    v_mfma_f32_16x16x32_bf16 v[8:11], v[104:107], v[68:71], 0
    ds_read_b64_tr_b16 v[118:119], v158 offset:9216
    s_waitcnt lgkmcnt(7)
    v_mfma_f32_16x16x32_bf16 v[12:15], v[108:111], v[68:71], 0
    ds_read_b128 v[84:87], v157 offset:0
    s_waitcnt lgkmcnt(6)
    v_mfma_f32_16x16x32_bf16 v[16:19], v[112:115], v[68:71], 0
    ds_read_b64_tr_b16 v[120:121], v159 offset:8192
    s_waitcnt lgkmcnt(6)
    v_mfma_f32_16x16x32_bf16 v[20:23], v[100:103], v[72:75], 0
    ds_read_b64_tr_b16 v[122:123], v159 offset:9216
    v_mfma_f32_16x16x32_bf16 v[24:27], v[104:107], v[72:75], 0
    ds_read_b64_tr_b16 v[124:125], v160 offset:8192
    v_mfma_f32_16x16x32_bf16 v[28:31], v[108:111], v[72:75], 0
    ds_read_b64_tr_b16 v[126:127], v160 offset:9216
    v_mfma_f32_16x16x32_bf16 v[32:35], v[112:115], v[72:75], 0
    ds_read_b64_tr_b16 v[128:129], v161 offset:8192
    s_waitcnt lgkmcnt(9)
    v_mfma_f32_16x16x32_bf16 v[36:39], v[100:103], v[76:79], 0
    ds_read_b64_tr_b16 v[130:131], v161 offset:9216
    v_mfma_f32_16x16x32_bf16 v[40:43], v[104:107], v[76:79], 0
    ds_read_b128 v[88:91], v157 offset:2048
    v_mfma_f32_16x16x32_bf16 v[44:47], v[108:111], v[76:79], 0
    ds_read_b128 v[92:95], v157 offset:4096
    v_mfma_f32_16x16x32_bf16 v[48:51], v[112:115], v[76:79], 0
    ds_read_b128 v[96:99], v157 offset:6144
    s_waitcnt lgkmcnt(12)
    v_mfma_f32_16x16x32_bf16 v[52:55], v[100:103], v[80:83], 0
    v_mfma_f32_16x16x32_bf16 v[56:59], v[104:107], v[80:83], 0
    v_mfma_f32_16x16x32_bf16 v[60:63], v[108:111], v[80:83], 0
    v_mfma_f32_16x16x32_bf16 v[64:67], v[112:115], v[80:83], 0
    s_mov_b32 s58, 0
.p2align 6
L_loop_A:
    s_waitcnt lgkmcnt(9)
    v_mfma_f32_16x16x32_bf16 v[4:7], v[116:119], v[84:87], v[4:7]
    s_waitcnt lgkmcnt(7)
    v_mfma_f32_16x16x32_bf16 v[8:11], v[120:123], v[84:87], v[8:11]
    s_waitcnt lgkmcnt(5)
    v_mfma_f32_16x16x32_bf16 v[12:15], v[124:127], v[84:87], v[12:15]
    s_waitcnt lgkmcnt(3)
    v_mfma_f32_16x16x32_bf16 v[16:19], v[128:131], v[84:87], v[16:19]
    s_waitcnt lgkmcnt(0)
    s_barrier
    ds_read_b64_tr_b16 v[100:101], v158 offset:16384
    v_mfma_f32_16x16x32_bf16 v[20:23], v[116:119], v[88:91], v[20:23]
    ds_read_b64_tr_b16 v[102:103], v158 offset:17408
    v_mfma_f32_16x16x32_bf16 v[24:27], v[120:123], v[88:91], v[24:27]
    ds_read_b128 v[68:71], v156 offset:16384
    v_mfma_f32_16x16x32_bf16 v[28:31], v[124:127], v[88:91], v[28:31]
    ds_read_b64_tr_b16 v[104:105], v159 offset:16384
    v_mfma_f32_16x16x32_bf16 v[32:35], v[128:131], v[88:91], v[32:35]
    ds_read_b64_tr_b16 v[106:107], v159 offset:17408
    v_mfma_f32_16x16x32_bf16 v[36:39], v[116:119], v[92:95], v[36:39]
    ds_read_b64_tr_b16 v[108:109], v160 offset:16384
    v_mfma_f32_16x16x32_bf16 v[40:43], v[120:123], v[92:95], v[40:43]
    ds_read_b64_tr_b16 v[110:111], v160 offset:17408
    v_mfma_f32_16x16x32_bf16 v[44:47], v[124:127], v[92:95], v[44:47]
    ds_read_b64_tr_b16 v[112:113], v161 offset:16384
    v_mfma_f32_16x16x32_bf16 v[48:51], v[128:131], v[92:95], v[48:51]
    ds_read_b64_tr_b16 v[114:115], v161 offset:17408
    v_mfma_f32_16x16x32_bf16 v[52:55], v[116:119], v[96:99], v[52:55]
    ds_read_b128 v[72:75], v156 offset:18432
    v_mfma_f32_16x16x32_bf16 v[56:59], v[120:123], v[96:99], v[56:59]
    ds_read_b128 v[76:79], v156 offset:20480
    v_mfma_f32_16x16x32_bf16 v[60:63], v[124:127], v[96:99], v[60:63]
    ds_read_b128 v[80:83], v156 offset:22528
    v_mfma_f32_16x16x32_bf16 v[64:67], v[128:131], v[96:99], v[64:67]
    s_waitcnt lgkmcnt(9)
    v_mfma_f32_16x16x32_bf16 v[4:7], v[100:103], v[68:71], v[4:7]
    ds_read_b64_tr_b16 v[116:117], v158 offset:24576
    s_waitcnt lgkmcnt(8)
    v_mfma_f32_16x16x32_bf16 v[8:11], v[104:107], v[68:71], v[8:11]
    ds_read_b64_tr_b16 v[118:119], v158 offset:25600
    s_waitcnt lgkmcnt(7)
    v_mfma_f32_16x16x32_bf16 v[12:15], v[108:111], v[68:71], v[12:15]
    ds_read_b128 v[84:87], v157 offset:16384
    s_waitcnt lgkmcnt(6)
    v_mfma_f32_16x16x32_bf16 v[16:19], v[112:115], v[68:71], v[16:19]
    ds_read_b64_tr_b16 v[120:121], v159 offset:24576
    s_waitcnt lgkmcnt(6)
    v_mfma_f32_16x16x32_bf16 v[20:23], v[100:103], v[72:75], v[20:23]
    ds_read_b64_tr_b16 v[122:123], v159 offset:25600
    v_mfma_f32_16x16x32_bf16 v[24:27], v[104:107], v[72:75], v[24:27]
    ds_read_b64_tr_b16 v[124:125], v160 offset:24576
    v_mfma_f32_16x16x32_bf16 v[28:31], v[108:111], v[72:75], v[28:31]
    ds_read_b64_tr_b16 v[126:127], v160 offset:25600
    v_mfma_f32_16x16x32_bf16 v[32:35], v[112:115], v[72:75], v[32:35]
    ds_read_b64_tr_b16 v[128:129], v161 offset:24576
    s_waitcnt lgkmcnt(9)
    v_mfma_f32_16x16x32_bf16 v[36:39], v[100:103], v[76:79], v[36:39]
    ds_read_b64_tr_b16 v[130:131], v161 offset:25600
    v_mfma_f32_16x16x32_bf16 v[40:43], v[104:107], v[76:79], v[40:43]
    ds_read_b128 v[88:91], v157 offset:18432
    v_mfma_f32_16x16x32_bf16 v[44:47], v[108:111], v[76:79], v[44:47]
    ds_read_b128 v[92:95], v157 offset:20480
    v_mfma_f32_16x16x32_bf16 v[48:51], v[112:115], v[76:79], v[48:51]
    ds_read_b128 v[96:99], v157 offset:22528
    s_waitcnt lgkmcnt(12)
    v_mfma_f32_16x16x32_bf16 v[52:55], v[100:103], v[80:83], v[52:55]
    v_mfma_f32_16x16x32_bf16 v[56:59], v[104:107], v[80:83], v[56:59]
    v_mfma_f32_16x16x32_bf16 v[60:63], v[108:111], v[80:83], v[60:63]
    v_mfma_f32_16x16x32_bf16 v[64:67], v[112:115], v[80:83], v[64:67]
    s_waitcnt lgkmcnt(9)
    v_mfma_f32_16x16x32_bf16 v[4:7], v[116:119], v[84:87], v[4:7]
    s_waitcnt lgkmcnt(7)
    v_mfma_f32_16x16x32_bf16 v[8:11], v[120:123], v[84:87], v[8:11]
    s_waitcnt lgkmcnt(5)
    v_mfma_f32_16x16x32_bf16 v[12:15], v[124:127], v[84:87], v[12:15]
    s_waitcnt lgkmcnt(3)
    v_mfma_f32_16x16x32_bf16 v[16:19], v[128:131], v[84:87], v[16:19]
    s_waitcnt lgkmcnt(0)
    s_waitcnt vmcnt(0)
    s_barrier
    ds_read_b64_tr_b16 v[100:101], v158 offset:32768
    v_mfma_f32_16x16x32_bf16 v[20:23], v[116:119], v[88:91], v[20:23]
    ds_read_b64_tr_b16 v[102:103], v158 offset:33792
    v_mfma_f32_16x16x32_bf16 v[24:27], v[120:123], v[88:91], v[24:27]
    ds_read_b128 v[68:71], v156 offset:32768
    v_mfma_f32_16x16x32_bf16 v[28:31], v[124:127], v[88:91], v[28:31]
    ds_read_b64_tr_b16 v[104:105], v159 offset:32768
    v_mfma_f32_16x16x32_bf16 v[32:35], v[128:131], v[88:91], v[32:35]
    ds_read_b64_tr_b16 v[106:107], v159 offset:33792
    v_mfma_f32_16x16x32_bf16 v[36:39], v[116:119], v[92:95], v[36:39]
    ds_read_b64_tr_b16 v[108:109], v160 offset:32768
    v_mfma_f32_16x16x32_bf16 v[40:43], v[120:123], v[92:95], v[40:43]
    ds_read_b64_tr_b16 v[110:111], v160 offset:33792
    v_mfma_f32_16x16x32_bf16 v[44:47], v[124:127], v[92:95], v[44:47]
    ds_read_b64_tr_b16 v[112:113], v161 offset:32768
    v_mfma_f32_16x16x32_bf16 v[48:51], v[128:131], v[92:95], v[48:51]
    ds_read_b64_tr_b16 v[114:115], v161 offset:33792
    v_mfma_f32_16x16x32_bf16 v[52:55], v[116:119], v[96:99], v[52:55]
    ds_read_b128 v[72:75], v156 offset:34816
    v_mfma_f32_16x16x32_bf16 v[56:59], v[120:123], v[96:99], v[56:59]
    ds_read_b128 v[76:79], v156 offset:36864
    v_mfma_f32_16x16x32_bf16 v[60:63], v[124:127], v[96:99], v[60:63]
    ds_read_b128 v[80:83], v156 offset:38912
    v_mfma_f32_16x16x32_bf16 v[64:67], v[128:131], v[96:99], v[64:67]
    s_waitcnt lgkmcnt(9)
    v_mfma_f32_16x16x32_bf16 v[4:7], v[100:103], v[68:71], v[4:7]
    ds_read_b64_tr_b16 v[116:117], v158 offset:40960
    s_waitcnt lgkmcnt(8)
    v_mfma_f32_16x16x32_bf16 v[8:11], v[104:107], v[68:71], v[8:11]
    ds_read_b64_tr_b16 v[118:119], v158 offset:41984
    s_waitcnt lgkmcnt(7)
    v_mfma_f32_16x16x32_bf16 v[12:15], v[108:111], v[68:71], v[12:15]
    ds_read_b128 v[84:87], v157 offset:32768
    s_waitcnt lgkmcnt(6)
    v_mfma_f32_16x16x32_bf16 v[16:19], v[112:115], v[68:71], v[16:19]
    ds_read_b64_tr_b16 v[120:121], v159 offset:40960
    s_waitcnt lgkmcnt(6)
    v_mfma_f32_16x16x32_bf16 v[20:23], v[100:103], v[72:75], v[20:23]
    ds_read_b64_tr_b16 v[122:123], v159 offset:41984
    v_mfma_f32_16x16x32_bf16 v[24:27], v[104:107], v[72:75], v[24:27]
    ds_read_b64_tr_b16 v[124:125], v160 offset:40960
    v_mfma_f32_16x16x32_bf16 v[28:31], v[108:111], v[72:75], v[28:31]
    ds_read_b64_tr_b16 v[126:127], v160 offset:41984
    v_mfma_f32_16x16x32_bf16 v[32:35], v[112:115], v[72:75], v[32:35]
    ds_read_b64_tr_b16 v[128:129], v161 offset:40960
    s_waitcnt lgkmcnt(9)
    v_mfma_f32_16x16x32_bf16 v[36:39], v[100:103], v[76:79], v[36:39]
    ds_read_b64_tr_b16 v[130:131], v161 offset:41984
    v_mfma_f32_16x16x32_bf16 v[40:43], v[104:107], v[76:79], v[40:43]
    ds_read_b128 v[88:91], v157 offset:34816
    v_mfma_f32_16x16x32_bf16 v[44:47], v[108:111], v[76:79], v[44:47]
    ds_read_b128 v[92:95], v157 offset:36864
    v_mfma_f32_16x16x32_bf16 v[48:51], v[112:115], v[76:79], v[48:51]
    ds_read_b128 v[96:99], v157 offset:38912
    s_waitcnt lgkmcnt(12)
    v_mfma_f32_16x16x32_bf16 v[52:55], v[100:103], v[80:83], v[52:55]
    v_mfma_f32_16x16x32_bf16 v[56:59], v[104:107], v[80:83], v[56:59]
    v_mfma_f32_16x16x32_bf16 v[60:63], v[108:111], v[80:83], v[60:63]
    v_mfma_f32_16x16x32_bf16 v[64:67], v[112:115], v[80:83], v[64:67]
    s_waitcnt lgkmcnt(9)
    v_mfma_f32_16x16x32_bf16 v[4:7], v[116:119], v[84:87], v[4:7]
    s_waitcnt lgkmcnt(7)
    v_mfma_f32_16x16x32_bf16 v[8:11], v[120:123], v[84:87], v[8:11]
    s_waitcnt lgkmcnt(5)
    v_mfma_f32_16x16x32_bf16 v[12:15], v[124:127], v[84:87], v[12:15]
    s_waitcnt lgkmcnt(3)
    v_mfma_f32_16x16x32_bf16 v[16:19], v[128:131], v[84:87], v[16:19]
    s_waitcnt lgkmcnt(0)
    s_barrier
    ds_read_b64_tr_b16 v[100:101], v158 offset:49152
    v_mfma_f32_16x16x32_bf16 v[20:23], v[116:119], v[88:91], v[20:23]
    ds_read_b64_tr_b16 v[102:103], v158 offset:50176
    v_mfma_f32_16x16x32_bf16 v[24:27], v[120:123], v[88:91], v[24:27]
    ds_read_b128 v[68:71], v156 offset:49152
    v_mfma_f32_16x16x32_bf16 v[28:31], v[124:127], v[88:91], v[28:31]
    ds_read_b64_tr_b16 v[104:105], v159 offset:49152
    v_mfma_f32_16x16x32_bf16 v[32:35], v[128:131], v[88:91], v[32:35]
    ds_read_b64_tr_b16 v[106:107], v159 offset:50176
    v_mfma_f32_16x16x32_bf16 v[36:39], v[116:119], v[92:95], v[36:39]
    ds_read_b64_tr_b16 v[108:109], v160 offset:49152
    v_mfma_f32_16x16x32_bf16 v[40:43], v[120:123], v[92:95], v[40:43]
    ds_read_b64_tr_b16 v[110:111], v160 offset:50176
    v_mfma_f32_16x16x32_bf16 v[44:47], v[124:127], v[92:95], v[44:47]
    ds_read_b64_tr_b16 v[112:113], v161 offset:49152
    v_mfma_f32_16x16x32_bf16 v[48:51], v[128:131], v[92:95], v[48:51]
    ds_read_b64_tr_b16 v[114:115], v161 offset:50176
    v_mfma_f32_16x16x32_bf16 v[52:55], v[116:119], v[96:99], v[52:55]
    ds_read_b128 v[72:75], v156 offset:51200
    v_mfma_f32_16x16x32_bf16 v[56:59], v[120:123], v[96:99], v[56:59]
    ds_read_b128 v[76:79], v156 offset:53248
    v_mfma_f32_16x16x32_bf16 v[60:63], v[124:127], v[96:99], v[60:63]
    ds_read_b128 v[80:83], v156 offset:55296
    v_mfma_f32_16x16x32_bf16 v[64:67], v[128:131], v[96:99], v[64:67]
    s_waitcnt lgkmcnt(9)
    v_mfma_f32_16x16x32_bf16 v[4:7], v[100:103], v[68:71], v[4:7]
    ds_read_b64_tr_b16 v[116:117], v158 offset:57344
    s_waitcnt lgkmcnt(8)
    v_mfma_f32_16x16x32_bf16 v[8:11], v[104:107], v[68:71], v[8:11]
    ds_read_b64_tr_b16 v[118:119], v158 offset:58368
    s_waitcnt lgkmcnt(7)
    v_mfma_f32_16x16x32_bf16 v[12:15], v[108:111], v[68:71], v[12:15]
    ds_read_b128 v[84:87], v157 offset:49152
    s_waitcnt lgkmcnt(6)
    v_mfma_f32_16x16x32_bf16 v[16:19], v[112:115], v[68:71], v[16:19]
    ds_read_b64_tr_b16 v[120:121], v159 offset:57344
    s_waitcnt lgkmcnt(6)
    v_mfma_f32_16x16x32_bf16 v[20:23], v[100:103], v[72:75], v[20:23]
    ds_read_b64_tr_b16 v[122:123], v159 offset:58368
    v_mfma_f32_16x16x32_bf16 v[24:27], v[104:107], v[72:75], v[24:27]
    ds_read_b64_tr_b16 v[124:125], v160 offset:57344
    v_mfma_f32_16x16x32_bf16 v[28:31], v[108:111], v[72:75], v[28:31]
    ds_read_b64_tr_b16 v[126:127], v160 offset:58368
    v_mfma_f32_16x16x32_bf16 v[32:35], v[112:115], v[72:75], v[32:35]
    ds_read_b64_tr_b16 v[128:129], v161 offset:57344
    s_waitcnt lgkmcnt(9)
    v_mfma_f32_16x16x32_bf16 v[36:39], v[100:103], v[76:79], v[36:39]
    ds_read_b64_tr_b16 v[130:131], v161 offset:58368
    v_mfma_f32_16x16x32_bf16 v[40:43], v[104:107], v[76:79], v[40:43]
    ds_read_b128 v[88:91], v157 offset:51200
    v_mfma_f32_16x16x32_bf16 v[44:47], v[108:111], v[76:79], v[44:47]
    ds_read_b128 v[92:95], v157 offset:53248
    v_mfma_f32_16x16x32_bf16 v[48:51], v[112:115], v[76:79], v[48:51]
    ds_read_b128 v[96:99], v157 offset:55296
    s_waitcnt lgkmcnt(12)
    v_mfma_f32_16x16x32_bf16 v[52:55], v[100:103], v[80:83], v[52:55]
    v_mfma_f32_16x16x32_bf16 v[56:59], v[104:107], v[80:83], v[56:59]
    v_mfma_f32_16x16x32_bf16 v[60:63], v[108:111], v[80:83], v[60:63]
    v_mfma_f32_16x16x32_bf16 v[64:67], v[112:115], v[80:83], v[64:67]
    s_waitcnt lgkmcnt(9)
    v_mfma_f32_16x16x32_bf16 v[4:7], v[116:119], v[84:87], v[4:7]
    s_waitcnt lgkmcnt(7)
    v_mfma_f32_16x16x32_bf16 v[8:11], v[120:123], v[84:87], v[8:11]
    s_waitcnt lgkmcnt(5)
    v_mfma_f32_16x16x32_bf16 v[12:15], v[124:127], v[84:87], v[12:15]
    s_waitcnt lgkmcnt(3)
    v_mfma_f32_16x16x32_bf16 v[16:19], v[128:131], v[84:87], v[16:19]
    s_waitcnt lgkmcnt(0)
    s_barrier
    ds_read_b64_tr_b16 v[100:101], v158 offset:0
    v_mfma_f32_16x16x32_bf16 v[20:23], v[116:119], v[88:91], v[20:23]
    ds_read_b64_tr_b16 v[102:103], v158 offset:1024
    v_mfma_f32_16x16x32_bf16 v[24:27], v[120:123], v[88:91], v[24:27]
    ds_read_b128 v[68:71], v156 offset:0
    v_mfma_f32_16x16x32_bf16 v[28:31], v[124:127], v[88:91], v[28:31]
    ds_read_b64_tr_b16 v[104:105], v159 offset:0
    v_mfma_f32_16x16x32_bf16 v[32:35], v[128:131], v[88:91], v[32:35]
    ds_read_b64_tr_b16 v[106:107], v159 offset:1024
    v_mfma_f32_16x16x32_bf16 v[36:39], v[116:119], v[92:95], v[36:39]
    ds_read_b64_tr_b16 v[108:109], v160 offset:0
    v_mfma_f32_16x16x32_bf16 v[40:43], v[120:123], v[92:95], v[40:43]
    ds_read_b64_tr_b16 v[110:111], v160 offset:1024
    v_mfma_f32_16x16x32_bf16 v[44:47], v[124:127], v[92:95], v[44:47]
    ds_read_b64_tr_b16 v[112:113], v161 offset:0
    v_mfma_f32_16x16x32_bf16 v[48:51], v[128:131], v[92:95], v[48:51]
    ds_read_b64_tr_b16 v[114:115], v161 offset:1024
    v_mfma_f32_16x16x32_bf16 v[52:55], v[116:119], v[96:99], v[52:55]
    ds_read_b128 v[72:75], v156 offset:2048
    v_mfma_f32_16x16x32_bf16 v[56:59], v[120:123], v[96:99], v[56:59]
    ds_read_b128 v[76:79], v156 offset:4096
    v_mfma_f32_16x16x32_bf16 v[60:63], v[124:127], v[96:99], v[60:63]
    ds_read_b128 v[80:83], v156 offset:6144
    v_mfma_f32_16x16x32_bf16 v[64:67], v[128:131], v[96:99], v[64:67]
    s_waitcnt lgkmcnt(9)
    v_mfma_f32_16x16x32_bf16 v[4:7], v[100:103], v[68:71], v[4:7]
    ds_read_b64_tr_b16 v[116:117], v158 offset:8192
    s_waitcnt lgkmcnt(8)
    v_mfma_f32_16x16x32_bf16 v[8:11], v[104:107], v[68:71], v[8:11]
    ds_read_b64_tr_b16 v[118:119], v158 offset:9216
    s_waitcnt lgkmcnt(7)
    v_mfma_f32_16x16x32_bf16 v[12:15], v[108:111], v[68:71], v[12:15]
    ds_read_b128 v[84:87], v157 offset:0
    s_waitcnt lgkmcnt(6)
    v_mfma_f32_16x16x32_bf16 v[16:19], v[112:115], v[68:71], v[16:19]
    ds_read_b64_tr_b16 v[120:121], v159 offset:8192
    s_waitcnt lgkmcnt(6)
    v_mfma_f32_16x16x32_bf16 v[20:23], v[100:103], v[72:75], v[20:23]
    ds_read_b64_tr_b16 v[122:123], v159 offset:9216
    v_mfma_f32_16x16x32_bf16 v[24:27], v[104:107], v[72:75], v[24:27]
    ds_read_b64_tr_b16 v[124:125], v160 offset:8192
    v_mfma_f32_16x16x32_bf16 v[28:31], v[108:111], v[72:75], v[28:31]
    ds_read_b64_tr_b16 v[126:127], v160 offset:9216
    v_mfma_f32_16x16x32_bf16 v[32:35], v[112:115], v[72:75], v[32:35]
    ds_read_b64_tr_b16 v[128:129], v161 offset:8192
    s_waitcnt lgkmcnt(9)
    v_mfma_f32_16x16x32_bf16 v[36:39], v[100:103], v[76:79], v[36:39]
    ds_read_b64_tr_b16 v[130:131], v161 offset:9216
    v_mfma_f32_16x16x32_bf16 v[40:43], v[104:107], v[76:79], v[40:43]
    ds_read_b128 v[88:91], v157 offset:2048
    v_mfma_f32_16x16x32_bf16 v[44:47], v[108:111], v[76:79], v[44:47]
    ds_read_b128 v[92:95], v157 offset:4096
    v_mfma_f32_16x16x32_bf16 v[48:51], v[112:115], v[76:79], v[48:51]
    ds_read_b128 v[96:99], v157 offset:6144
    s_waitcnt lgkmcnt(12)
    v_mfma_f32_16x16x32_bf16 v[52:55], v[100:103], v[80:83], v[52:55]
    v_mfma_f32_16x16x32_bf16 v[56:59], v[104:107], v[80:83], v[56:59]
    v_mfma_f32_16x16x32_bf16 v[60:63], v[108:111], v[80:83], v[60:63]
    v_mfma_f32_16x16x32_bf16 v[64:67], v[112:115], v[80:83], v[64:67]
    s_add_u32 s58, s58, 1
    s_cmp_lt_u32 s58, 3
    s_cbranch_scc1 L_loop_A
    s_waitcnt lgkmcnt(9)
    v_mfma_f32_16x16x32_bf16 v[4:7], v[116:119], v[84:87], v[4:7]
    s_waitcnt lgkmcnt(7)
    v_mfma_f32_16x16x32_bf16 v[8:11], v[120:123], v[84:87], v[8:11]
    s_waitcnt lgkmcnt(5)
    v_mfma_f32_16x16x32_bf16 v[12:15], v[124:127], v[84:87], v[12:15]
    s_waitcnt lgkmcnt(3)
    v_mfma_f32_16x16x32_bf16 v[16:19], v[128:131], v[84:87], v[16:19]
    s_waitcnt lgkmcnt(0)
    s_barrier
    ds_read_b64_tr_b16 v[100:101], v158 offset:16384
    v_mfma_f32_16x16x32_bf16 v[20:23], v[116:119], v[88:91], v[20:23]
    ds_read_b64_tr_b16 v[102:103], v158 offset:17408
    v_mfma_f32_16x16x32_bf16 v[24:27], v[120:123], v[88:91], v[24:27]
    ds_read_b128 v[68:71], v156 offset:16384
    v_mfma_f32_16x16x32_bf16 v[28:31], v[124:127], v[88:91], v[28:31]
    ds_read_b64_tr_b16 v[104:105], v159 offset:16384
    v_mfma_f32_16x16x32_bf16 v[32:35], v[128:131], v[88:91], v[32:35]
    ds_read_b64_tr_b16 v[106:107], v159 offset:17408
    v_mfma_f32_16x16x32_bf16 v[36:39], v[116:119], v[92:95], v[36:39]
    ds_read_b64_tr_b16 v[108:109], v160 offset:16384
    v_mfma_f32_16x16x32_bf16 v[40:43], v[120:123], v[92:95], v[40:43]
    ds_read_b64_tr_b16 v[110:111], v160 offset:17408
    v_mfma_f32_16x16x32_bf16 v[44:47], v[124:127], v[92:95], v[44:47]
    ds_read_b64_tr_b16 v[112:113], v161 offset:16384
    v_mfma_f32_16x16x32_bf16 v[48:51], v[128:131], v[92:95], v[48:51]
    ds_read_b64_tr_b16 v[114:115], v161 offset:17408
    v_mfma_f32_16x16x32_bf16 v[52:55], v[116:119], v[96:99], v[52:55]
    ds_read_b128 v[72:75], v156 offset:18432
    v_mfma_f32_16x16x32_bf16 v[56:59], v[120:123], v[96:99], v[56:59]
    ds_read_b128 v[76:79], v156 offset:20480
    v_mfma_f32_16x16x32_bf16 v[60:63], v[124:127], v[96:99], v[60:63]
    ds_read_b128 v[80:83], v156 offset:22528
    v_mfma_f32_16x16x32_bf16 v[64:67], v[128:131], v[96:99], v[64:67]
    s_waitcnt lgkmcnt(9)
    v_mfma_f32_16x16x32_bf16 v[4:7], v[100:103], v[68:71], v[4:7]
    ds_read_b64_tr_b16 v[116:117], v158 offset:24576
    s_waitcnt lgkmcnt(8)
    v_mfma_f32_16x16x32_bf16 v[8:11], v[104:107], v[68:71], v[8:11]
    ds_read_b64_tr_b16 v[118:119], v158 offset:25600
    s_waitcnt lgkmcnt(7)
    v_mfma_f32_16x16x32_bf16 v[12:15], v[108:111], v[68:71], v[12:15]
    ds_read_b128 v[84:87], v157 offset:16384
    s_waitcnt lgkmcnt(6)
    v_mfma_f32_16x16x32_bf16 v[16:19], v[112:115], v[68:71], v[16:19]
    ds_read_b64_tr_b16 v[120:121], v159 offset:24576
    s_waitcnt lgkmcnt(6)
    v_mfma_f32_16x16x32_bf16 v[20:23], v[100:103], v[72:75], v[20:23]
    ds_read_b64_tr_b16 v[122:123], v159 offset:25600
    v_mfma_f32_16x16x32_bf16 v[24:27], v[104:107], v[72:75], v[24:27]
    ds_read_b64_tr_b16 v[124:125], v160 offset:24576
    v_mfma_f32_16x16x32_bf16 v[28:31], v[108:111], v[72:75], v[28:31]
    ds_read_b64_tr_b16 v[126:127], v160 offset:25600
    v_mfma_f32_16x16x32_bf16 v[32:35], v[112:115], v[72:75], v[32:35]
    ds_read_b64_tr_b16 v[128:129], v161 offset:24576
    s_waitcnt lgkmcnt(9)
    v_mfma_f32_16x16x32_bf16 v[36:39], v[100:103], v[76:79], v[36:39]
    ds_read_b64_tr_b16 v[130:131], v161 offset:25600
    v_mfma_f32_16x16x32_bf16 v[40:43], v[104:107], v[76:79], v[40:43]
    ds_read_b128 v[88:91], v157 offset:18432
    v_mfma_f32_16x16x32_bf16 v[44:47], v[108:111], v[76:79], v[44:47]
    ds_read_b128 v[92:95], v157 offset:20480
    v_mfma_f32_16x16x32_bf16 v[48:51], v[112:115], v[76:79], v[48:51]
    ds_read_b128 v[96:99], v157 offset:22528
    s_waitcnt lgkmcnt(12)
    v_mfma_f32_16x16x32_bf16 v[52:55], v[100:103], v[80:83], v[52:55]
    v_mfma_f32_16x16x32_bf16 v[56:59], v[104:107], v[80:83], v[56:59]
    v_mfma_f32_16x16x32_bf16 v[60:63], v[108:111], v[80:83], v[60:63]
    v_mfma_f32_16x16x32_bf16 v[64:67], v[112:115], v[80:83], v[64:67]
    s_waitcnt lgkmcnt(9)
    v_mfma_f32_16x16x32_bf16 v[4:7], v[116:119], v[84:87], v[4:7]
    s_waitcnt lgkmcnt(7)
    v_mfma_f32_16x16x32_bf16 v[8:11], v[120:123], v[84:87], v[8:11]
    s_waitcnt lgkmcnt(5)
    v_mfma_f32_16x16x32_bf16 v[12:15], v[124:127], v[84:87], v[12:15]
    s_waitcnt lgkmcnt(3)
    v_mfma_f32_16x16x32_bf16 v[16:19], v[128:131], v[84:87], v[16:19]
    s_waitcnt lgkmcnt(0)
    s_waitcnt vmcnt(0)
    s_barrier
    ds_read_b64_tr_b16 v[100:101], v158 offset:32768
    v_mfma_f32_16x16x32_bf16 v[20:23], v[116:119], v[88:91], v[20:23]
    ds_read_b64_tr_b16 v[102:103], v158 offset:33792
    v_mfma_f32_16x16x32_bf16 v[24:27], v[120:123], v[88:91], v[24:27]
    ds_read_b128 v[68:71], v156 offset:32768
    v_mfma_f32_16x16x32_bf16 v[28:31], v[124:127], v[88:91], v[28:31]
    ds_read_b64_tr_b16 v[104:105], v159 offset:32768
    v_mfma_f32_16x16x32_bf16 v[32:35], v[128:131], v[88:91], v[32:35]
    ds_read_b64_tr_b16 v[106:107], v159 offset:33792
    v_mfma_f32_16x16x32_bf16 v[36:39], v[116:119], v[92:95], v[36:39]
    ds_read_b64_tr_b16 v[108:109], v160 offset:32768
    v_mfma_f32_16x16x32_bf16 v[40:43], v[120:123], v[92:95], v[40:43]
    ds_read_b64_tr_b16 v[110:111], v160 offset:33792
    v_mfma_f32_16x16x32_bf16 v[44:47], v[124:127], v[92:95], v[44:47]
    ds_read_b64_tr_b16 v[112:113], v161 offset:32768
    v_mfma_f32_16x16x32_bf16 v[48:51], v[128:131], v[92:95], v[48:51]
    ds_read_b64_tr_b16 v[114:115], v161 offset:33792
    v_mfma_f32_16x16x32_bf16 v[52:55], v[116:119], v[96:99], v[52:55]
    ds_read_b128 v[72:75], v156 offset:34816
    v_mfma_f32_16x16x32_bf16 v[56:59], v[120:123], v[96:99], v[56:59]
    ds_read_b128 v[76:79], v156 offset:36864
    v_mfma_f32_16x16x32_bf16 v[60:63], v[124:127], v[96:99], v[60:63]
    ds_read_b128 v[80:83], v156 offset:38912
    v_mfma_f32_16x16x32_bf16 v[64:67], v[128:131], v[96:99], v[64:67]
    s_waitcnt lgkmcnt(9)
    v_mfma_f32_16x16x32_bf16 v[4:7], v[100:103], v[68:71], v[4:7]
    ds_read_b64_tr_b16 v[116:117], v158 offset:40960
    s_waitcnt lgkmcnt(8)
    v_mfma_f32_16x16x32_bf16 v[8:11], v[104:107], v[68:71], v[8:11]
    ds_read_b64_tr_b16 v[118:119], v158 offset:41984
    s_waitcnt lgkmcnt(7)
    v_mfma_f32_16x16x32_bf16 v[12:15], v[108:111], v[68:71], v[12:15]
    ds_read_b128 v[84:87], v157 offset:32768
    s_waitcnt lgkmcnt(6)
    v_mfma_f32_16x16x32_bf16 v[16:19], v[112:115], v[68:71], v[16:19]
    ds_read_b64_tr_b16 v[120:121], v159 offset:40960
    s_waitcnt lgkmcnt(6)
    v_mfma_f32_16x16x32_bf16 v[20:23], v[100:103], v[72:75], v[20:23]
    ds_read_b64_tr_b16 v[122:123], v159 offset:41984
    v_mfma_f32_16x16x32_bf16 v[24:27], v[104:107], v[72:75], v[24:27]
    ds_read_b64_tr_b16 v[124:125], v160 offset:40960
    v_mfma_f32_16x16x32_bf16 v[28:31], v[108:111], v[72:75], v[28:31]
    ds_read_b64_tr_b16 v[126:127], v160 offset:41984
    v_mfma_f32_16x16x32_bf16 v[32:35], v[112:115], v[72:75], v[32:35]
    ds_read_b64_tr_b16 v[128:129], v161 offset:40960
    s_waitcnt lgkmcnt(9)
    v_mfma_f32_16x16x32_bf16 v[36:39], v[100:103], v[76:79], v[36:39]
    ds_read_b64_tr_b16 v[130:131], v161 offset:41984
    v_mfma_f32_16x16x32_bf16 v[40:43], v[104:107], v[76:79], v[40:43]
    ds_read_b128 v[88:91], v157 offset:34816
    v_mfma_f32_16x16x32_bf16 v[44:47], v[108:111], v[76:79], v[44:47]
    ds_read_b128 v[92:95], v157 offset:36864
    v_mfma_f32_16x16x32_bf16 v[48:51], v[112:115], v[76:79], v[48:51]
    ds_read_b128 v[96:99], v157 offset:38912
    s_waitcnt lgkmcnt(12)
    v_mfma_f32_16x16x32_bf16 v[52:55], v[100:103], v[80:83], v[52:55]
    v_mfma_f32_16x16x32_bf16 v[56:59], v[104:107], v[80:83], v[56:59]
    v_mfma_f32_16x16x32_bf16 v[60:63], v[108:111], v[80:83], v[60:63]
    v_mfma_f32_16x16x32_bf16 v[64:67], v[112:115], v[80:83], v[64:67]
    s_waitcnt lgkmcnt(9)
    v_mfma_f32_16x16x32_bf16 v[4:7], v[116:119], v[84:87], v[4:7]
    s_waitcnt lgkmcnt(7)
    v_mfma_f32_16x16x32_bf16 v[8:11], v[120:123], v[84:87], v[8:11]
    s_waitcnt lgkmcnt(5)
    v_mfma_f32_16x16x32_bf16 v[12:15], v[124:127], v[84:87], v[12:15]
    s_waitcnt lgkmcnt(3)
    v_mfma_f32_16x16x32_bf16 v[16:19], v[128:131], v[84:87], v[16:19]
    s_waitcnt lgkmcnt(0)
    s_barrier
    ds_read_b64_tr_b16 v[100:101], v158 offset:49152
    v_mfma_f32_16x16x32_bf16 v[20:23], v[116:119], v[88:91], v[20:23]
    ds_read_b64_tr_b16 v[102:103], v158 offset:50176
    v_mfma_f32_16x16x32_bf16 v[24:27], v[120:123], v[88:91], v[24:27]
    ds_read_b128 v[68:71], v156 offset:49152
    v_mfma_f32_16x16x32_bf16 v[28:31], v[124:127], v[88:91], v[28:31]
    ds_read_b64_tr_b16 v[104:105], v159 offset:49152
    v_mfma_f32_16x16x32_bf16 v[32:35], v[128:131], v[88:91], v[32:35]
    ds_read_b64_tr_b16 v[106:107], v159 offset:50176
    v_mfma_f32_16x16x32_bf16 v[36:39], v[116:119], v[92:95], v[36:39]
    ds_read_b64_tr_b16 v[108:109], v160 offset:49152
    v_mfma_f32_16x16x32_bf16 v[40:43], v[120:123], v[92:95], v[40:43]
    ds_read_b64_tr_b16 v[110:111], v160 offset:50176
    v_mfma_f32_16x16x32_bf16 v[44:47], v[124:127], v[92:95], v[44:47]
    ds_read_b64_tr_b16 v[112:113], v161 offset:49152
    v_mfma_f32_16x16x32_bf16 v[48:51], v[128:131], v[92:95], v[48:51]
    ds_read_b64_tr_b16 v[114:115], v161 offset:50176
    v_mfma_f32_16x16x32_bf16 v[52:55], v[116:119], v[96:99], v[52:55]
    ds_read_b128 v[72:75], v156 offset:51200
    v_mfma_f32_16x16x32_bf16 v[56:59], v[120:123], v[96:99], v[56:59]
    ds_read_b128 v[76:79], v156 offset:53248
    v_mfma_f32_16x16x32_bf16 v[60:63], v[124:127], v[96:99], v[60:63]
    ds_read_b128 v[80:83], v156 offset:55296
    v_mfma_f32_16x16x32_bf16 v[64:67], v[128:131], v[96:99], v[64:67]
    s_waitcnt lgkmcnt(9)
    v_mfma_f32_16x16x32_bf16 v[4:7], v[100:103], v[68:71], v[4:7]
    ds_read_b64_tr_b16 v[116:117], v158 offset:57344
    s_waitcnt lgkmcnt(8)
    v_mfma_f32_16x16x32_bf16 v[8:11], v[104:107], v[68:71], v[8:11]
    ds_read_b64_tr_b16 v[118:119], v158 offset:58368
    s_waitcnt lgkmcnt(7)
    v_mfma_f32_16x16x32_bf16 v[12:15], v[108:111], v[68:71], v[12:15]
    ds_read_b128 v[84:87], v157 offset:49152
    s_waitcnt lgkmcnt(6)
    v_mfma_f32_16x16x32_bf16 v[16:19], v[112:115], v[68:71], v[16:19]
    ds_read_b64_tr_b16 v[120:121], v159 offset:57344
    s_waitcnt lgkmcnt(6)
    v_mfma_f32_16x16x32_bf16 v[20:23], v[100:103], v[72:75], v[20:23]
    ds_read_b64_tr_b16 v[122:123], v159 offset:58368
    v_mfma_f32_16x16x32_bf16 v[24:27], v[104:107], v[72:75], v[24:27]
    ds_read_b64_tr_b16 v[124:125], v160 offset:57344
    v_mfma_f32_16x16x32_bf16 v[28:31], v[108:111], v[72:75], v[28:31]
    ds_read_b64_tr_b16 v[126:127], v160 offset:58368
    v_mfma_f32_16x16x32_bf16 v[32:35], v[112:115], v[72:75], v[32:35]
    ds_read_b64_tr_b16 v[128:129], v161 offset:57344
    s_waitcnt lgkmcnt(9)
    v_mfma_f32_16x16x32_bf16 v[36:39], v[100:103], v[76:79], v[36:39]
    ds_read_b64_tr_b16 v[130:131], v161 offset:58368
    v_mfma_f32_16x16x32_bf16 v[40:43], v[104:107], v[76:79], v[40:43]
    ds_read_b128 v[88:91], v157 offset:51200
    v_mfma_f32_16x16x32_bf16 v[44:47], v[108:111], v[76:79], v[44:47]
    ds_read_b128 v[92:95], v157 offset:53248
    v_mfma_f32_16x16x32_bf16 v[48:51], v[112:115], v[76:79], v[48:51]
    ds_read_b128 v[96:99], v157 offset:55296
    s_waitcnt lgkmcnt(12)
    v_mfma_f32_16x16x32_bf16 v[52:55], v[100:103], v[80:83], v[52:55]
    v_mfma_f32_16x16x32_bf16 v[56:59], v[104:107], v[80:83], v[56:59]
    v_mfma_f32_16x16x32_bf16 v[60:63], v[108:111], v[80:83], v[60:63]
    v_mfma_f32_16x16x32_bf16 v[64:67], v[112:115], v[80:83], v[64:67]
    s_waitcnt lgkmcnt(9)
    v_mfma_f32_16x16x32_bf16 v[4:7], v[116:119], v[84:87], v[4:7]
    s_waitcnt lgkmcnt(7)
    v_mfma_f32_16x16x32_bf16 v[8:11], v[120:123], v[84:87], v[8:11]
    s_waitcnt lgkmcnt(5)
    v_mfma_f32_16x16x32_bf16 v[12:15], v[124:127], v[84:87], v[12:15]
    s_waitcnt lgkmcnt(3)
    v_mfma_f32_16x16x32_bf16 v[16:19], v[128:131], v[84:87], v[16:19]
    s_waitcnt lgkmcnt(0)
    s_barrier
    v_mfma_f32_16x16x32_bf16 v[20:23], v[116:119], v[88:91], v[20:23]
    v_mfma_f32_16x16x32_bf16 v[24:27], v[120:123], v[88:91], v[24:27]
    v_mfma_f32_16x16x32_bf16 v[28:31], v[124:127], v[88:91], v[28:31]
    v_mfma_f32_16x16x32_bf16 v[32:35], v[128:131], v[88:91], v[32:35]
    v_mfma_f32_16x16x32_bf16 v[36:39], v[116:119], v[92:95], v[36:39]
    v_cvt_pk_bf16_f32 v148, v4, v5
    v_cvt_pk_bf16_f32 v149, v6, v7
    v_cvt_pk_bf16_f32 v150, v8, v9
    v_mfma_f32_16x16x32_bf16 v[40:43], v[120:123], v[92:95], v[40:43]
    v_cvt_pk_bf16_f32 v151, v10, v11
    buffer_store_dwordx4 v[148:151], v163, s[20:23], s40 offen sc1
    v_cvt_pk_bf16_f32 v152, v12, v13
    v_mfma_f32_16x16x32_bf16 v[44:47], v[124:127], v[92:95], v[44:47]
    v_cvt_pk_bf16_f32 v153, v14, v15
    v_cvt_pk_bf16_f32 v154, v16, v17
    v_mfma_f32_16x16x32_bf16 v[48:51], v[128:131], v[92:95], v[48:51]
    v_cvt_pk_bf16_f32 v155, v18, v19
    buffer_store_dwordx4 v[152:155], v165, s[20:23], s40 offen sc1
    v_mfma_f32_16x16x32_bf16 v[52:55], v[116:119], v[96:99], v[52:55]
    v_cvt_pk_bf16_f32 v148, v20, v21
    v_cvt_pk_bf16_f32 v149, v22, v23
    v_cvt_pk_bf16_f32 v150, v24, v25
    v_mfma_f32_16x16x32_bf16 v[56:59], v[120:123], v[96:99], v[56:59]
    v_cvt_pk_bf16_f32 v151, v26, v27
    buffer_store_dwordx4 v[148:151], v164, s[20:23], s40 offen sc1
    v_cvt_pk_bf16_f32 v152, v28, v29
    v_mfma_f32_16x16x32_bf16 v[60:63], v[124:127], v[96:99], v[60:63]
    v_cvt_pk_bf16_f32 v153, v30, v31
    v_cvt_pk_bf16_f32 v154, v32, v33
    v_mfma_f32_16x16x32_bf16 v[64:67], v[128:131], v[96:99], v[64:67]
    v_cvt_pk_bf16_f32 v155, v34, v35
    buffer_store_dwordx4 v[152:155], v166, s[20:23], s40 offen sc1
    v_cvt_pk_bf16_f32 v148, v36, v37
    v_cvt_pk_bf16_f32 v149, v38, v39
    v_cvt_pk_bf16_f32 v150, v40, v41
    v_cvt_pk_bf16_f32 v151, v42, v43
    buffer_store_dwordx4 v[148:151], v163, s[20:23], s41 offen sc1
    v_cvt_pk_bf16_f32 v152, v44, v45
    v_cvt_pk_bf16_f32 v153, v46, v47
    v_cvt_pk_bf16_f32 v154, v48, v49
    v_cvt_pk_bf16_f32 v155, v50, v51
    buffer_store_dwordx4 v[152:155], v165, s[20:23], s41 offen sc1
    s_nop 3
    v_cvt_pk_bf16_f32 v148, v52, v53
    v_cvt_pk_bf16_f32 v149, v54, v55
    v_cvt_pk_bf16_f32 v150, v56, v57
    v_cvt_pk_bf16_f32 v151, v58, v59
    buffer_store_dwordx4 v[148:151], v164, s[20:23], s41 offen sc1
    v_cvt_pk_bf16_f32 v152, v60, v61
    v_cvt_pk_bf16_f32 v153, v62, v63
    v_cvt_pk_bf16_f32 v154, v64, v65
    v_cvt_pk_bf16_f32 v155, v66, v67
    buffer_store_dwordx4 v[152:155], v166, s[20:23], s41 offen sc1
L_att:
    s_waitcnt lgkmcnt(0)
    v_and_b32 v163, 15, v2
    v_and_b32 v164, 2, v163
    v_and_b32 v165, 4, v163
    v_mov_b32 v166, 0x3f803f80
    v_cmp_eq_u32 vcc, 0, v164
    s_nop 1
    v_cndmask_b32 v166, 0, v166, vcc
    v_cmp_eq_u32 vcc, 0, v165
    s_nop 1
    v_cndmask_b32 v156, 0, v166, vcc
    v_cndmask_b32 v157, 0, v166, vcc
    v_cndmask_b32 v158, v166, 0, vcc
    v_cndmask_b32 v159, v166, 0, vcc
    v_and_b32 v164, 1, v163
    v_mov_b32 v165, 0x4444
    v_mov_b32 v166, 0xeeee
    v_cmp_eq_u32 vcc, 0, v164
    s_nop 1
    v_cndmask_b32 v160, v166, v165, vcc
    v_add_u32 v161, 65536, v167
    v_lshrrev_b32 v163, 4, v2
    v_and_b32 v163, 1, v163
    v_lshlrev_b32 v163, 15, v163
    v_lshrrev_b32 v164, 5, v2
    v_lshlrev_b32 v164, 8, v164
    v_add_u32 v163, v163, v164
    v_and_b32 v164, 15, v2
    v_lshlrev_b32 v164, 4, v164
    v_add_u32 v162, v163, v164
    s_mov_b32 s33, 0
    ds_read_b128 v[68:71], v167 offset:0
    ds_read_b128 v[72:75], v167 offset:1024
    ds_read_b128 v[76:79], v167 offset:4096
    ds_read_b128 v[80:83], v167 offset:5120
    ds_read_b128 v[84:87], v167 offset:2048
    s_lshl_b32 s26, s24, 12
    s_add_u32 s26, s26, 131072
    v_add_u32 v164, s26, v167
    ds_read_b128 v[132:135], v164
    ds_read_b128 v[136:139], v164 offset:1024
    ds_read_b128 v[140:143], v164 offset:2048
    ds_read_b128 v[144:147], v164 offset:3072
L_att_phase:
    s_lshl_b32 s29, s33, 4
    s_add_u32 s29, s29, s85
    s_lshl_b32 s26, s84, 22
    s_lshl_b32 s27, s29, 10
    s_add_u32 s26, s26, s27
    s_lshl_b32 s27, s86, 3
    s_lshl_b32 s28, s24, 1
    s_add_u32 s27, s27, s28
    s_lshl_b32 s27, s27, 16
    s_add_u32 s26, s26, s27
    s_add_u32 s26, s26, 17825792
    s_add_u32 s12, s4, s26
    s_addc_u32 s13, s5, 0
    s_and_b32 s13, s13, 0xffff
    s_mov_b32 s14, 131072
    s_mov_b32 s15, 0x20000
    v_mov_b32 v92, 0
    v_mov_b32 v93, 0
    v_mov_b32 v94, 0
    v_mov_b32 v95, 0
    v_mov_b32 v96, 0
    v_mov_b32 v97, 0
    v_mov_b32 v98, 0
    v_mov_b32 v99, 0
    v_mov_b32 v108, 0
    v_mov_b32 v109, 0
    v_mov_b32 v110, 0
    v_mov_b32 v111, 0
    v_mov_b32 v112, 0
    v_mov_b32 v113, 0
    v_mov_b32 v114, 0
    v_mov_b32 v115, 0
    s_waitcnt lgkmcnt(2)
    v_mfma_f32_32x32x16_bf16 v[4:19], v[68:71], v[132:135], 0
    v_mfma_f32_32x32x16_bf16 v[4:19], v[72:75], v[136:139], v[4:19]
    v_mfma_f32_32x32x16_bf16 v[52:67], v[92:95], v[108:111], 0
    v_mfma_f32_32x32x16_bf16 v[36:51], v[92:95], v[108:111], 0
    v_mov_b32 v148, 0
    v_mov_b32 v149, 0
    v_mov_b32 v150, 0
    v_mov_b32 v151, 0
    v_mov_b32 v152, 0
    v_mov_b32 v153, 0
    v_mov_b32 v154, 0
    v_mov_b32 v155, 0
    s_nop 3
    s_mov_b32 s58, 0
    s_waitcnt lgkmcnt(0)
L_att_loop:
    v_mfma_f32_32x32x16_bf16 v[20:35], v[68:71], v[140:143], 0
    ds_read_b128 v[88:91], v167 offset:3072
    v_exp_f32 v4, v4
    v_exp_f32 v5, v5
    v_exp_f32 v6, v6
    v_exp_f32 v7, v7
    v_mfma_f32_32x32x16_bf16 v[52:67], v[92:95], v[108:111], v[52:67]
    v_exp_f32 v8, v8
    v_exp_f32 v9, v9
    v_exp_f32 v10, v10
    v_exp_f32 v11, v11
    v_mfma_f32_32x32x16_bf16 v[20:35], v[72:75], v[144:147], v[20:35]
    v_exp_f32 v12, v12
    v_exp_f32 v13, v13
    v_exp_f32 v14, v14
    v_exp_f32 v15, v15
    v_mfma_f32_32x32x16_bf16 v[52:67], v[96:99], v[112:115], v[52:67]
    v_exp_f32 v16, v16
    v_exp_f32 v17, v17
    v_exp_f32 v18, v18
    v_exp_f32 v19, v19
    v_smfmac_f32_16x16x64_bf16 v[152:155], v[156:159], v[108:115], v160
    ds_read_b128 v[68:71], v167 offset:8192
    v_cvt_pk_bf16_f32 v100, v4, v5
    v_cvt_pk_bf16_f32 v101, v6, v7
    v_cvt_pk_bf16_f32 v102, v8, v9
    v_cvt_pk_bf16_f32 v103, v10, v11
    v_cvt_pk_bf16_f32 v104, v12, v13
    v_cvt_pk_bf16_f32 v105, v14, v15
    v_cvt_pk_bf16_f32 v106, v16, v17
    v_cvt_pk_bf16_f32 v107, v18, v19
    s_waitcnt lgkmcnt(1)
    v_mfma_f32_32x32x16_bf16 v[4:19], v[76:79], v[132:135], 0
    v_exp_f32 v20, v20
    v_exp_f32 v21, v21
    v_exp_f32 v22, v22
    v_exp_f32 v23, v23
    v_mfma_f32_32x32x16_bf16 v[36:51], v[84:87], v[100:103], v[36:51]
    ds_read_b128 v[92:95], v167 offset:6144
    v_exp_f32 v24, v24
    v_exp_f32 v25, v25
    v_exp_f32 v26, v26
    v_exp_f32 v27, v27
    v_mfma_f32_32x32x16_bf16 v[4:19], v[80:83], v[136:139], v[4:19]
    v_exp_f32 v28, v28
    v_exp_f32 v29, v29
    v_exp_f32 v30, v30
    v_exp_f32 v31, v31
    v_mfma_f32_32x32x16_bf16 v[36:51], v[88:91], v[104:107], v[36:51]
    v_exp_f32 v32, v32
    v_exp_f32 v33, v33
    v_exp_f32 v34, v34
    v_exp_f32 v35, v35
    v_smfmac_f32_16x16x64_bf16 v[148:151], v[156:159], v[100:107], v160
    ds_read_b128 v[72:75], v167 offset:9216
    v_cvt_pk_bf16_f32 v108, v20, v21
    v_cvt_pk_bf16_f32 v109, v22, v23
    v_cvt_pk_bf16_f32 v110, v24, v25
    v_cvt_pk_bf16_f32 v111, v26, v27
    v_cvt_pk_bf16_f32 v112, v28, v29
    v_cvt_pk_bf16_f32 v113, v30, v31
    v_cvt_pk_bf16_f32 v114, v32, v33
    v_cvt_pk_bf16_f32 v115, v34, v35
    v_mfma_f32_32x32x16_bf16 v[20:35], v[76:79], v[140:143], 0
    ds_read_b128 v[96:99], v167 offset:7168
    v_exp_f32 v4, v4
    v_exp_f32 v5, v5
    v_exp_f32 v6, v6
    v_exp_f32 v7, v7
    v_mfma_f32_32x32x16_bf16 v[52:67], v[84:87], v[108:111], v[52:67]
    v_exp_f32 v8, v8
    v_exp_f32 v9, v9
    v_exp_f32 v10, v10
    v_exp_f32 v11, v11
    v_mfma_f32_32x32x16_bf16 v[20:35], v[80:83], v[144:147], v[20:35]
    v_exp_f32 v12, v12
    v_exp_f32 v13, v13
    v_exp_f32 v14, v14
    v_exp_f32 v15, v15
    v_mfma_f32_32x32x16_bf16 v[52:67], v[88:91], v[112:115], v[52:67]
    v_exp_f32 v16, v16
    v_exp_f32 v17, v17
    v_exp_f32 v18, v18
    v_exp_f32 v19, v19
    v_smfmac_f32_16x16x64_bf16 v[152:155], v[156:159], v[108:115], v160
    ds_read_b128 v[76:79], v167 offset:12288
    v_cvt_pk_bf16_f32 v100, v4, v5
    v_cvt_pk_bf16_f32 v101, v6, v7
    v_cvt_pk_bf16_f32 v102, v8, v9
    v_cvt_pk_bf16_f32 v103, v10, v11
    v_cvt_pk_bf16_f32 v104, v12, v13
    v_cvt_pk_bf16_f32 v105, v14, v15
    v_cvt_pk_bf16_f32 v106, v16, v17
    v_cvt_pk_bf16_f32 v107, v18, v19
    s_waitcnt lgkmcnt(1)
    v_mfma_f32_32x32x16_bf16 v[4:19], v[68:71], v[132:135], 0
    v_exp_f32 v20, v20
    v_exp_f32 v21, v21
    v_exp_f32 v22, v22
    v_exp_f32 v23, v23
    v_mfma_f32_32x32x16_bf16 v[36:51], v[92:95], v[100:103], v[36:51]
    ds_read_b128 v[84:87], v167 offset:10240
    v_exp_f32 v24, v24
    v_exp_f32 v25, v25
    v_exp_f32 v26, v26
    v_exp_f32 v27, v27
    v_mfma_f32_32x32x16_bf16 v[4:19], v[72:75], v[136:139], v[4:19]
    v_exp_f32 v28, v28
    v_exp_f32 v29, v29
    v_exp_f32 v30, v30
    v_exp_f32 v31, v31
    v_mfma_f32_32x32x16_bf16 v[36:51], v[96:99], v[104:107], v[36:51]
    v_exp_f32 v32, v32
    v_exp_f32 v33, v33
    v_exp_f32 v34, v34
    v_exp_f32 v35, v35
    v_smfmac_f32_16x16x64_bf16 v[148:151], v[156:159], v[100:107], v160
    ds_read_b128 v[80:83], v167 offset:13312
    v_cvt_pk_bf16_f32 v108, v20, v21
    v_cvt_pk_bf16_f32 v109, v22, v23
    v_cvt_pk_bf16_f32 v110, v24, v25
    v_cvt_pk_bf16_f32 v111, v26, v27
    v_cvt_pk_bf16_f32 v112, v28, v29
    v_cvt_pk_bf16_f32 v113, v30, v31
    v_cvt_pk_bf16_f32 v114, v32, v33
    v_cvt_pk_bf16_f32 v115, v34, v35
    v_mfma_f32_32x32x16_bf16 v[20:35], v[68:71], v[140:143], 0
    ds_read_b128 v[88:91], v167 offset:11264
    v_exp_f32 v4, v4
    v_exp_f32 v5, v5
    v_exp_f32 v6, v6
    v_exp_f32 v7, v7
    v_mfma_f32_32x32x16_bf16 v[52:67], v[92:95], v[108:111], v[52:67]
    v_exp_f32 v8, v8
    v_exp_f32 v9, v9
    v_exp_f32 v10, v10
    v_exp_f32 v11, v11
    v_mfma_f32_32x32x16_bf16 v[20:35], v[72:75], v[144:147], v[20:35]
    v_exp_f32 v12, v12
    v_exp_f32 v13, v13
    v_exp_f32 v14, v14
    v_exp_f32 v15, v15
    v_mfma_f32_32x32x16_bf16 v[52:67], v[96:99], v[112:115], v[52:67]
    v_exp_f32 v16, v16
    v_exp_f32 v17, v17
    v_exp_f32 v18, v18
    v_exp_f32 v19, v19
    v_smfmac_f32_16x16x64_bf16 v[152:155], v[156:159], v[108:115], v160
    ds_read_b128 v[68:71], v161 offset:0
    v_cvt_pk_bf16_f32 v100, v4, v5
    v_cvt_pk_bf16_f32 v101, v6, v7
    v_cvt_pk_bf16_f32 v102, v8, v9
    v_cvt_pk_bf16_f32 v103, v10, v11
    v_cvt_pk_bf16_f32 v104, v12, v13
    v_cvt_pk_bf16_f32 v105, v14, v15
    v_cvt_pk_bf16_f32 v106, v16, v17
    v_cvt_pk_bf16_f32 v107, v18, v19
    s_waitcnt lgkmcnt(1)
    v_mfma_f32_32x32x16_bf16 v[4:19], v[76:79], v[132:135], 0
    v_exp_f32 v20, v20
    v_exp_f32 v21, v21
    v_exp_f32 v22, v22
    v_exp_f32 v23, v23
    v_mfma_f32_32x32x16_bf16 v[36:51], v[84:87], v[100:103], v[36:51]
    ds_read_b128 v[92:95], v167 offset:14336
    v_exp_f32 v24, v24
    v_exp_f32 v25, v25
    v_exp_f32 v26, v26
    v_exp_f32 v27, v27
    v_mfma_f32_32x32x16_bf16 v[4:19], v[80:83], v[136:139], v[4:19]
    v_exp_f32 v28, v28
    v_exp_f32 v29, v29
    v_exp_f32 v30, v30
    v_exp_f32 v31, v31
    v_mfma_f32_32x32x16_bf16 v[36:51], v[88:91], v[104:107], v[36:51]
    v_exp_f32 v32, v32
    v_exp_f32 v33, v33
    v_exp_f32 v34, v34
    v_exp_f32 v35, v35
    v_smfmac_f32_16x16x64_bf16 v[148:151], v[156:159], v[100:107], v160
    ds_read_b128 v[72:75], v161 offset:1024
    v_cvt_pk_bf16_f32 v108, v20, v21
    v_cvt_pk_bf16_f32 v109, v22, v23
    v_cvt_pk_bf16_f32 v110, v24, v25
    v_cvt_pk_bf16_f32 v111, v26, v27
    v_cvt_pk_bf16_f32 v112, v28, v29
    v_cvt_pk_bf16_f32 v113, v30, v31
    v_cvt_pk_bf16_f32 v114, v32, v33
    v_cvt_pk_bf16_f32 v115, v34, v35
    v_mfma_f32_32x32x16_bf16 v[20:35], v[76:79], v[140:143], 0
    ds_read_b128 v[96:99], v167 offset:15360
    v_exp_f32 v4, v4
    v_exp_f32 v5, v5
    v_exp_f32 v6, v6
    v_exp_f32 v7, v7
    v_mfma_f32_32x32x16_bf16 v[52:67], v[84:87], v[108:111], v[52:67]
    v_exp_f32 v8, v8
    v_exp_f32 v9, v9
    v_exp_f32 v10, v10
    v_exp_f32 v11, v11
    v_mfma_f32_32x32x16_bf16 v[20:35], v[80:83], v[144:147], v[20:35]
    v_exp_f32 v12, v12
    v_exp_f32 v13, v13
    v_exp_f32 v14, v14
    v_exp_f32 v15, v15
    v_mfma_f32_32x32x16_bf16 v[52:67], v[88:91], v[112:115], v[52:67]
    v_exp_f32 v16, v16
    v_exp_f32 v17, v17
    v_exp_f32 v18, v18
    v_exp_f32 v19, v19
    v_smfmac_f32_16x16x64_bf16 v[152:155], v[156:159], v[108:115], v160
    ds_read_b128 v[76:79], v161 offset:4096
    v_cvt_pk_bf16_f32 v100, v4, v5
    v_cvt_pk_bf16_f32 v101, v6, v7
    v_cvt_pk_bf16_f32 v102, v8, v9
    v_cvt_pk_bf16_f32 v103, v10, v11
    v_cvt_pk_bf16_f32 v104, v12, v13
    v_cvt_pk_bf16_f32 v105, v14, v15
    v_cvt_pk_bf16_f32 v106, v16, v17
    v_cvt_pk_bf16_f32 v107, v18, v19
    s_waitcnt lgkmcnt(1)
    v_mfma_f32_32x32x16_bf16 v[4:19], v[68:71], v[132:135], 0
    v_exp_f32 v20, v20
    v_exp_f32 v21, v21
    v_exp_f32 v22, v22
    v_exp_f32 v23, v23
    v_mfma_f32_32x32x16_bf16 v[36:51], v[92:95], v[100:103], v[36:51]
    ds_read_b128 v[84:87], v161 offset:2048
    v_exp_f32 v24, v24
    v_exp_f32 v25, v25
    v_exp_f32 v26, v26
    v_exp_f32 v27, v27
    v_mfma_f32_32x32x16_bf16 v[4:19], v[72:75], v[136:139], v[4:19]
    v_exp_f32 v28, v28
    v_exp_f32 v29, v29
    v_exp_f32 v30, v30
    v_exp_f32 v31, v31
    v_mfma_f32_32x32x16_bf16 v[36:51], v[96:99], v[104:107], v[36:51]
    v_exp_f32 v32, v32
    v_exp_f32 v33, v33
    v_exp_f32 v34, v34
    v_exp_f32 v35, v35
    v_smfmac_f32_16x16x64_bf16 v[148:151], v[156:159], v[100:107], v160
    ds_read_b128 v[80:83], v161 offset:5120
    v_cvt_pk_bf16_f32 v108, v20, v21
    v_cvt_pk_bf16_f32 v109, v22, v23
    v_cvt_pk_bf16_f32 v110, v24, v25
    v_cvt_pk_bf16_f32 v111, v26, v27
    v_cvt_pk_bf16_f32 v112, v28, v29
    v_cvt_pk_bf16_f32 v113, v30, v31
    v_cvt_pk_bf16_f32 v114, v32, v33
    v_cvt_pk_bf16_f32 v115, v34, v35
    v_mfma_f32_32x32x16_bf16 v[20:35], v[68:71], v[140:143], 0
    ds_read_b128 v[88:91], v161 offset:3072
    v_exp_f32 v4, v4
    v_exp_f32 v5, v5
    v_exp_f32 v6, v6
    v_exp_f32 v7, v7
    v_mfma_f32_32x32x16_bf16 v[52:67], v[92:95], v[108:111], v[52:67]
    v_exp_f32 v8, v8
    v_exp_f32 v9, v9
    v_exp_f32 v10, v10
    v_exp_f32 v11, v11
    v_mfma_f32_32x32x16_bf16 v[20:35], v[72:75], v[144:147], v[20:35]
    v_exp_f32 v12, v12
    v_exp_f32 v13, v13
    v_exp_f32 v14, v14
    v_exp_f32 v15, v15
    v_mfma_f32_32x32x16_bf16 v[52:67], v[96:99], v[112:115], v[52:67]
    v_exp_f32 v16, v16
    v_exp_f32 v17, v17
    v_exp_f32 v18, v18
    v_exp_f32 v19, v19
    v_smfmac_f32_16x16x64_bf16 v[152:155], v[156:159], v[108:115], v160
    ds_read_b128 v[68:71], v161 offset:8192
    v_cvt_pk_bf16_f32 v100, v4, v5
    v_cvt_pk_bf16_f32 v101, v6, v7
    v_cvt_pk_bf16_f32 v102, v8, v9
    v_cvt_pk_bf16_f32 v103, v10, v11
    v_cvt_pk_bf16_f32 v104, v12, v13
    v_cvt_pk_bf16_f32 v105, v14, v15
    v_cvt_pk_bf16_f32 v106, v16, v17
    v_cvt_pk_bf16_f32 v107, v18, v19
    s_waitcnt lgkmcnt(1)
    v_mfma_f32_32x32x16_bf16 v[4:19], v[76:79], v[132:135], 0
    v_exp_f32 v20, v20
    v_exp_f32 v21, v21
    v_exp_f32 v22, v22
    v_exp_f32 v23, v23
    v_mfma_f32_32x32x16_bf16 v[36:51], v[84:87], v[100:103], v[36:51]
    ds_read_b128 v[92:95], v161 offset:6144
    v_exp_f32 v24, v24
    v_exp_f32 v25, v25
    v_exp_f32 v26, v26
    v_exp_f32 v27, v27
    v_mfma_f32_32x32x16_bf16 v[4:19], v[80:83], v[136:139], v[4:19]
    v_exp_f32 v28, v28
    v_exp_f32 v29, v29
    v_exp_f32 v30, v30
    v_exp_f32 v31, v31
    v_mfma_f32_32x32x16_bf16 v[36:51], v[88:91], v[104:107], v[36:51]
    v_exp_f32 v32, v32
    v_exp_f32 v33, v33
    v_exp_f32 v34, v34
    v_exp_f32 v35, v35
    v_smfmac_f32_16x16x64_bf16 v[148:151], v[156:159], v[100:107], v160
    ds_read_b128 v[72:75], v161 offset:9216
    v_cvt_pk_bf16_f32 v108, v20, v21
    v_cvt_pk_bf16_f32 v109, v22, v23
    v_cvt_pk_bf16_f32 v110, v24, v25
    v_cvt_pk_bf16_f32 v111, v26, v27
    v_cvt_pk_bf16_f32 v112, v28, v29
    v_cvt_pk_bf16_f32 v113, v30, v31
    v_cvt_pk_bf16_f32 v114, v32, v33
    v_cvt_pk_bf16_f32 v115, v34, v35
    v_mfma_f32_32x32x16_bf16 v[20:35], v[76:79], v[140:143], 0
    ds_read_b128 v[96:99], v161 offset:7168
    v_exp_f32 v4, v4
    v_exp_f32 v5, v5
    v_exp_f32 v6, v6
    v_exp_f32 v7, v7
    v_mfma_f32_32x32x16_bf16 v[52:67], v[84:87], v[108:111], v[52:67]
    v_exp_f32 v8, v8
    v_exp_f32 v9, v9
    v_exp_f32 v10, v10
    v_exp_f32 v11, v11
    v_mfma_f32_32x32x16_bf16 v[20:35], v[80:83], v[144:147], v[20:35]
    v_exp_f32 v12, v12
    v_exp_f32 v13, v13
    v_exp_f32 v14, v14
    v_exp_f32 v15, v15
    v_mfma_f32_32x32x16_bf16 v[52:67], v[88:91], v[112:115], v[52:67]
    v_exp_f32 v16, v16
    v_exp_f32 v17, v17
    v_exp_f32 v18, v18
    v_exp_f32 v19, v19
    v_smfmac_f32_16x16x64_bf16 v[152:155], v[156:159], v[108:115], v160
    ds_read_b128 v[76:79], v161 offset:12288
    v_cvt_pk_bf16_f32 v100, v4, v5
    v_cvt_pk_bf16_f32 v101, v6, v7
    v_cvt_pk_bf16_f32 v102, v8, v9
    v_cvt_pk_bf16_f32 v103, v10, v11
    v_cvt_pk_bf16_f32 v104, v12, v13
    v_cvt_pk_bf16_f32 v105, v14, v15
    v_cvt_pk_bf16_f32 v106, v16, v17
    v_cvt_pk_bf16_f32 v107, v18, v19
    s_waitcnt lgkmcnt(1)
    v_mfma_f32_32x32x16_bf16 v[4:19], v[68:71], v[132:135], 0
    v_exp_f32 v20, v20
    v_exp_f32 v21, v21
    v_exp_f32 v22, v22
    v_exp_f32 v23, v23
    v_mfma_f32_32x32x16_bf16 v[36:51], v[92:95], v[100:103], v[36:51]
    ds_read_b128 v[84:87], v161 offset:10240
    v_exp_f32 v24, v24
    v_exp_f32 v25, v25
    v_exp_f32 v26, v26
    v_exp_f32 v27, v27
    v_mfma_f32_32x32x16_bf16 v[4:19], v[72:75], v[136:139], v[4:19]
    v_exp_f32 v28, v28
    v_exp_f32 v29, v29
    v_exp_f32 v30, v30
    v_exp_f32 v31, v31
    v_mfma_f32_32x32x16_bf16 v[36:51], v[96:99], v[104:107], v[36:51]
    v_exp_f32 v32, v32
    v_exp_f32 v33, v33
    v_exp_f32 v34, v34
    v_exp_f32 v35, v35
    v_smfmac_f32_16x16x64_bf16 v[148:151], v[156:159], v[100:107], v160
    ds_read_b128 v[80:83], v161 offset:13312
    v_cvt_pk_bf16_f32 v108, v20, v21
    v_cvt_pk_bf16_f32 v109, v22, v23
    v_cvt_pk_bf16_f32 v110, v24, v25
    v_cvt_pk_bf16_f32 v111, v26, v27
    v_cvt_pk_bf16_f32 v112, v28, v29
    v_cvt_pk_bf16_f32 v113, v30, v31
    v_cvt_pk_bf16_f32 v114, v32, v33
    v_cvt_pk_bf16_f32 v115, v34, v35
    v_mfma_f32_32x32x16_bf16 v[20:35], v[68:71], v[140:143], 0
    ds_read_b128 v[88:91], v161 offset:11264
    v_exp_f32 v4, v4
    v_exp_f32 v5, v5
    v_exp_f32 v6, v6
    v_exp_f32 v7, v7
    v_mfma_f32_32x32x16_bf16 v[52:67], v[92:95], v[108:111], v[52:67]
    v_exp_f32 v8, v8
    v_exp_f32 v9, v9
    v_exp_f32 v10, v10
    v_exp_f32 v11, v11
    v_mfma_f32_32x32x16_bf16 v[20:35], v[72:75], v[144:147], v[20:35]
    v_exp_f32 v12, v12
    v_exp_f32 v13, v13
    v_exp_f32 v14, v14
    v_exp_f32 v15, v15
    s_waitcnt vmcnt(0)
    v_mfma_f32_32x32x16_bf16 v[52:67], v[96:99], v[112:115], v[52:67]
    s_barrier
    v_exp_f32 v16, v16
    v_exp_f32 v17, v17
    v_exp_f32 v18, v18
    v_exp_f32 v19, v19
    v_smfmac_f32_16x16x64_bf16 v[152:155], v[156:159], v[108:115], v160
    ds_read_b128 v[68:71], v167 offset:16384
    v_cvt_pk_bf16_f32 v100, v4, v5
    v_cvt_pk_bf16_f32 v101, v6, v7
    v_cvt_pk_bf16_f32 v102, v8, v9
    v_cvt_pk_bf16_f32 v103, v10, v11
    v_cvt_pk_bf16_f32 v104, v12, v13
    v_cvt_pk_bf16_f32 v105, v14, v15
    v_cvt_pk_bf16_f32 v106, v16, v17
    v_cvt_pk_bf16_f32 v107, v18, v19
    s_waitcnt lgkmcnt(1)
    v_mfma_f32_32x32x16_bf16 v[4:19], v[76:79], v[132:135], 0
    v_exp_f32 v20, v20
    v_exp_f32 v21, v21
    v_exp_f32 v22, v22
    v_exp_f32 v23, v23
    v_mfma_f32_32x32x16_bf16 v[36:51], v[84:87], v[100:103], v[36:51]
    ds_read_b128 v[92:95], v161 offset:14336
    v_exp_f32 v24, v24
    v_exp_f32 v25, v25
    v_exp_f32 v26, v26
    v_exp_f32 v27, v27
    v_mfma_f32_32x32x16_bf16 v[4:19], v[80:83], v[136:139], v[4:19]
    v_exp_f32 v28, v28
    v_exp_f32 v29, v29
    v_exp_f32 v30, v30
    v_exp_f32 v31, v31
    v_mfma_f32_32x32x16_bf16 v[36:51], v[88:91], v[104:107], v[36:51]
    v_exp_f32 v32, v32
    v_exp_f32 v33, v33
    v_exp_f32 v34, v34
    v_exp_f32 v35, v35
    v_smfmac_f32_16x16x64_bf16 v[148:151], v[156:159], v[100:107], v160
    ds_read_b128 v[72:75], v167 offset:17408
    v_cvt_pk_bf16_f32 v108, v20, v21
    v_cvt_pk_bf16_f32 v109, v22, v23
    v_cvt_pk_bf16_f32 v110, v24, v25
    v_cvt_pk_bf16_f32 v111, v26, v27
    v_cvt_pk_bf16_f32 v112, v28, v29
    v_cvt_pk_bf16_f32 v113, v30, v31
    v_cvt_pk_bf16_f32 v114, v32, v33
    v_cvt_pk_bf16_f32 v115, v34, v35
    v_mfma_f32_32x32x16_bf16 v[20:35], v[76:79], v[140:143], 0
    ds_read_b128 v[96:99], v161 offset:15360
    v_exp_f32 v4, v4
    v_exp_f32 v5, v5
    v_exp_f32 v6, v6
    v_exp_f32 v7, v7
    v_mfma_f32_32x32x16_bf16 v[52:67], v[84:87], v[108:111], v[52:67]
    v_exp_f32 v8, v8
    v_exp_f32 v9, v9
    v_exp_f32 v10, v10
    v_exp_f32 v11, v11
    v_mfma_f32_32x32x16_bf16 v[20:35], v[80:83], v[144:147], v[20:35]
    v_exp_f32 v12, v12
    v_exp_f32 v13, v13
    v_exp_f32 v14, v14
    v_exp_f32 v15, v15
    v_mfma_f32_32x32x16_bf16 v[52:67], v[88:91], v[112:115], v[52:67]
    v_exp_f32 v16, v16
    v_exp_f32 v17, v17
    v_exp_f32 v18, v18
    v_exp_f32 v19, v19
    v_smfmac_f32_16x16x64_bf16 v[152:155], v[156:159], v[108:115], v160
    ds_read_b128 v[76:79], v167 offset:20480
    v_cvt_pk_bf16_f32 v100, v4, v5
    v_cvt_pk_bf16_f32 v101, v6, v7
    v_cvt_pk_bf16_f32 v102, v8, v9
    v_cvt_pk_bf16_f32 v103, v10, v11
    v_cvt_pk_bf16_f32 v104, v12, v13
    v_cvt_pk_bf16_f32 v105, v14, v15
    v_cvt_pk_bf16_f32 v106, v16, v17
    v_cvt_pk_bf16_f32 v107, v18, v19
    s_waitcnt lgkmcnt(1)
    v_mfma_f32_32x32x16_bf16 v[4:19], v[68:71], v[132:135], 0
    v_exp_f32 v20, v20
    v_exp_f32 v21, v21
    v_exp_f32 v22, v22
    v_exp_f32 v23, v23
    v_mfma_f32_32x32x16_bf16 v[36:51], v[92:95], v[100:103], v[36:51]
    ds_read_b128 v[84:87], v167 offset:18432
    v_exp_f32 v24, v24
    v_exp_f32 v25, v25
    v_exp_f32 v26, v26
    v_exp_f32 v27, v27
    v_mfma_f32_32x32x16_bf16 v[4:19], v[72:75], v[136:139], v[4:19]
    v_exp_f32 v28, v28
    v_exp_f32 v29, v29
    v_exp_f32 v30, v30
    v_exp_f32 v31, v31
    v_mfma_f32_32x32x16_bf16 v[36:51], v[96:99], v[104:107], v[36:51]
    v_exp_f32 v32, v32
    v_exp_f32 v33, v33
    v_exp_f32 v34, v34
    v_exp_f32 v35, v35
    v_smfmac_f32_16x16x64_bf16 v[148:151], v[156:159], v[100:107], v160
    ds_read_b128 v[80:83], v167 offset:21504
    v_cvt_pk_bf16_f32 v108, v20, v21
    v_cvt_pk_bf16_f32 v109, v22, v23
    v_cvt_pk_bf16_f32 v110, v24, v25
    v_cvt_pk_bf16_f32 v111, v26, v27
    v_cvt_pk_bf16_f32 v112, v28, v29
    v_cvt_pk_bf16_f32 v113, v30, v31
    v_cvt_pk_bf16_f32 v114, v32, v33
    v_cvt_pk_bf16_f32 v115, v34, v35
    v_mfma_f32_32x32x16_bf16 v[20:35], v[68:71], v[140:143], 0
    ds_read_b128 v[88:91], v167 offset:19456
    v_exp_f32 v4, v4
    v_exp_f32 v5, v5
    v_exp_f32 v6, v6
    v_exp_f32 v7, v7
    v_mfma_f32_32x32x16_bf16 v[52:67], v[92:95], v[108:111], v[52:67]
    v_exp_f32 v8, v8
    v_exp_f32 v9, v9
    v_exp_f32 v10, v10
    v_exp_f32 v11, v11
    v_mfma_f32_32x32x16_bf16 v[20:35], v[72:75], v[144:147], v[20:35]
    v_exp_f32 v12, v12
    v_exp_f32 v13, v13
    v_exp_f32 v14, v14
    v_exp_f32 v15, v15
    v_mfma_f32_32x32x16_bf16 v[52:67], v[96:99], v[112:115], v[52:67]
    v_exp_f32 v16, v16
    v_exp_f32 v17, v17
    v_exp_f32 v18, v18
    v_exp_f32 v19, v19
    v_smfmac_f32_16x16x64_bf16 v[152:155], v[156:159], v[108:115], v160
    ds_read_b128 v[68:71], v167 offset:24576
    v_cvt_pk_bf16_f32 v100, v4, v5
    v_cvt_pk_bf16_f32 v101, v6, v7
    v_cvt_pk_bf16_f32 v102, v8, v9
    v_cvt_pk_bf16_f32 v103, v10, v11
    v_cvt_pk_bf16_f32 v104, v12, v13
    v_cvt_pk_bf16_f32 v105, v14, v15
    v_cvt_pk_bf16_f32 v106, v16, v17
    v_cvt_pk_bf16_f32 v107, v18, v19
    s_waitcnt lgkmcnt(1)
    v_mfma_f32_32x32x16_bf16 v[4:19], v[76:79], v[132:135], 0
    v_exp_f32 v20, v20
    v_exp_f32 v21, v21
    v_exp_f32 v22, v22
    v_exp_f32 v23, v23
    v_mfma_f32_32x32x16_bf16 v[36:51], v[84:87], v[100:103], v[36:51]
    ds_read_b128 v[92:95], v167 offset:22528
    v_exp_f32 v24, v24
    v_exp_f32 v25, v25
    v_exp_f32 v26, v26
    v_exp_f32 v27, v27
    v_mfma_f32_32x32x16_bf16 v[4:19], v[80:83], v[136:139], v[4:19]
    v_exp_f32 v28, v28
    v_exp_f32 v29, v29
    v_exp_f32 v30, v30
    v_exp_f32 v31, v31
    v_mfma_f32_32x32x16_bf16 v[36:51], v[88:91], v[104:107], v[36:51]
    v_exp_f32 v32, v32
    v_exp_f32 v33, v33
    v_exp_f32 v34, v34
    v_exp_f32 v35, v35
    v_smfmac_f32_16x16x64_bf16 v[148:151], v[156:159], v[100:107], v160
    ds_read_b128 v[72:75], v167 offset:25600
    v_cvt_pk_bf16_f32 v108, v20, v21
    v_cvt_pk_bf16_f32 v109, v22, v23
    v_cvt_pk_bf16_f32 v110, v24, v25
    v_cvt_pk_bf16_f32 v111, v26, v27
    v_cvt_pk_bf16_f32 v112, v28, v29
    v_cvt_pk_bf16_f32 v113, v30, v31
    v_cvt_pk_bf16_f32 v114, v32, v33
    v_cvt_pk_bf16_f32 v115, v34, v35
    v_mfma_f32_32x32x16_bf16 v[20:35], v[76:79], v[140:143], 0
    ds_read_b128 v[96:99], v167 offset:23552
    v_exp_f32 v4, v4
    v_exp_f32 v5, v5
    v_exp_f32 v6, v6
    v_exp_f32 v7, v7
    v_mfma_f32_32x32x16_bf16 v[52:67], v[84:87], v[108:111], v[52:67]
    v_exp_f32 v8, v8
    v_exp_f32 v9, v9
    v_exp_f32 v10, v10
    v_exp_f32 v11, v11
    v_mfma_f32_32x32x16_bf16 v[20:35], v[80:83], v[144:147], v[20:35]
    v_exp_f32 v12, v12
    v_exp_f32 v13, v13
    v_exp_f32 v14, v14
    v_exp_f32 v15, v15
    v_mfma_f32_32x32x16_bf16 v[52:67], v[88:91], v[112:115], v[52:67]
    v_exp_f32 v16, v16
    v_exp_f32 v17, v17
    v_exp_f32 v18, v18
    v_exp_f32 v19, v19
    v_smfmac_f32_16x16x64_bf16 v[152:155], v[156:159], v[108:115], v160
    ds_read_b128 v[76:79], v167 offset:28672
    v_cvt_pk_bf16_f32 v100, v4, v5
    v_cvt_pk_bf16_f32 v101, v6, v7
    v_cvt_pk_bf16_f32 v102, v8, v9
    v_cvt_pk_bf16_f32 v103, v10, v11
    v_cvt_pk_bf16_f32 v104, v12, v13
    v_cvt_pk_bf16_f32 v105, v14, v15
    v_cvt_pk_bf16_f32 v106, v16, v17
    v_cvt_pk_bf16_f32 v107, v18, v19
    s_waitcnt lgkmcnt(1)
    v_mfma_f32_32x32x16_bf16 v[4:19], v[68:71], v[132:135], 0
    v_exp_f32 v20, v20
    v_exp_f32 v21, v21
    v_exp_f32 v22, v22
    v_exp_f32 v23, v23
    v_mfma_f32_32x32x16_bf16 v[36:51], v[92:95], v[100:103], v[36:51]
    ds_read_b128 v[84:87], v167 offset:26624
    v_exp_f32 v24, v24
    v_exp_f32 v25, v25
    v_exp_f32 v26, v26
    v_exp_f32 v27, v27
    v_mfma_f32_32x32x16_bf16 v[4:19], v[72:75], v[136:139], v[4:19]
    v_exp_f32 v28, v28
    v_exp_f32 v29, v29
    v_exp_f32 v30, v30
    v_exp_f32 v31, v31
    v_mfma_f32_32x32x16_bf16 v[36:51], v[96:99], v[104:107], v[36:51]
    v_exp_f32 v32, v32
    v_exp_f32 v33, v33
    v_exp_f32 v34, v34
    v_exp_f32 v35, v35
    v_smfmac_f32_16x16x64_bf16 v[148:151], v[156:159], v[100:107], v160
    ds_read_b128 v[80:83], v167 offset:29696
    v_cvt_pk_bf16_f32 v108, v20, v21
    v_cvt_pk_bf16_f32 v109, v22, v23
    v_cvt_pk_bf16_f32 v110, v24, v25
    v_cvt_pk_bf16_f32 v111, v26, v27
    v_cvt_pk_bf16_f32 v112, v28, v29
    v_cvt_pk_bf16_f32 v113, v30, v31
    v_cvt_pk_bf16_f32 v114, v32, v33
    v_cvt_pk_bf16_f32 v115, v34, v35
    v_mfma_f32_32x32x16_bf16 v[20:35], v[68:71], v[140:143], 0
    ds_read_b128 v[88:91], v167 offset:27648
    v_exp_f32 v4, v4
    v_exp_f32 v5, v5
    v_exp_f32 v6, v6
    v_exp_f32 v7, v7
    v_mfma_f32_32x32x16_bf16 v[52:67], v[92:95], v[108:111], v[52:67]
    v_exp_f32 v8, v8
    v_exp_f32 v9, v9
    v_exp_f32 v10, v10
    v_exp_f32 v11, v11
    v_mfma_f32_32x32x16_bf16 v[20:35], v[72:75], v[144:147], v[20:35]
    v_exp_f32 v12, v12
    v_exp_f32 v13, v13
    v_exp_f32 v14, v14
    v_exp_f32 v15, v15
    v_mfma_f32_32x32x16_bf16 v[52:67], v[96:99], v[112:115], v[52:67]
    v_exp_f32 v16, v16
    v_exp_f32 v17, v17
    v_exp_f32 v18, v18
    v_exp_f32 v19, v19
    v_smfmac_f32_16x16x64_bf16 v[152:155], v[156:159], v[108:115], v160
    ds_read_b128 v[68:71], v161 offset:16384
    v_cvt_pk_bf16_f32 v100, v4, v5
    v_cvt_pk_bf16_f32 v101, v6, v7
    v_cvt_pk_bf16_f32 v102, v8, v9
    v_cvt_pk_bf16_f32 v103, v10, v11
    v_cvt_pk_bf16_f32 v104, v12, v13
    v_cvt_pk_bf16_f32 v105, v14, v15
    v_cvt_pk_bf16_f32 v106, v16, v17
    v_cvt_pk_bf16_f32 v107, v18, v19
    s_waitcnt lgkmcnt(1)
    v_mfma_f32_32x32x16_bf16 v[4:19], v[76:79], v[132:135], 0
    v_exp_f32 v20, v20
    v_exp_f32 v21, v21
    v_exp_f32 v22, v22
    v_exp_f32 v23, v23
    v_mfma_f32_32x32x16_bf16 v[36:51], v[84:87], v[100:103], v[36:51]
    ds_read_b128 v[92:95], v167 offset:30720
    v_exp_f32 v24, v24
    v_exp_f32 v25, v25
    v_exp_f32 v26, v26
    v_exp_f32 v27, v27
    v_mfma_f32_32x32x16_bf16 v[4:19], v[80:83], v[136:139], v[4:19]
    v_exp_f32 v28, v28
    v_exp_f32 v29, v29
    v_exp_f32 v30, v30
    v_exp_f32 v31, v31
    v_mfma_f32_32x32x16_bf16 v[36:51], v[88:91], v[104:107], v[36:51]
    v_exp_f32 v32, v32
    v_exp_f32 v33, v33
    v_exp_f32 v34, v34
    v_exp_f32 v35, v35
    v_smfmac_f32_16x16x64_bf16 v[148:151], v[156:159], v[100:107], v160
    ds_read_b128 v[72:75], v161 offset:17408
    v_cvt_pk_bf16_f32 v108, v20, v21
    v_cvt_pk_bf16_f32 v109, v22, v23
    v_cvt_pk_bf16_f32 v110, v24, v25
    v_cvt_pk_bf16_f32 v111, v26, v27
    v_cvt_pk_bf16_f32 v112, v28, v29
    v_cvt_pk_bf16_f32 v113, v30, v31
    v_cvt_pk_bf16_f32 v114, v32, v33
    v_cvt_pk_bf16_f32 v115, v34, v35
    v_mfma_f32_32x32x16_bf16 v[20:35], v[76:79], v[140:143], 0
    ds_read_b128 v[96:99], v167 offset:31744
    v_exp_f32 v4, v4
    v_exp_f32 v5, v5
    v_exp_f32 v6, v6
    v_exp_f32 v7, v7
    v_mfma_f32_32x32x16_bf16 v[52:67], v[84:87], v[108:111], v[52:67]
    v_exp_f32 v8, v8
    v_exp_f32 v9, v9
    v_exp_f32 v10, v10
    v_exp_f32 v11, v11
    v_mfma_f32_32x32x16_bf16 v[20:35], v[80:83], v[144:147], v[20:35]
    v_exp_f32 v12, v12
    v_exp_f32 v13, v13
    v_exp_f32 v14, v14
    v_exp_f32 v15, v15
    v_mfma_f32_32x32x16_bf16 v[52:67], v[88:91], v[112:115], v[52:67]
    v_exp_f32 v16, v16
    v_exp_f32 v17, v17
    v_exp_f32 v18, v18
    v_exp_f32 v19, v19
    v_smfmac_f32_16x16x64_bf16 v[152:155], v[156:159], v[108:115], v160
    ds_read_b128 v[76:79], v161 offset:20480
    v_cvt_pk_bf16_f32 v100, v4, v5
    v_cvt_pk_bf16_f32 v101, v6, v7
    v_cvt_pk_bf16_f32 v102, v8, v9
    v_cvt_pk_bf16_f32 v103, v10, v11
    v_cvt_pk_bf16_f32 v104, v12, v13
    v_cvt_pk_bf16_f32 v105, v14, v15
    v_cvt_pk_bf16_f32 v106, v16, v17
    v_cvt_pk_bf16_f32 v107, v18, v19
    s_waitcnt lgkmcnt(1)
    v_mfma_f32_32x32x16_bf16 v[4:19], v[68:71], v[132:135], 0
    v_exp_f32 v20, v20
    v_exp_f32 v21, v21
    v_exp_f32 v22, v22
    v_exp_f32 v23, v23
    v_mfma_f32_32x32x16_bf16 v[36:51], v[92:95], v[100:103], v[36:51]
    ds_read_b128 v[84:87], v161 offset:18432
    v_exp_f32 v24, v24
    v_exp_f32 v25, v25
    v_exp_f32 v26, v26
    v_exp_f32 v27, v27
    v_mfma_f32_32x32x16_bf16 v[4:19], v[72:75], v[136:139], v[4:19]
    v_exp_f32 v28, v28
    v_exp_f32 v29, v29
    v_exp_f32 v30, v30
    v_exp_f32 v31, v31
    v_mfma_f32_32x32x16_bf16 v[36:51], v[96:99], v[104:107], v[36:51]
    v_exp_f32 v32, v32
    v_exp_f32 v33, v33
    v_exp_f32 v34, v34
    v_exp_f32 v35, v35
    v_smfmac_f32_16x16x64_bf16 v[148:151], v[156:159], v[100:107], v160
    ds_read_b128 v[80:83], v161 offset:21504
    v_cvt_pk_bf16_f32 v108, v20, v21
    v_cvt_pk_bf16_f32 v109, v22, v23
    v_cvt_pk_bf16_f32 v110, v24, v25
    v_cvt_pk_bf16_f32 v111, v26, v27
    v_cvt_pk_bf16_f32 v112, v28, v29
    v_cvt_pk_bf16_f32 v113, v30, v31
    v_cvt_pk_bf16_f32 v114, v32, v33
    v_cvt_pk_bf16_f32 v115, v34, v35
    v_mfma_f32_32x32x16_bf16 v[20:35], v[68:71], v[140:143], 0
    ds_read_b128 v[88:91], v161 offset:19456
    v_exp_f32 v4, v4
    v_exp_f32 v5, v5
    v_exp_f32 v6, v6
    v_exp_f32 v7, v7
    v_mfma_f32_32x32x16_bf16 v[52:67], v[92:95], v[108:111], v[52:67]
    v_exp_f32 v8, v8
    v_exp_f32 v9, v9
    v_exp_f32 v10, v10
    v_exp_f32 v11, v11
    v_mfma_f32_32x32x16_bf16 v[20:35], v[72:75], v[144:147], v[20:35]
    v_exp_f32 v12, v12
    v_exp_f32 v13, v13
    v_exp_f32 v14, v14
    v_exp_f32 v15, v15
    v_mfma_f32_32x32x16_bf16 v[52:67], v[96:99], v[112:115], v[52:67]
    v_exp_f32 v16, v16
    v_exp_f32 v17, v17
    v_exp_f32 v18, v18
    v_exp_f32 v19, v19
    v_smfmac_f32_16x16x64_bf16 v[152:155], v[156:159], v[108:115], v160
    ds_read_b128 v[68:71], v161 offset:24576
    v_cvt_pk_bf16_f32 v100, v4, v5
    v_cvt_pk_bf16_f32 v101, v6, v7
    v_cvt_pk_bf16_f32 v102, v8, v9
    v_cvt_pk_bf16_f32 v103, v10, v11
    v_cvt_pk_bf16_f32 v104, v12, v13
    v_cvt_pk_bf16_f32 v105, v14, v15
    v_cvt_pk_bf16_f32 v106, v16, v17
    v_cvt_pk_bf16_f32 v107, v18, v19
    s_waitcnt lgkmcnt(1)
    v_mfma_f32_32x32x16_bf16 v[4:19], v[76:79], v[132:135], 0
    v_exp_f32 v20, v20
    v_exp_f32 v21, v21
    v_exp_f32 v22, v22
    v_exp_f32 v23, v23
    v_mfma_f32_32x32x16_bf16 v[36:51], v[84:87], v[100:103], v[36:51]
    ds_read_b128 v[92:95], v161 offset:22528
    v_exp_f32 v24, v24
    v_exp_f32 v25, v25
    v_exp_f32 v26, v26
    v_exp_f32 v27, v27
    v_mfma_f32_32x32x16_bf16 v[4:19], v[80:83], v[136:139], v[4:19]
    v_exp_f32 v28, v28
    v_exp_f32 v29, v29
    v_exp_f32 v30, v30
    v_exp_f32 v31, v31
    v_mfma_f32_32x32x16_bf16 v[36:51], v[88:91], v[104:107], v[36:51]
    v_exp_f32 v32, v32
    v_exp_f32 v33, v33
    v_exp_f32 v34, v34
    v_exp_f32 v35, v35
    v_smfmac_f32_16x16x64_bf16 v[148:151], v[156:159], v[100:107], v160
    ds_read_b128 v[72:75], v161 offset:25600
    v_cvt_pk_bf16_f32 v108, v20, v21
    v_cvt_pk_bf16_f32 v109, v22, v23
    v_cvt_pk_bf16_f32 v110, v24, v25
    v_cvt_pk_bf16_f32 v111, v26, v27
    v_cvt_pk_bf16_f32 v112, v28, v29
    v_cvt_pk_bf16_f32 v113, v30, v31
    v_cvt_pk_bf16_f32 v114, v32, v33
    v_cvt_pk_bf16_f32 v115, v34, v35
    v_mfma_f32_32x32x16_bf16 v[20:35], v[76:79], v[140:143], 0
    ds_read_b128 v[96:99], v161 offset:23552
    v_exp_f32 v4, v4
    v_exp_f32 v5, v5
    v_exp_f32 v6, v6
    v_exp_f32 v7, v7
    v_mfma_f32_32x32x16_bf16 v[52:67], v[84:87], v[108:111], v[52:67]
    v_exp_f32 v8, v8
    v_exp_f32 v9, v9
    v_exp_f32 v10, v10
    v_exp_f32 v11, v11
    v_mfma_f32_32x32x16_bf16 v[20:35], v[80:83], v[144:147], v[20:35]
    v_exp_f32 v12, v12
    v_exp_f32 v13, v13
    v_exp_f32 v14, v14
    v_exp_f32 v15, v15
    v_mfma_f32_32x32x16_bf16 v[52:67], v[88:91], v[112:115], v[52:67]
    v_exp_f32 v16, v16
    v_exp_f32 v17, v17
    v_exp_f32 v18, v18
    v_exp_f32 v19, v19
    v_smfmac_f32_16x16x64_bf16 v[152:155], v[156:159], v[108:115], v160
    ds_read_b128 v[76:79], v161 offset:28672
    v_cvt_pk_bf16_f32 v100, v4, v5
    v_cvt_pk_bf16_f32 v101, v6, v7
    v_cvt_pk_bf16_f32 v102, v8, v9
    v_cvt_pk_bf16_f32 v103, v10, v11
    v_cvt_pk_bf16_f32 v104, v12, v13
    v_cvt_pk_bf16_f32 v105, v14, v15
    v_cvt_pk_bf16_f32 v106, v16, v17
    v_cvt_pk_bf16_f32 v107, v18, v19
    s_waitcnt lgkmcnt(1)
    v_mfma_f32_32x32x16_bf16 v[4:19], v[68:71], v[132:135], 0
    v_exp_f32 v20, v20
    v_exp_f32 v21, v21
    v_exp_f32 v22, v22
    v_exp_f32 v23, v23
    v_mfma_f32_32x32x16_bf16 v[36:51], v[92:95], v[100:103], v[36:51]
    ds_read_b128 v[84:87], v161 offset:26624
    v_exp_f32 v24, v24
    v_exp_f32 v25, v25
    v_exp_f32 v26, v26
    v_exp_f32 v27, v27
    v_mfma_f32_32x32x16_bf16 v[4:19], v[72:75], v[136:139], v[4:19]
    v_exp_f32 v28, v28
    v_exp_f32 v29, v29
    v_exp_f32 v30, v30
    v_exp_f32 v31, v31
    v_mfma_f32_32x32x16_bf16 v[36:51], v[96:99], v[104:107], v[36:51]
    v_exp_f32 v32, v32
    v_exp_f32 v33, v33
    v_exp_f32 v34, v34
    v_exp_f32 v35, v35
    v_smfmac_f32_16x16x64_bf16 v[148:151], v[156:159], v[100:107], v160
    ds_read_b128 v[80:83], v161 offset:29696
    v_cvt_pk_bf16_f32 v108, v20, v21
    v_cvt_pk_bf16_f32 v109, v22, v23
    v_cvt_pk_bf16_f32 v110, v24, v25
    v_cvt_pk_bf16_f32 v111, v26, v27
    v_cvt_pk_bf16_f32 v112, v28, v29
    v_cvt_pk_bf16_f32 v113, v30, v31
    v_cvt_pk_bf16_f32 v114, v32, v33
    v_cvt_pk_bf16_f32 v115, v34, v35
    v_mfma_f32_32x32x16_bf16 v[20:35], v[68:71], v[140:143], 0
    ds_read_b128 v[88:91], v161 offset:27648
    v_exp_f32 v4, v4
    v_exp_f32 v5, v5
    v_exp_f32 v6, v6
    v_exp_f32 v7, v7
    v_mfma_f32_32x32x16_bf16 v[52:67], v[92:95], v[108:111], v[52:67]
    v_exp_f32 v8, v8
    v_exp_f32 v9, v9
    v_exp_f32 v10, v10
    v_exp_f32 v11, v11
    v_mfma_f32_32x32x16_bf16 v[20:35], v[72:75], v[144:147], v[20:35]
    v_exp_f32 v12, v12
    v_exp_f32 v13, v13
    v_exp_f32 v14, v14
    v_exp_f32 v15, v15
    v_mfma_f32_32x32x16_bf16 v[52:67], v[96:99], v[112:115], v[52:67]
    s_barrier
    v_exp_f32 v16, v16
    v_exp_f32 v17, v17
    v_exp_f32 v18, v18
    v_exp_f32 v19, v19
    v_smfmac_f32_16x16x64_bf16 v[152:155], v[156:159], v[108:115], v160
    ds_read_b128 v[68:71], v167 offset:32768
    v_cvt_pk_bf16_f32 v100, v4, v5
    v_cvt_pk_bf16_f32 v101, v6, v7
    v_cvt_pk_bf16_f32 v102, v8, v9
    v_cvt_pk_bf16_f32 v103, v10, v11
    v_cvt_pk_bf16_f32 v104, v12, v13
    v_cvt_pk_bf16_f32 v105, v14, v15
    v_cvt_pk_bf16_f32 v106, v16, v17
    v_cvt_pk_bf16_f32 v107, v18, v19
    s_waitcnt lgkmcnt(1)
    v_mfma_f32_32x32x16_bf16 v[4:19], v[76:79], v[132:135], 0
    v_exp_f32 v20, v20
    v_exp_f32 v21, v21
    v_exp_f32 v22, v22
    v_exp_f32 v23, v23
    v_mfma_f32_32x32x16_bf16 v[36:51], v[84:87], v[100:103], v[36:51]
    ds_read_b128 v[92:95], v161 offset:30720
    v_exp_f32 v24, v24
    v_exp_f32 v25, v25
    v_exp_f32 v26, v26
    v_exp_f32 v27, v27
    v_mfma_f32_32x32x16_bf16 v[4:19], v[80:83], v[136:139], v[4:19]
    v_exp_f32 v28, v28
    v_exp_f32 v29, v29
    v_exp_f32 v30, v30
    v_exp_f32 v31, v31
    v_mfma_f32_32x32x16_bf16 v[36:51], v[88:91], v[104:107], v[36:51]
    v_exp_f32 v32, v32
    v_exp_f32 v33, v33
    v_exp_f32 v34, v34
    v_exp_f32 v35, v35
    v_smfmac_f32_16x16x64_bf16 v[148:151], v[156:159], v[100:107], v160
    ds_read_b128 v[72:75], v167 offset:33792
    v_cvt_pk_bf16_f32 v108, v20, v21
    v_cvt_pk_bf16_f32 v109, v22, v23
    v_cvt_pk_bf16_f32 v110, v24, v25
    v_cvt_pk_bf16_f32 v111, v26, v27
    v_cvt_pk_bf16_f32 v112, v28, v29
    v_cvt_pk_bf16_f32 v113, v30, v31
    v_cvt_pk_bf16_f32 v114, v32, v33
    v_cvt_pk_bf16_f32 v115, v34, v35
    v_mfma_f32_32x32x16_bf16 v[20:35], v[76:79], v[140:143], 0
    ds_read_b128 v[96:99], v161 offset:31744
    v_exp_f32 v4, v4
    v_exp_f32 v5, v5
    v_exp_f32 v6, v6
    v_exp_f32 v7, v7
    v_mfma_f32_32x32x16_bf16 v[52:67], v[84:87], v[108:111], v[52:67]
    v_exp_f32 v8, v8
    v_exp_f32 v9, v9
    v_exp_f32 v10, v10
    v_exp_f32 v11, v11
    v_mfma_f32_32x32x16_bf16 v[20:35], v[80:83], v[144:147], v[20:35]
    v_exp_f32 v12, v12
    v_exp_f32 v13, v13
    v_exp_f32 v14, v14
    v_exp_f32 v15, v15
    v_mfma_f32_32x32x16_bf16 v[52:67], v[88:91], v[112:115], v[52:67]
    v_exp_f32 v16, v16
    v_exp_f32 v17, v17
    v_exp_f32 v18, v18
    v_exp_f32 v19, v19
    v_smfmac_f32_16x16x64_bf16 v[152:155], v[156:159], v[108:115], v160
    ds_read_b128 v[76:79], v167 offset:36864
    v_cvt_pk_bf16_f32 v100, v4, v5
    v_cvt_pk_bf16_f32 v101, v6, v7
    v_cvt_pk_bf16_f32 v102, v8, v9
    v_cvt_pk_bf16_f32 v103, v10, v11
    v_cvt_pk_bf16_f32 v104, v12, v13
    v_cvt_pk_bf16_f32 v105, v14, v15
    v_cvt_pk_bf16_f32 v106, v16, v17
    v_cvt_pk_bf16_f32 v107, v18, v19
    s_waitcnt lgkmcnt(1)
    v_mfma_f32_32x32x16_bf16 v[4:19], v[68:71], v[132:135], 0
    v_exp_f32 v20, v20
    v_exp_f32 v21, v21
    v_exp_f32 v22, v22
    v_exp_f32 v23, v23
    v_mfma_f32_32x32x16_bf16 v[36:51], v[92:95], v[100:103], v[36:51]
    ds_read_b128 v[84:87], v167 offset:34816
    v_exp_f32 v24, v24
    v_exp_f32 v25, v25
    v_exp_f32 v26, v26
    v_exp_f32 v27, v27
    v_mfma_f32_32x32x16_bf16 v[4:19], v[72:75], v[136:139], v[4:19]
    v_exp_f32 v28, v28
    v_exp_f32 v29, v29
    v_exp_f32 v30, v30
    v_exp_f32 v31, v31
    v_mfma_f32_32x32x16_bf16 v[36:51], v[96:99], v[104:107], v[36:51]
    v_exp_f32 v32, v32
    v_exp_f32 v33, v33
    v_exp_f32 v34, v34
    v_exp_f32 v35, v35
    v_smfmac_f32_16x16x64_bf16 v[148:151], v[156:159], v[100:107], v160
    ds_read_b128 v[80:83], v167 offset:37888
    v_cvt_pk_bf16_f32 v108, v20, v21
    v_cvt_pk_bf16_f32 v109, v22, v23
    v_cvt_pk_bf16_f32 v110, v24, v25
    v_cvt_pk_bf16_f32 v111, v26, v27
    v_cvt_pk_bf16_f32 v112, v28, v29
    v_cvt_pk_bf16_f32 v113, v30, v31
    v_cvt_pk_bf16_f32 v114, v32, v33
    v_cvt_pk_bf16_f32 v115, v34, v35
    v_mfma_f32_32x32x16_bf16 v[20:35], v[68:71], v[140:143], 0
    ds_read_b128 v[88:91], v167 offset:35840
    v_exp_f32 v4, v4
    v_exp_f32 v5, v5
    v_exp_f32 v6, v6
    v_exp_f32 v7, v7
    v_mfma_f32_32x32x16_bf16 v[52:67], v[92:95], v[108:111], v[52:67]
    v_exp_f32 v8, v8
    v_exp_f32 v9, v9
    v_exp_f32 v10, v10
    v_exp_f32 v11, v11
    v_mfma_f32_32x32x16_bf16 v[20:35], v[72:75], v[144:147], v[20:35]
    v_exp_f32 v12, v12
    v_exp_f32 v13, v13
    v_exp_f32 v14, v14
    v_exp_f32 v15, v15
    v_mfma_f32_32x32x16_bf16 v[52:67], v[96:99], v[112:115], v[52:67]
    v_exp_f32 v16, v16
    v_exp_f32 v17, v17
    v_exp_f32 v18, v18
    v_exp_f32 v19, v19
    v_smfmac_f32_16x16x64_bf16 v[152:155], v[156:159], v[108:115], v160
    ds_read_b128 v[68:71], v167 offset:40960
    v_cvt_pk_bf16_f32 v100, v4, v5
    v_cvt_pk_bf16_f32 v101, v6, v7
    v_cvt_pk_bf16_f32 v102, v8, v9
    v_cvt_pk_bf16_f32 v103, v10, v11
    v_cvt_pk_bf16_f32 v104, v12, v13
    v_cvt_pk_bf16_f32 v105, v14, v15
    v_cvt_pk_bf16_f32 v106, v16, v17
    v_cvt_pk_bf16_f32 v107, v18, v19
    s_waitcnt lgkmcnt(1)
    v_mfma_f32_32x32x16_bf16 v[4:19], v[76:79], v[132:135], 0
    v_exp_f32 v20, v20
    v_exp_f32 v21, v21
    v_exp_f32 v22, v22
    v_exp_f32 v23, v23
    v_mfma_f32_32x32x16_bf16 v[36:51], v[84:87], v[100:103], v[36:51]
    ds_read_b128 v[92:95], v167 offset:38912
    v_exp_f32 v24, v24
    v_exp_f32 v25, v25
    v_exp_f32 v26, v26
    v_exp_f32 v27, v27
    v_mfma_f32_32x32x16_bf16 v[4:19], v[80:83], v[136:139], v[4:19]
    v_exp_f32 v28, v28
    v_exp_f32 v29, v29
    v_exp_f32 v30, v30
    v_exp_f32 v31, v31
    v_mfma_f32_32x32x16_bf16 v[36:51], v[88:91], v[104:107], v[36:51]
    v_exp_f32 v32, v32
    v_exp_f32 v33, v33
    v_exp_f32 v34, v34
    v_exp_f32 v35, v35
    v_smfmac_f32_16x16x64_bf16 v[148:151], v[156:159], v[100:107], v160
    ds_read_b128 v[72:75], v167 offset:41984
    v_cvt_pk_bf16_f32 v108, v20, v21
    v_cvt_pk_bf16_f32 v109, v22, v23
    v_cvt_pk_bf16_f32 v110, v24, v25
    v_cvt_pk_bf16_f32 v111, v26, v27
    v_cvt_pk_bf16_f32 v112, v28, v29
    v_cvt_pk_bf16_f32 v113, v30, v31
    v_cvt_pk_bf16_f32 v114, v32, v33
    v_cvt_pk_bf16_f32 v115, v34, v35
    v_mfma_f32_32x32x16_bf16 v[20:35], v[76:79], v[140:143], 0
    ds_read_b128 v[96:99], v167 offset:39936
    v_exp_f32 v4, v4
    v_exp_f32 v5, v5
    v_exp_f32 v6, v6
    v_exp_f32 v7, v7
    v_mfma_f32_32x32x16_bf16 v[52:67], v[84:87], v[108:111], v[52:67]
    v_exp_f32 v8, v8
    v_exp_f32 v9, v9
    v_exp_f32 v10, v10
    v_exp_f32 v11, v11
    v_mfma_f32_32x32x16_bf16 v[20:35], v[80:83], v[144:147], v[20:35]
    v_exp_f32 v12, v12
    v_exp_f32 v13, v13
    v_exp_f32 v14, v14
    v_exp_f32 v15, v15
    v_mfma_f32_32x32x16_bf16 v[52:67], v[88:91], v[112:115], v[52:67]
    v_exp_f32 v16, v16
    v_exp_f32 v17, v17
    v_exp_f32 v18, v18
    v_exp_f32 v19, v19
    v_smfmac_f32_16x16x64_bf16 v[152:155], v[156:159], v[108:115], v160
    ds_read_b128 v[76:79], v167 offset:45056
    v_cvt_pk_bf16_f32 v100, v4, v5
    v_cvt_pk_bf16_f32 v101, v6, v7
    v_cvt_pk_bf16_f32 v102, v8, v9
    v_cvt_pk_bf16_f32 v103, v10, v11
    v_cvt_pk_bf16_f32 v104, v12, v13
    v_cvt_pk_bf16_f32 v105, v14, v15
    v_cvt_pk_bf16_f32 v106, v16, v17
    v_cvt_pk_bf16_f32 v107, v18, v19
    s_waitcnt lgkmcnt(1)
    v_mfma_f32_32x32x16_bf16 v[4:19], v[68:71], v[132:135], 0
    v_exp_f32 v20, v20
    v_exp_f32 v21, v21
    v_exp_f32 v22, v22
    v_exp_f32 v23, v23
    v_mfma_f32_32x32x16_bf16 v[36:51], v[92:95], v[100:103], v[36:51]
    ds_read_b128 v[84:87], v167 offset:43008
    v_exp_f32 v24, v24
    v_exp_f32 v25, v25
    v_exp_f32 v26, v26
    v_exp_f32 v27, v27
    v_mfma_f32_32x32x16_bf16 v[4:19], v[72:75], v[136:139], v[4:19]
    v_exp_f32 v28, v28
    v_exp_f32 v29, v29
    v_exp_f32 v30, v30
    v_exp_f32 v31, v31
    v_mfma_f32_32x32x16_bf16 v[36:51], v[96:99], v[104:107], v[36:51]
    v_exp_f32 v32, v32
    v_exp_f32 v33, v33
    v_exp_f32 v34, v34
    v_exp_f32 v35, v35
    v_smfmac_f32_16x16x64_bf16 v[148:151], v[156:159], v[100:107], v160
    ds_read_b128 v[80:83], v167 offset:46080
    v_cvt_pk_bf16_f32 v108, v20, v21
    v_cvt_pk_bf16_f32 v109, v22, v23
    v_cvt_pk_bf16_f32 v110, v24, v25
    v_cvt_pk_bf16_f32 v111, v26, v27
    v_cvt_pk_bf16_f32 v112, v28, v29
    v_cvt_pk_bf16_f32 v113, v30, v31
    v_cvt_pk_bf16_f32 v114, v32, v33
    v_cvt_pk_bf16_f32 v115, v34, v35
    v_mfma_f32_32x32x16_bf16 v[20:35], v[68:71], v[140:143], 0
    ds_read_b128 v[88:91], v167 offset:44032
    v_exp_f32 v4, v4
    v_exp_f32 v5, v5
    v_exp_f32 v6, v6
    v_exp_f32 v7, v7
    v_mfma_f32_32x32x16_bf16 v[52:67], v[92:95], v[108:111], v[52:67]
    v_exp_f32 v8, v8
    v_exp_f32 v9, v9
    v_exp_f32 v10, v10
    v_exp_f32 v11, v11
    v_mfma_f32_32x32x16_bf16 v[20:35], v[72:75], v[144:147], v[20:35]
    v_exp_f32 v12, v12
    v_exp_f32 v13, v13
    v_exp_f32 v14, v14
    v_exp_f32 v15, v15
    v_mfma_f32_32x32x16_bf16 v[52:67], v[96:99], v[112:115], v[52:67]
    v_exp_f32 v16, v16
    v_exp_f32 v17, v17
    v_exp_f32 v18, v18
    v_exp_f32 v19, v19
    v_smfmac_f32_16x16x64_bf16 v[152:155], v[156:159], v[108:115], v160
    ds_read_b128 v[68:71], v161 offset:32768
    v_cvt_pk_bf16_f32 v100, v4, v5
    v_cvt_pk_bf16_f32 v101, v6, v7
    v_cvt_pk_bf16_f32 v102, v8, v9
    v_cvt_pk_bf16_f32 v103, v10, v11
    v_cvt_pk_bf16_f32 v104, v12, v13
    v_cvt_pk_bf16_f32 v105, v14, v15
    v_cvt_pk_bf16_f32 v106, v16, v17
    v_cvt_pk_bf16_f32 v107, v18, v19
    s_waitcnt lgkmcnt(1)
    v_mfma_f32_32x32x16_bf16 v[4:19], v[76:79], v[132:135], 0
    v_exp_f32 v20, v20
    v_exp_f32 v21, v21
    v_exp_f32 v22, v22
    v_exp_f32 v23, v23
    v_mfma_f32_32x32x16_bf16 v[36:51], v[84:87], v[100:103], v[36:51]
    ds_read_b128 v[92:95], v167 offset:47104
    v_exp_f32 v24, v24
    v_exp_f32 v25, v25
    v_exp_f32 v26, v26
    v_exp_f32 v27, v27
    v_mfma_f32_32x32x16_bf16 v[4:19], v[80:83], v[136:139], v[4:19]
    v_exp_f32 v28, v28
    v_exp_f32 v29, v29
    v_exp_f32 v30, v30
    v_exp_f32 v31, v31
    v_mfma_f32_32x32x16_bf16 v[36:51], v[88:91], v[104:107], v[36:51]
    v_exp_f32 v32, v32
    v_exp_f32 v33, v33
    v_exp_f32 v34, v34
    v_exp_f32 v35, v35
    v_smfmac_f32_16x16x64_bf16 v[148:151], v[156:159], v[100:107], v160
    ds_read_b128 v[72:75], v161 offset:33792
    v_cvt_pk_bf16_f32 v108, v20, v21
    v_cvt_pk_bf16_f32 v109, v22, v23
    v_cvt_pk_bf16_f32 v110, v24, v25
    v_cvt_pk_bf16_f32 v111, v26, v27
    v_cvt_pk_bf16_f32 v112, v28, v29
    v_cvt_pk_bf16_f32 v113, v30, v31
    v_cvt_pk_bf16_f32 v114, v32, v33
    v_cvt_pk_bf16_f32 v115, v34, v35
    v_mfma_f32_32x32x16_bf16 v[20:35], v[76:79], v[140:143], 0
    ds_read_b128 v[96:99], v167 offset:48128
    v_exp_f32 v4, v4
    v_exp_f32 v5, v5
    v_exp_f32 v6, v6
    v_exp_f32 v7, v7
    v_mfma_f32_32x32x16_bf16 v[52:67], v[84:87], v[108:111], v[52:67]
    v_exp_f32 v8, v8
    v_exp_f32 v9, v9
    v_exp_f32 v10, v10
    v_exp_f32 v11, v11
    v_mfma_f32_32x32x16_bf16 v[20:35], v[80:83], v[144:147], v[20:35]
    v_exp_f32 v12, v12
    v_exp_f32 v13, v13
    v_exp_f32 v14, v14
    v_exp_f32 v15, v15
    v_mfma_f32_32x32x16_bf16 v[52:67], v[88:91], v[112:115], v[52:67]
    v_exp_f32 v16, v16
    v_exp_f32 v17, v17
    v_exp_f32 v18, v18
    v_exp_f32 v19, v19
    v_smfmac_f32_16x16x64_bf16 v[152:155], v[156:159], v[108:115], v160
    ds_read_b128 v[76:79], v161 offset:36864
    v_cvt_pk_bf16_f32 v100, v4, v5
    v_cvt_pk_bf16_f32 v101, v6, v7
    v_cvt_pk_bf16_f32 v102, v8, v9
    v_cvt_pk_bf16_f32 v103, v10, v11
    v_cvt_pk_bf16_f32 v104, v12, v13
    v_cvt_pk_bf16_f32 v105, v14, v15
    v_cvt_pk_bf16_f32 v106, v16, v17
    v_cvt_pk_bf16_f32 v107, v18, v19
    s_waitcnt lgkmcnt(1)
    v_mfma_f32_32x32x16_bf16 v[4:19], v[68:71], v[132:135], 0
    v_exp_f32 v20, v20
    v_exp_f32 v21, v21
    v_exp_f32 v22, v22
    v_exp_f32 v23, v23
    v_mfma_f32_32x32x16_bf16 v[36:51], v[92:95], v[100:103], v[36:51]
    ds_read_b128 v[84:87], v161 offset:34816
    v_exp_f32 v24, v24
    v_exp_f32 v25, v25
    v_exp_f32 v26, v26
    v_exp_f32 v27, v27
    v_mfma_f32_32x32x16_bf16 v[4:19], v[72:75], v[136:139], v[4:19]
    v_exp_f32 v28, v28
    v_exp_f32 v29, v29
    v_exp_f32 v30, v30
    v_exp_f32 v31, v31
    v_mfma_f32_32x32x16_bf16 v[36:51], v[96:99], v[104:107], v[36:51]
    v_exp_f32 v32, v32
    v_exp_f32 v33, v33
    v_exp_f32 v34, v34
    v_exp_f32 v35, v35
    v_smfmac_f32_16x16x64_bf16 v[148:151], v[156:159], v[100:107], v160
    ds_read_b128 v[80:83], v161 offset:37888
    v_cvt_pk_bf16_f32 v108, v20, v21
    v_cvt_pk_bf16_f32 v109, v22, v23
    v_cvt_pk_bf16_f32 v110, v24, v25
    v_cvt_pk_bf16_f32 v111, v26, v27
    v_cvt_pk_bf16_f32 v112, v28, v29
    v_cvt_pk_bf16_f32 v113, v30, v31
    v_cvt_pk_bf16_f32 v114, v32, v33
    v_cvt_pk_bf16_f32 v115, v34, v35
    v_mfma_f32_32x32x16_bf16 v[20:35], v[68:71], v[140:143], 0
    ds_read_b128 v[88:91], v161 offset:35840
    v_exp_f32 v4, v4
    v_exp_f32 v5, v5
    v_exp_f32 v6, v6
    v_exp_f32 v7, v7
    v_mfma_f32_32x32x16_bf16 v[52:67], v[92:95], v[108:111], v[52:67]
    v_exp_f32 v8, v8
    v_exp_f32 v9, v9
    v_exp_f32 v10, v10
    v_exp_f32 v11, v11
    v_mfma_f32_32x32x16_bf16 v[20:35], v[72:75], v[144:147], v[20:35]
    v_exp_f32 v12, v12
    v_exp_f32 v13, v13
    v_exp_f32 v14, v14
    v_exp_f32 v15, v15
    v_mfma_f32_32x32x16_bf16 v[52:67], v[96:99], v[112:115], v[52:67]
    v_exp_f32 v16, v16
    v_exp_f32 v17, v17
    v_exp_f32 v18, v18
    v_exp_f32 v19, v19
    v_smfmac_f32_16x16x64_bf16 v[152:155], v[156:159], v[108:115], v160
    ds_read_b128 v[68:71], v161 offset:40960
    v_cvt_pk_bf16_f32 v100, v4, v5
    v_cvt_pk_bf16_f32 v101, v6, v7
    v_cvt_pk_bf16_f32 v102, v8, v9
    v_cvt_pk_bf16_f32 v103, v10, v11
    v_cvt_pk_bf16_f32 v104, v12, v13
    v_cvt_pk_bf16_f32 v105, v14, v15
    v_cvt_pk_bf16_f32 v106, v16, v17
    v_cvt_pk_bf16_f32 v107, v18, v19
    s_waitcnt lgkmcnt(1)
    v_mfma_f32_32x32x16_bf16 v[4:19], v[76:79], v[132:135], 0
    v_exp_f32 v20, v20
    v_exp_f32 v21, v21
    v_exp_f32 v22, v22
    v_exp_f32 v23, v23
    v_mfma_f32_32x32x16_bf16 v[36:51], v[84:87], v[100:103], v[36:51]
    ds_read_b128 v[92:95], v161 offset:38912
    v_exp_f32 v24, v24
    v_exp_f32 v25, v25
    v_exp_f32 v26, v26
    v_exp_f32 v27, v27
    v_mfma_f32_32x32x16_bf16 v[4:19], v[80:83], v[136:139], v[4:19]
    v_exp_f32 v28, v28
    v_exp_f32 v29, v29
    v_exp_f32 v30, v30
    v_exp_f32 v31, v31
    v_mfma_f32_32x32x16_bf16 v[36:51], v[88:91], v[104:107], v[36:51]
    v_exp_f32 v32, v32
    v_exp_f32 v33, v33
    v_exp_f32 v34, v34
    v_exp_f32 v35, v35
    v_smfmac_f32_16x16x64_bf16 v[148:151], v[156:159], v[100:107], v160
    ds_read_b128 v[72:75], v161 offset:41984
    v_cvt_pk_bf16_f32 v108, v20, v21
    v_cvt_pk_bf16_f32 v109, v22, v23
    v_cvt_pk_bf16_f32 v110, v24, v25
    v_cvt_pk_bf16_f32 v111, v26, v27
    v_cvt_pk_bf16_f32 v112, v28, v29
    v_cvt_pk_bf16_f32 v113, v30, v31
    v_cvt_pk_bf16_f32 v114, v32, v33
    v_cvt_pk_bf16_f32 v115, v34, v35
    v_mfma_f32_32x32x16_bf16 v[20:35], v[76:79], v[140:143], 0
    ds_read_b128 v[96:99], v161 offset:39936
    v_exp_f32 v4, v4
    v_exp_f32 v5, v5
    v_exp_f32 v6, v6
    v_exp_f32 v7, v7
    v_mfma_f32_32x32x16_bf16 v[52:67], v[84:87], v[108:111], v[52:67]
    v_exp_f32 v8, v8
    v_exp_f32 v9, v9
    v_exp_f32 v10, v10
    v_exp_f32 v11, v11
    v_mfma_f32_32x32x16_bf16 v[20:35], v[80:83], v[144:147], v[20:35]
    v_exp_f32 v12, v12
    v_exp_f32 v13, v13
    v_exp_f32 v14, v14
    v_exp_f32 v15, v15
    v_mfma_f32_32x32x16_bf16 v[52:67], v[88:91], v[112:115], v[52:67]
    v_exp_f32 v16, v16
    v_exp_f32 v17, v17
    v_exp_f32 v18, v18
    v_exp_f32 v19, v19
    v_smfmac_f32_16x16x64_bf16 v[152:155], v[156:159], v[108:115], v160
    ds_read_b128 v[76:79], v161 offset:45056
    v_cvt_pk_bf16_f32 v100, v4, v5
    v_cvt_pk_bf16_f32 v101, v6, v7
    v_cvt_pk_bf16_f32 v102, v8, v9
    v_cvt_pk_bf16_f32 v103, v10, v11
    v_cvt_pk_bf16_f32 v104, v12, v13
    v_cvt_pk_bf16_f32 v105, v14, v15
    v_cvt_pk_bf16_f32 v106, v16, v17
    v_cvt_pk_bf16_f32 v107, v18, v19
    s_waitcnt lgkmcnt(1)
    v_mfma_f32_32x32x16_bf16 v[4:19], v[68:71], v[132:135], 0
    v_exp_f32 v20, v20
    v_exp_f32 v21, v21
    v_exp_f32 v22, v22
    v_exp_f32 v23, v23
    v_mfma_f32_32x32x16_bf16 v[36:51], v[92:95], v[100:103], v[36:51]
    ds_read_b128 v[84:87], v161 offset:43008
    v_exp_f32 v24, v24
    v_exp_f32 v25, v25
    v_exp_f32 v26, v26
    v_exp_f32 v27, v27
    v_mfma_f32_32x32x16_bf16 v[4:19], v[72:75], v[136:139], v[4:19]
    v_exp_f32 v28, v28
    v_exp_f32 v29, v29
    v_exp_f32 v30, v30
    v_exp_f32 v31, v31
    v_mfma_f32_32x32x16_bf16 v[36:51], v[96:99], v[104:107], v[36:51]
    v_exp_f32 v32, v32
    v_exp_f32 v33, v33
    v_exp_f32 v34, v34
    v_exp_f32 v35, v35
    v_smfmac_f32_16x16x64_bf16 v[148:151], v[156:159], v[100:107], v160
    ds_read_b128 v[80:83], v161 offset:46080
    v_cvt_pk_bf16_f32 v108, v20, v21
    v_cvt_pk_bf16_f32 v109, v22, v23
    v_cvt_pk_bf16_f32 v110, v24, v25
    v_cvt_pk_bf16_f32 v111, v26, v27
    v_cvt_pk_bf16_f32 v112, v28, v29
    v_cvt_pk_bf16_f32 v113, v30, v31
    v_cvt_pk_bf16_f32 v114, v32, v33
    v_cvt_pk_bf16_f32 v115, v34, v35
    v_mfma_f32_32x32x16_bf16 v[20:35], v[68:71], v[140:143], 0
    ds_read_b128 v[88:91], v161 offset:44032
    v_exp_f32 v4, v4
    v_exp_f32 v5, v5
    v_exp_f32 v6, v6
    v_exp_f32 v7, v7
    v_mfma_f32_32x32x16_bf16 v[52:67], v[92:95], v[108:111], v[52:67]
    v_exp_f32 v8, v8
    v_exp_f32 v9, v9
    v_exp_f32 v10, v10
    v_exp_f32 v11, v11
    v_mfma_f32_32x32x16_bf16 v[20:35], v[72:75], v[144:147], v[20:35]
    v_exp_f32 v12, v12
    v_exp_f32 v13, v13
    v_exp_f32 v14, v14
    v_exp_f32 v15, v15
    v_mfma_f32_32x32x16_bf16 v[52:67], v[96:99], v[112:115], v[52:67]
    s_barrier
    v_exp_f32 v16, v16
    v_exp_f32 v17, v17
    v_exp_f32 v18, v18
    v_exp_f32 v19, v19
    v_smfmac_f32_16x16x64_bf16 v[152:155], v[156:159], v[108:115], v160
    ds_read_b128 v[68:71], v167 offset:49152
    v_cvt_pk_bf16_f32 v100, v4, v5
    v_cvt_pk_bf16_f32 v101, v6, v7
    v_cvt_pk_bf16_f32 v102, v8, v9
    v_cvt_pk_bf16_f32 v103, v10, v11
    v_cvt_pk_bf16_f32 v104, v12, v13
    v_cvt_pk_bf16_f32 v105, v14, v15
    v_cvt_pk_bf16_f32 v106, v16, v17
    v_cvt_pk_bf16_f32 v107, v18, v19
    s_waitcnt lgkmcnt(1)
    v_mfma_f32_32x32x16_bf16 v[4:19], v[76:79], v[132:135], 0
    v_exp_f32 v20, v20
    v_exp_f32 v21, v21
    v_exp_f32 v22, v22
    v_exp_f32 v23, v23
    v_mfma_f32_32x32x16_bf16 v[36:51], v[84:87], v[100:103], v[36:51]
    ds_read_b128 v[92:95], v161 offset:47104
    v_exp_f32 v24, v24
    v_exp_f32 v25, v25
    v_exp_f32 v26, v26
    v_exp_f32 v27, v27
    v_mfma_f32_32x32x16_bf16 v[4:19], v[80:83], v[136:139], v[4:19]
    v_exp_f32 v28, v28
    v_exp_f32 v29, v29
    v_exp_f32 v30, v30
    v_exp_f32 v31, v31
    v_mfma_f32_32x32x16_bf16 v[36:51], v[88:91], v[104:107], v[36:51]
    v_exp_f32 v32, v32
    v_exp_f32 v33, v33
    v_exp_f32 v34, v34
    v_exp_f32 v35, v35
    v_smfmac_f32_16x16x64_bf16 v[148:151], v[156:159], v[100:107], v160
    ds_read_b128 v[72:75], v167 offset:50176
    v_cvt_pk_bf16_f32 v108, v20, v21
    v_cvt_pk_bf16_f32 v109, v22, v23
    v_cvt_pk_bf16_f32 v110, v24, v25
    v_cvt_pk_bf16_f32 v111, v26, v27
    v_cvt_pk_bf16_f32 v112, v28, v29
    v_cvt_pk_bf16_f32 v113, v30, v31
    v_cvt_pk_bf16_f32 v114, v32, v33
    v_cvt_pk_bf16_f32 v115, v34, v35
    v_mfma_f32_32x32x16_bf16 v[20:35], v[76:79], v[140:143], 0
    ds_read_b128 v[96:99], v161 offset:48128
    v_exp_f32 v4, v4
    v_exp_f32 v5, v5
    v_exp_f32 v6, v6
    v_exp_f32 v7, v7
    v_mfma_f32_32x32x16_bf16 v[52:67], v[84:87], v[108:111], v[52:67]
    v_exp_f32 v8, v8
    v_exp_f32 v9, v9
    v_exp_f32 v10, v10
    v_exp_f32 v11, v11
    v_mfma_f32_32x32x16_bf16 v[20:35], v[80:83], v[144:147], v[20:35]
    v_exp_f32 v12, v12
    v_exp_f32 v13, v13
    v_exp_f32 v14, v14
    v_exp_f32 v15, v15
    v_mfma_f32_32x32x16_bf16 v[52:67], v[88:91], v[112:115], v[52:67]
    v_exp_f32 v16, v16
    v_exp_f32 v17, v17
    v_exp_f32 v18, v18
    v_exp_f32 v19, v19
    v_smfmac_f32_16x16x64_bf16 v[152:155], v[156:159], v[108:115], v160
    ds_read_b128 v[76:79], v167 offset:53248
    v_cvt_pk_bf16_f32 v100, v4, v5
    v_cvt_pk_bf16_f32 v101, v6, v7
    v_cvt_pk_bf16_f32 v102, v8, v9
    v_cvt_pk_bf16_f32 v103, v10, v11
    v_cvt_pk_bf16_f32 v104, v12, v13
    v_cvt_pk_bf16_f32 v105, v14, v15
    v_cvt_pk_bf16_f32 v106, v16, v17
    v_cvt_pk_bf16_f32 v107, v18, v19
    s_waitcnt lgkmcnt(1)
    v_mfma_f32_32x32x16_bf16 v[4:19], v[68:71], v[132:135], 0
    v_exp_f32 v20, v20
    v_exp_f32 v21, v21
    v_exp_f32 v22, v22
    v_exp_f32 v23, v23
    v_mfma_f32_32x32x16_bf16 v[36:51], v[92:95], v[100:103], v[36:51]
    ds_read_b128 v[84:87], v167 offset:51200
    v_exp_f32 v24, v24
    v_exp_f32 v25, v25
    v_exp_f32 v26, v26
    v_exp_f32 v27, v27
    v_mfma_f32_32x32x16_bf16 v[4:19], v[72:75], v[136:139], v[4:19]
    v_exp_f32 v28, v28
    v_exp_f32 v29, v29
    v_exp_f32 v30, v30
    v_exp_f32 v31, v31
    v_mfma_f32_32x32x16_bf16 v[36:51], v[96:99], v[104:107], v[36:51]
    v_exp_f32 v32, v32
    v_exp_f32 v33, v33
    v_exp_f32 v34, v34
    v_exp_f32 v35, v35
    v_smfmac_f32_16x16x64_bf16 v[148:151], v[156:159], v[100:107], v160
    ds_read_b128 v[80:83], v167 offset:54272
    v_cvt_pk_bf16_f32 v108, v20, v21
    v_cvt_pk_bf16_f32 v109, v22, v23
    v_cvt_pk_bf16_f32 v110, v24, v25
    v_cvt_pk_bf16_f32 v111, v26, v27
    v_cvt_pk_bf16_f32 v112, v28, v29
    v_cvt_pk_bf16_f32 v113, v30, v31
    v_cvt_pk_bf16_f32 v114, v32, v33
    v_cvt_pk_bf16_f32 v115, v34, v35
    v_mfma_f32_32x32x16_bf16 v[20:35], v[68:71], v[140:143], 0
    ds_read_b128 v[88:91], v167 offset:52224
    v_exp_f32 v4, v4
    v_exp_f32 v5, v5
    v_exp_f32 v6, v6
    v_exp_f32 v7, v7
    v_mfma_f32_32x32x16_bf16 v[52:67], v[92:95], v[108:111], v[52:67]
    v_exp_f32 v8, v8
    v_exp_f32 v9, v9
    v_exp_f32 v10, v10
    v_exp_f32 v11, v11
    v_mfma_f32_32x32x16_bf16 v[20:35], v[72:75], v[144:147], v[20:35]
    v_exp_f32 v12, v12
    v_exp_f32 v13, v13
    v_exp_f32 v14, v14
    v_exp_f32 v15, v15
    v_mfma_f32_32x32x16_bf16 v[52:67], v[96:99], v[112:115], v[52:67]
    v_exp_f32 v16, v16
    v_exp_f32 v17, v17
    v_exp_f32 v18, v18
    v_exp_f32 v19, v19
    v_smfmac_f32_16x16x64_bf16 v[152:155], v[156:159], v[108:115], v160
    ds_read_b128 v[68:71], v167 offset:57344
    v_cvt_pk_bf16_f32 v100, v4, v5
    v_cvt_pk_bf16_f32 v101, v6, v7
    v_cvt_pk_bf16_f32 v102, v8, v9
    v_cvt_pk_bf16_f32 v103, v10, v11
    v_cvt_pk_bf16_f32 v104, v12, v13
    v_cvt_pk_bf16_f32 v105, v14, v15
    v_cvt_pk_bf16_f32 v106, v16, v17
    v_cvt_pk_bf16_f32 v107, v18, v19
    s_waitcnt lgkmcnt(1)
    v_mfma_f32_32x32x16_bf16 v[4:19], v[76:79], v[132:135], 0
    v_exp_f32 v20, v20
    v_exp_f32 v21, v21
    v_exp_f32 v22, v22
    v_exp_f32 v23, v23
    v_mfma_f32_32x32x16_bf16 v[36:51], v[84:87], v[100:103], v[36:51]
    ds_read_b128 v[92:95], v167 offset:55296
    v_exp_f32 v24, v24
    v_exp_f32 v25, v25
    v_exp_f32 v26, v26
    v_exp_f32 v27, v27
    v_mfma_f32_32x32x16_bf16 v[4:19], v[80:83], v[136:139], v[4:19]
    v_exp_f32 v28, v28
    v_exp_f32 v29, v29
    v_exp_f32 v30, v30
    v_exp_f32 v31, v31
    v_mfma_f32_32x32x16_bf16 v[36:51], v[88:91], v[104:107], v[36:51]
    v_exp_f32 v32, v32
    v_exp_f32 v33, v33
    v_exp_f32 v34, v34
    v_exp_f32 v35, v35
    v_smfmac_f32_16x16x64_bf16 v[148:151], v[156:159], v[100:107], v160
    ds_read_b128 v[72:75], v167 offset:58368
    v_cvt_pk_bf16_f32 v108, v20, v21
    v_cvt_pk_bf16_f32 v109, v22, v23
    v_cvt_pk_bf16_f32 v110, v24, v25
    v_cvt_pk_bf16_f32 v111, v26, v27
    v_cvt_pk_bf16_f32 v112, v28, v29
    v_cvt_pk_bf16_f32 v113, v30, v31
    v_cvt_pk_bf16_f32 v114, v32, v33
    v_cvt_pk_bf16_f32 v115, v34, v35
    v_mfma_f32_32x32x16_bf16 v[20:35], v[76:79], v[140:143], 0
    ds_read_b128 v[96:99], v167 offset:56320
    v_exp_f32 v4, v4
    v_exp_f32 v5, v5
    v_exp_f32 v6, v6
    v_exp_f32 v7, v7
    v_mfma_f32_32x32x16_bf16 v[52:67], v[84:87], v[108:111], v[52:67]
    v_exp_f32 v8, v8
    v_exp_f32 v9, v9
    v_exp_f32 v10, v10
    v_exp_f32 v11, v11
    v_mfma_f32_32x32x16_bf16 v[20:35], v[80:83], v[144:147], v[20:35]
    v_exp_f32 v12, v12
    v_exp_f32 v13, v13
    v_exp_f32 v14, v14
    v_exp_f32 v15, v15
    v_mfma_f32_32x32x16_bf16 v[52:67], v[88:91], v[112:115], v[52:67]
    v_exp_f32 v16, v16
    v_exp_f32 v17, v17
    v_exp_f32 v18, v18
    v_exp_f32 v19, v19
    v_smfmac_f32_16x16x64_bf16 v[152:155], v[156:159], v[108:115], v160
    ds_read_b128 v[76:79], v167 offset:61440
    v_cvt_pk_bf16_f32 v100, v4, v5
    v_cvt_pk_bf16_f32 v101, v6, v7
    v_cvt_pk_bf16_f32 v102, v8, v9
    v_cvt_pk_bf16_f32 v103, v10, v11
    v_cvt_pk_bf16_f32 v104, v12, v13
    v_cvt_pk_bf16_f32 v105, v14, v15
    v_cvt_pk_bf16_f32 v106, v16, v17
    v_cvt_pk_bf16_f32 v107, v18, v19
    s_waitcnt lgkmcnt(1)
    v_mfma_f32_32x32x16_bf16 v[4:19], v[68:71], v[132:135], 0
    v_exp_f32 v20, v20
    v_exp_f32 v21, v21
    v_exp_f32 v22, v22
    v_exp_f32 v23, v23
    v_mfma_f32_32x32x16_bf16 v[36:51], v[92:95], v[100:103], v[36:51]
    ds_read_b128 v[84:87], v167 offset:59392
    v_exp_f32 v24, v24
    v_exp_f32 v25, v25
    v_exp_f32 v26, v26
    v_exp_f32 v27, v27
    v_mfma_f32_32x32x16_bf16 v[4:19], v[72:75], v[136:139], v[4:19]
    v_exp_f32 v28, v28
    v_exp_f32 v29, v29
    v_exp_f32 v30, v30
    v_exp_f32 v31, v31
    v_mfma_f32_32x32x16_bf16 v[36:51], v[96:99], v[104:107], v[36:51]
    v_exp_f32 v32, v32
    v_exp_f32 v33, v33
    v_exp_f32 v34, v34
    v_exp_f32 v35, v35
    v_smfmac_f32_16x16x64_bf16 v[148:151], v[156:159], v[100:107], v160
    ds_read_b128 v[80:83], v167 offset:62464
    v_cvt_pk_bf16_f32 v108, v20, v21
    v_cvt_pk_bf16_f32 v109, v22, v23
    v_cvt_pk_bf16_f32 v110, v24, v25
    v_cvt_pk_bf16_f32 v111, v26, v27
    v_cvt_pk_bf16_f32 v112, v28, v29
    v_cvt_pk_bf16_f32 v113, v30, v31
    v_cvt_pk_bf16_f32 v114, v32, v33
    v_cvt_pk_bf16_f32 v115, v34, v35
    v_mfma_f32_32x32x16_bf16 v[20:35], v[68:71], v[140:143], 0
    ds_read_b128 v[88:91], v167 offset:60416
    v_exp_f32 v4, v4
    v_exp_f32 v5, v5
    v_exp_f32 v6, v6
    v_exp_f32 v7, v7
    v_mfma_f32_32x32x16_bf16 v[52:67], v[92:95], v[108:111], v[52:67]
    v_exp_f32 v8, v8
    v_exp_f32 v9, v9
    v_exp_f32 v10, v10
    v_exp_f32 v11, v11
    v_mfma_f32_32x32x16_bf16 v[20:35], v[72:75], v[144:147], v[20:35]
    v_exp_f32 v12, v12
    v_exp_f32 v13, v13
    v_exp_f32 v14, v14
    v_exp_f32 v15, v15
    v_mfma_f32_32x32x16_bf16 v[52:67], v[96:99], v[112:115], v[52:67]
    v_exp_f32 v16, v16
    v_exp_f32 v17, v17
    v_exp_f32 v18, v18
    v_exp_f32 v19, v19
    v_smfmac_f32_16x16x64_bf16 v[152:155], v[156:159], v[108:115], v160
    ds_read_b128 v[68:71], v161 offset:49152
    v_cvt_pk_bf16_f32 v100, v4, v5
    v_cvt_pk_bf16_f32 v101, v6, v7
    v_cvt_pk_bf16_f32 v102, v8, v9
    v_cvt_pk_bf16_f32 v103, v10, v11
    v_cvt_pk_bf16_f32 v104, v12, v13
    v_cvt_pk_bf16_f32 v105, v14, v15
    v_cvt_pk_bf16_f32 v106, v16, v17
    v_cvt_pk_bf16_f32 v107, v18, v19
    s_waitcnt lgkmcnt(1)
    v_mfma_f32_32x32x16_bf16 v[4:19], v[76:79], v[132:135], 0
    v_exp_f32 v20, v20
    v_exp_f32 v21, v21
    v_exp_f32 v22, v22
    v_exp_f32 v23, v23
    v_mfma_f32_32x32x16_bf16 v[36:51], v[84:87], v[100:103], v[36:51]
    ds_read_b128 v[92:95], v167 offset:63488
    v_exp_f32 v24, v24
    v_exp_f32 v25, v25
    v_exp_f32 v26, v26
    v_exp_f32 v27, v27
    v_mfma_f32_32x32x16_bf16 v[4:19], v[80:83], v[136:139], v[4:19]
    v_exp_f32 v28, v28
    v_exp_f32 v29, v29
    v_exp_f32 v30, v30
    v_exp_f32 v31, v31
    v_mfma_f32_32x32x16_bf16 v[36:51], v[88:91], v[104:107], v[36:51]
    v_exp_f32 v32, v32
    v_exp_f32 v33, v33
    v_exp_f32 v34, v34
    v_exp_f32 v35, v35
    v_smfmac_f32_16x16x64_bf16 v[148:151], v[156:159], v[100:107], v160
    ds_read_b128 v[72:75], v161 offset:50176
    v_cvt_pk_bf16_f32 v108, v20, v21
    v_cvt_pk_bf16_f32 v109, v22, v23
    v_cvt_pk_bf16_f32 v110, v24, v25
    v_cvt_pk_bf16_f32 v111, v26, v27
    v_cvt_pk_bf16_f32 v112, v28, v29
    v_cvt_pk_bf16_f32 v113, v30, v31
    v_cvt_pk_bf16_f32 v114, v32, v33
    v_cvt_pk_bf16_f32 v115, v34, v35
    v_mfma_f32_32x32x16_bf16 v[20:35], v[76:79], v[140:143], 0
    ds_read_b128 v[96:99], v167 offset:64512
    v_exp_f32 v4, v4
    v_exp_f32 v5, v5
    v_exp_f32 v6, v6
    v_exp_f32 v7, v7
    v_mfma_f32_32x32x16_bf16 v[52:67], v[84:87], v[108:111], v[52:67]
    v_exp_f32 v8, v8
    v_exp_f32 v9, v9
    v_exp_f32 v10, v10
    v_exp_f32 v11, v11
    v_mfma_f32_32x32x16_bf16 v[20:35], v[80:83], v[144:147], v[20:35]
    v_exp_f32 v12, v12
    v_exp_f32 v13, v13
    v_exp_f32 v14, v14
    v_exp_f32 v15, v15
    v_mfma_f32_32x32x16_bf16 v[52:67], v[88:91], v[112:115], v[52:67]
    v_exp_f32 v16, v16
    v_exp_f32 v17, v17
    v_exp_f32 v18, v18
    v_exp_f32 v19, v19
    v_smfmac_f32_16x16x64_bf16 v[152:155], v[156:159], v[108:115], v160
    ds_read_b128 v[76:79], v161 offset:53248
    v_cvt_pk_bf16_f32 v100, v4, v5
    v_cvt_pk_bf16_f32 v101, v6, v7
    v_cvt_pk_bf16_f32 v102, v8, v9
    v_cvt_pk_bf16_f32 v103, v10, v11
    v_cvt_pk_bf16_f32 v104, v12, v13
    v_cvt_pk_bf16_f32 v105, v14, v15
    v_cvt_pk_bf16_f32 v106, v16, v17
    v_cvt_pk_bf16_f32 v107, v18, v19
    s_waitcnt lgkmcnt(1)
    v_mfma_f32_32x32x16_bf16 v[4:19], v[68:71], v[132:135], 0
    v_exp_f32 v20, v20
    v_exp_f32 v21, v21
    v_exp_f32 v22, v22
    v_exp_f32 v23, v23
    v_mfma_f32_32x32x16_bf16 v[36:51], v[92:95], v[100:103], v[36:51]
    ds_read_b128 v[84:87], v161 offset:51200
    v_exp_f32 v24, v24
    v_exp_f32 v25, v25
    v_exp_f32 v26, v26
    v_exp_f32 v27, v27
    v_mfma_f32_32x32x16_bf16 v[4:19], v[72:75], v[136:139], v[4:19]
    v_exp_f32 v28, v28
    v_exp_f32 v29, v29
    v_exp_f32 v30, v30
    v_exp_f32 v31, v31
    v_mfma_f32_32x32x16_bf16 v[36:51], v[96:99], v[104:107], v[36:51]
    v_exp_f32 v32, v32
    v_exp_f32 v33, v33
    v_exp_f32 v34, v34
    v_exp_f32 v35, v35
    v_smfmac_f32_16x16x64_bf16 v[148:151], v[156:159], v[100:107], v160
    ds_read_b128 v[80:83], v161 offset:54272
    v_cvt_pk_bf16_f32 v108, v20, v21
    v_cvt_pk_bf16_f32 v109, v22, v23
    v_cvt_pk_bf16_f32 v110, v24, v25
    v_cvt_pk_bf16_f32 v111, v26, v27
    v_cvt_pk_bf16_f32 v112, v28, v29
    v_cvt_pk_bf16_f32 v113, v30, v31
    v_cvt_pk_bf16_f32 v114, v32, v33
    v_cvt_pk_bf16_f32 v115, v34, v35
    v_mfma_f32_32x32x16_bf16 v[20:35], v[68:71], v[140:143], 0
    ds_read_b128 v[88:91], v161 offset:52224
    v_exp_f32 v4, v4
    v_exp_f32 v5, v5
    v_exp_f32 v6, v6
    v_exp_f32 v7, v7
    v_mfma_f32_32x32x16_bf16 v[52:67], v[92:95], v[108:111], v[52:67]
    v_exp_f32 v8, v8
    v_exp_f32 v9, v9
    v_exp_f32 v10, v10
    v_exp_f32 v11, v11
    v_mfma_f32_32x32x16_bf16 v[20:35], v[72:75], v[144:147], v[20:35]
    v_exp_f32 v12, v12
    v_exp_f32 v13, v13
    v_exp_f32 v14, v14
    v_exp_f32 v15, v15
    v_mfma_f32_32x32x16_bf16 v[52:67], v[96:99], v[112:115], v[52:67]
    v_exp_f32 v16, v16
    v_exp_f32 v17, v17
    v_exp_f32 v18, v18
    v_exp_f32 v19, v19
    v_smfmac_f32_16x16x64_bf16 v[152:155], v[156:159], v[108:115], v160
    ds_read_b128 v[68:71], v161 offset:57344
    v_cvt_pk_bf16_f32 v100, v4, v5
    v_cvt_pk_bf16_f32 v101, v6, v7
    v_cvt_pk_bf16_f32 v102, v8, v9
    v_cvt_pk_bf16_f32 v103, v10, v11
    v_cvt_pk_bf16_f32 v104, v12, v13
    v_cvt_pk_bf16_f32 v105, v14, v15
    v_cvt_pk_bf16_f32 v106, v16, v17
    v_cvt_pk_bf16_f32 v107, v18, v19
    s_waitcnt lgkmcnt(1)
    v_mfma_f32_32x32x16_bf16 v[4:19], v[76:79], v[132:135], 0
    v_exp_f32 v20, v20
    v_exp_f32 v21, v21
    v_exp_f32 v22, v22
    v_exp_f32 v23, v23
    v_mfma_f32_32x32x16_bf16 v[36:51], v[84:87], v[100:103], v[36:51]
    ds_read_b128 v[92:95], v161 offset:55296
    v_exp_f32 v24, v24
    v_exp_f32 v25, v25
    v_exp_f32 v26, v26
    v_exp_f32 v27, v27
    v_mfma_f32_32x32x16_bf16 v[4:19], v[80:83], v[136:139], v[4:19]
    v_exp_f32 v28, v28
    v_exp_f32 v29, v29
    v_exp_f32 v30, v30
    v_exp_f32 v31, v31
    v_mfma_f32_32x32x16_bf16 v[36:51], v[88:91], v[104:107], v[36:51]
    v_exp_f32 v32, v32
    v_exp_f32 v33, v33
    v_exp_f32 v34, v34
    v_exp_f32 v35, v35
    v_smfmac_f32_16x16x64_bf16 v[148:151], v[156:159], v[100:107], v160
    ds_read_b128 v[72:75], v161 offset:58368
    v_cvt_pk_bf16_f32 v108, v20, v21
    v_cvt_pk_bf16_f32 v109, v22, v23
    v_cvt_pk_bf16_f32 v110, v24, v25
    v_cvt_pk_bf16_f32 v111, v26, v27
    v_cvt_pk_bf16_f32 v112, v28, v29
    v_cvt_pk_bf16_f32 v113, v30, v31
    v_cvt_pk_bf16_f32 v114, v32, v33
    v_cvt_pk_bf16_f32 v115, v34, v35
    v_mfma_f32_32x32x16_bf16 v[20:35], v[76:79], v[140:143], 0
    ds_read_b128 v[96:99], v161 offset:56320
    v_exp_f32 v4, v4
    v_exp_f32 v5, v5
    v_exp_f32 v6, v6
    v_exp_f32 v7, v7
    v_mfma_f32_32x32x16_bf16 v[52:67], v[84:87], v[108:111], v[52:67]
    v_exp_f32 v8, v8
    v_exp_f32 v9, v9
    v_exp_f32 v10, v10
    v_exp_f32 v11, v11
    v_mfma_f32_32x32x16_bf16 v[20:35], v[80:83], v[144:147], v[20:35]
    v_exp_f32 v12, v12
    v_exp_f32 v13, v13
    v_exp_f32 v14, v14
    v_exp_f32 v15, v15
    v_mfma_f32_32x32x16_bf16 v[52:67], v[88:91], v[112:115], v[52:67]
    v_exp_f32 v16, v16
    v_exp_f32 v17, v17
    v_exp_f32 v18, v18
    v_exp_f32 v19, v19
    v_smfmac_f32_16x16x64_bf16 v[152:155], v[156:159], v[108:115], v160
    ds_read_b128 v[76:79], v161 offset:61440
    v_cvt_pk_bf16_f32 v100, v4, v5
    v_cvt_pk_bf16_f32 v101, v6, v7
    v_cvt_pk_bf16_f32 v102, v8, v9
    v_cvt_pk_bf16_f32 v103, v10, v11
    v_cvt_pk_bf16_f32 v104, v12, v13
    v_cvt_pk_bf16_f32 v105, v14, v15
    v_cvt_pk_bf16_f32 v106, v16, v17
    v_cvt_pk_bf16_f32 v107, v18, v19
    s_waitcnt lgkmcnt(1)
    v_mfma_f32_32x32x16_bf16 v[4:19], v[68:71], v[132:135], 0
    v_exp_f32 v20, v20
    v_exp_f32 v21, v21
    v_exp_f32 v22, v22
    v_exp_f32 v23, v23
    v_mfma_f32_32x32x16_bf16 v[36:51], v[92:95], v[100:103], v[36:51]
    ds_read_b128 v[84:87], v161 offset:59392
    v_exp_f32 v24, v24
    v_exp_f32 v25, v25
    v_exp_f32 v26, v26
    v_exp_f32 v27, v27
    v_mfma_f32_32x32x16_bf16 v[4:19], v[72:75], v[136:139], v[4:19]
    v_exp_f32 v28, v28
    v_exp_f32 v29, v29
    v_exp_f32 v30, v30
    v_exp_f32 v31, v31
    v_mfma_f32_32x32x16_bf16 v[36:51], v[96:99], v[104:107], v[36:51]
    v_exp_f32 v32, v32
    v_exp_f32 v33, v33
    v_exp_f32 v34, v34
    v_exp_f32 v35, v35
    v_smfmac_f32_16x16x64_bf16 v[148:151], v[156:159], v[100:107], v160
    ds_read_b128 v[80:83], v161 offset:62464
    v_cvt_pk_bf16_f32 v108, v20, v21
    v_cvt_pk_bf16_f32 v109, v22, v23
    v_cvt_pk_bf16_f32 v110, v24, v25
    v_cvt_pk_bf16_f32 v111, v26, v27
    v_cvt_pk_bf16_f32 v112, v28, v29
    v_cvt_pk_bf16_f32 v113, v30, v31
    v_cvt_pk_bf16_f32 v114, v32, v33
    v_cvt_pk_bf16_f32 v115, v34, v35
    v_mfma_f32_32x32x16_bf16 v[20:35], v[68:71], v[140:143], 0
    ds_read_b128 v[88:91], v161 offset:60416
    v_exp_f32 v4, v4
    v_exp_f32 v5, v5
    v_exp_f32 v6, v6
    v_exp_f32 v7, v7
    v_mfma_f32_32x32x16_bf16 v[52:67], v[92:95], v[108:111], v[52:67]
    v_exp_f32 v8, v8
    v_exp_f32 v9, v9
    v_exp_f32 v10, v10
    v_exp_f32 v11, v11
    v_mfma_f32_32x32x16_bf16 v[20:35], v[72:75], v[144:147], v[20:35]
    v_exp_f32 v12, v12
    v_exp_f32 v13, v13
    v_exp_f32 v14, v14
    v_exp_f32 v15, v15
    v_mfma_f32_32x32x16_bf16 v[52:67], v[96:99], v[112:115], v[52:67]
    s_barrier
    v_exp_f32 v16, v16
    v_exp_f32 v17, v17
    v_exp_f32 v18, v18
    v_exp_f32 v19, v19
    v_smfmac_f32_16x16x64_bf16 v[152:155], v[156:159], v[108:115], v160
    ds_read_b128 v[68:71], v167 offset:0
    v_cvt_pk_bf16_f32 v100, v4, v5
    v_cvt_pk_bf16_f32 v101, v6, v7
    v_cvt_pk_bf16_f32 v102, v8, v9
    v_cvt_pk_bf16_f32 v103, v10, v11
    v_cvt_pk_bf16_f32 v104, v12, v13
    v_cvt_pk_bf16_f32 v105, v14, v15
    v_cvt_pk_bf16_f32 v106, v16, v17
    v_cvt_pk_bf16_f32 v107, v18, v19
    s_waitcnt lgkmcnt(1)
    v_mfma_f32_32x32x16_bf16 v[4:19], v[76:79], v[132:135], 0
    v_exp_f32 v20, v20
    v_exp_f32 v21, v21
    v_exp_f32 v22, v22
    v_exp_f32 v23, v23
    v_mfma_f32_32x32x16_bf16 v[36:51], v[84:87], v[100:103], v[36:51]
    ds_read_b128 v[92:95], v161 offset:63488
    v_exp_f32 v24, v24
    v_exp_f32 v25, v25
    v_exp_f32 v26, v26
    v_exp_f32 v27, v27
    v_mfma_f32_32x32x16_bf16 v[4:19], v[80:83], v[136:139], v[4:19]
    v_exp_f32 v28, v28
    v_exp_f32 v29, v29
    v_exp_f32 v30, v30
    v_exp_f32 v31, v31
    v_mfma_f32_32x32x16_bf16 v[36:51], v[88:91], v[104:107], v[36:51]
    v_exp_f32 v32, v32
    v_exp_f32 v33, v33
    v_exp_f32 v34, v34
    v_exp_f32 v35, v35
    v_smfmac_f32_16x16x64_bf16 v[148:151], v[156:159], v[100:107], v160
    ds_read_b128 v[72:75], v167 offset:1024
    v_cvt_pk_bf16_f32 v108, v20, v21
    v_cvt_pk_bf16_f32 v109, v22, v23
    v_cvt_pk_bf16_f32 v110, v24, v25
    v_cvt_pk_bf16_f32 v111, v26, v27
    v_cvt_pk_bf16_f32 v112, v28, v29
    v_cvt_pk_bf16_f32 v113, v30, v31
    v_cvt_pk_bf16_f32 v114, v32, v33
    v_cvt_pk_bf16_f32 v115, v34, v35
    v_mfma_f32_32x32x16_bf16 v[20:35], v[76:79], v[140:143], 0
    ds_read_b128 v[96:99], v161 offset:64512
    v_exp_f32 v4, v4
    v_exp_f32 v5, v5
    v_exp_f32 v6, v6
    v_exp_f32 v7, v7
    v_mfma_f32_32x32x16_bf16 v[52:67], v[84:87], v[108:111], v[52:67]
    v_exp_f32 v8, v8
    v_exp_f32 v9, v9
    v_exp_f32 v10, v10
    v_exp_f32 v11, v11
    v_mfma_f32_32x32x16_bf16 v[20:35], v[80:83], v[144:147], v[20:35]
    v_exp_f32 v12, v12
    v_exp_f32 v13, v13
    v_exp_f32 v14, v14
    v_exp_f32 v15, v15
    v_mfma_f32_32x32x16_bf16 v[52:67], v[88:91], v[112:115], v[52:67]
    v_exp_f32 v16, v16
    v_exp_f32 v17, v17
    v_exp_f32 v18, v18
    v_exp_f32 v19, v19
    v_smfmac_f32_16x16x64_bf16 v[152:155], v[156:159], v[108:115], v160
    ds_read_b128 v[76:79], v167 offset:4096
    v_cvt_pk_bf16_f32 v100, v4, v5
    v_cvt_pk_bf16_f32 v101, v6, v7
    v_cvt_pk_bf16_f32 v102, v8, v9
    v_cvt_pk_bf16_f32 v103, v10, v11
    v_cvt_pk_bf16_f32 v104, v12, v13
    v_cvt_pk_bf16_f32 v105, v14, v15
    v_cvt_pk_bf16_f32 v106, v16, v17
    v_cvt_pk_bf16_f32 v107, v18, v19
    s_waitcnt lgkmcnt(1)
    v_mfma_f32_32x32x16_bf16 v[4:19], v[68:71], v[132:135], 0
    v_exp_f32 v20, v20
    v_exp_f32 v21, v21
    v_exp_f32 v22, v22
    v_exp_f32 v23, v23
    v_mfma_f32_32x32x16_bf16 v[36:51], v[92:95], v[100:103], v[36:51]
    ds_read_b128 v[84:87], v167 offset:2048
    v_exp_f32 v24, v24
    v_exp_f32 v25, v25
    v_exp_f32 v26, v26
    v_exp_f32 v27, v27
    v_mfma_f32_32x32x16_bf16 v[4:19], v[72:75], v[136:139], v[4:19]
    v_exp_f32 v28, v28
    v_exp_f32 v29, v29
    v_exp_f32 v30, v30
    v_exp_f32 v31, v31
    v_mfma_f32_32x32x16_bf16 v[36:51], v[96:99], v[104:107], v[36:51]
    v_exp_f32 v32, v32
    v_exp_f32 v33, v33
    v_exp_f32 v34, v34
    v_exp_f32 v35, v35
    v_smfmac_f32_16x16x64_bf16 v[148:151], v[156:159], v[100:107], v160
    ds_read_b128 v[80:83], v167 offset:5120
    v_cvt_pk_bf16_f32 v108, v20, v21
    v_cvt_pk_bf16_f32 v109, v22, v23
    v_cvt_pk_bf16_f32 v110, v24, v25
    v_cvt_pk_bf16_f32 v111, v26, v27
    v_cvt_pk_bf16_f32 v112, v28, v29
    v_cvt_pk_bf16_f32 v113, v30, v31
    v_cvt_pk_bf16_f32 v114, v32, v33
    v_cvt_pk_bf16_f32 v115, v34, v35
    s_add_u32 s58, s58, 1
    s_cmp_lt_u32 s58, 2
    s_cbranch_scc1 L_att_loop
    s_waitcnt lgkmcnt(0)
    v_mfma_f32_32x32x16_bf16 v[52:67], v[92:95], v[108:111], v[52:67]
    v_smfmac_f32_16x16x64_bf16 v[152:155], v[156:159], v[108:115], v160
    v_mfma_f32_32x32x16_bf16 v[52:67], v[96:99], v[112:115], v[52:67]
    s_mov_b32 s26, 0x2b800000
    s_mov_b32 s27, 0x53800000
    v_mov_b32 v20, 0
    v_mov_b32 v21, 0
    v_mov_b32 v22, 0
    v_mov_b32 v23, 0
    v_mov_b32 v24, 0
    v_mov_b32 v25, 0
    v_add_f32 v148, v148, v149
    v_cmp_le_f32 s[40:41], s26, v148
    v_cmp_ge_f32 s[42:43], s27, v148
    v_rcp_f32 v148, v148
    v_pk_fma_f32 v[20:21], v[36:37], v[22:23], v[20:21]
    v_pk_fma_f32 v[24:25], v[38:39], v[22:23], v[24:25]
    v_pk_fma_f32 v[20:21], v[40:41], v[22:23], v[20:21]
    v_pk_fma_f32 v[24:25], v[42:43], v[22:23], v[24:25]
    v_pk_fma_f32 v[20:21], v[44:45], v[22:23], v[20:21]
    v_pk_fma_f32 v[24:25], v[46:47], v[22:23], v[24:25]
    v_pk_fma_f32 v[20:21], v[48:49], v[22:23], v[20:21]
    v_pk_fma_f32 v[24:25], v[50:51], v[22:23], v[24:25]
    v_pk_mul_f32 v[36:37], v[36:37], v[148:149] op_sel_hi:[1,0]
    v_pk_mul_f32 v[38:39], v[38:39], v[148:149] op_sel_hi:[1,0]
    v_pk_mul_f32 v[40:41], v[40:41], v[148:149] op_sel_hi:[1,0]
    v_pk_mul_f32 v[42:43], v[42:43], v[148:149] op_sel_hi:[1,0]
    v_pk_mul_f32 v[44:45], v[44:45], v[148:149] op_sel_hi:[1,0]
    v_pk_mul_f32 v[46:47], v[46:47], v[148:149] op_sel_hi:[1,0]
    v_pk_mul_f32 v[48:49], v[48:49], v[148:149] op_sel_hi:[1,0]
    v_pk_mul_f32 v[50:51], v[50:51], v[148:149] op_sel_hi:[1,0]
    v_cvt_pk_bf16_f32 v36, v36, v37
    v_cvt_pk_bf16_f32 v37, v38, v39
    v_cvt_pk_bf16_f32 v38, v40, v41
    v_cvt_pk_bf16_f32 v39, v42, v43
    v_cvt_pk_bf16_f32 v40, v44, v45
    v_cvt_pk_bf16_f32 v41, v46, v47
    v_cvt_pk_bf16_f32 v42, v48, v49
    v_cvt_pk_bf16_f32 v43, v50, v51
    buffer_store_dwordx4 v[36:39], v162, s[12:15], 0 offen sc1
    buffer_store_dwordx4 v[40:43], v162, s[12:15], 0 offen offset:512 sc1
    v_add_f32 v152, v152, v153
    v_cmp_le_f32 s[44:45], s26, v152
    v_cmp_ge_f32 s[46:47], s27, v152
    v_rcp_f32 v152, v152
    v_pk_fma_f32 v[20:21], v[52:53], v[22:23], v[20:21]
    v_pk_fma_f32 v[24:25], v[54:55], v[22:23], v[24:25]
    v_pk_fma_f32 v[20:21], v[56:57], v[22:23], v[20:21]
    v_pk_fma_f32 v[24:25], v[58:59], v[22:23], v[24:25]
    v_pk_fma_f32 v[20:21], v[60:61], v[22:23], v[20:21]
    v_pk_fma_f32 v[24:25], v[62:63], v[22:23], v[24:25]
    v_pk_fma_f32 v[20:21], v[64:65], v[22:23], v[20:21]
    v_pk_fma_f32 v[24:25], v[66:67], v[22:23], v[24:25]
    v_pk_add_f32 v[20:21], v[20:21], v[24:25]
    v_add_u32 v163, 0x10000, v162
    v_add_f32 v20, v20, v21
    s_and_b64 s[40:41], s[40:41], s[42:43]
    s_and_b64 s[44:45], s[44:45], s[46:47]
    v_cmp_eq_f32 vcc, 0, v20
    s_and_b64 s[40:41], s[40:41], s[44:45]
    s_nop 0
    s_and_b64 vcc, vcc, s[40:41]
    s_cmp_eq_u64 vcc, exec
    s_cbranch_scc0 L_att_slow
L_att_store:
    s_lshl_b32 s26, s24, 12
    s_add_u32 s26, s26, 131072
    v_add_u32 v164, s26, v167
    ds_read_b128 v[132:135], v164
    ds_read_b128 v[136:139], v164 offset:1024
    ds_read_b128 v[140:143], v164 offset:2048
    ds_read_b128 v[144:147], v164 offset:3072
    v_pk_mul_f32 v[52:53], v[52:53], v[152:153] op_sel_hi:[1,0]
    v_pk_mul_f32 v[54:55], v[54:55], v[152:153] op_sel_hi:[1,0]
    v_pk_mul_f32 v[56:57], v[56:57], v[152:153] op_sel_hi:[1,0]
    v_pk_mul_f32 v[58:59], v[58:59], v[152:153] op_sel_hi:[1,0]
    v_pk_mul_f32 v[60:61], v[60:61], v[152:153] op_sel_hi:[1,0]
    v_pk_mul_f32 v[62:63], v[62:63], v[152:153] op_sel_hi:[1,0]
    v_pk_mul_f32 v[64:65], v[64:65], v[152:153] op_sel_hi:[1,0]
    v_pk_mul_f32 v[66:67], v[66:67], v[152:153] op_sel_hi:[1,0]
    v_cvt_pk_bf16_f32 v52, v52, v53
    v_cvt_pk_bf16_f32 v53, v54, v55
    v_cvt_pk_bf16_f32 v54, v56, v57
    v_cvt_pk_bf16_f32 v55, v58, v59
    v_cvt_pk_bf16_f32 v56, v60, v61
    v_cvt_pk_bf16_f32 v57, v62, v63
    v_cvt_pk_bf16_f32 v58, v64, v65
    v_cvt_pk_bf16_f32 v59, v66, v67
    buffer_store_dwordx4 v[52:55], v163, s[12:15], 0 offen sc1
    buffer_store_dwordx4 v[56:59], v163, s[12:15], 0 offen offset:512 sc1
    s_add_u32 s33, s33, 1
    s_cmp_lt_u32 s33, 2
    s_cbranch_scc1 L_att_phase
    v_and_b32 v68, 15, v2
    v_lshrrev_b32 v69, 4, v2
    s_lshl_b32 s26, s56, 13
    v_add_u32 v156, s26, v167
    v_lshrrev_b32 v70, 2, v68
    v_and_b32 v71, 1, v69
    v_lshlrev_b32 v71, 2, v71
    v_or_b32 v71, v71, v70
    v_lshrrev_b32 v72, 1, v69
    v_lshlrev_b32 v72, 4, v72
    v_add_u32 v72, v72, v71
    v_lshlrev_b32 v72, 8, v72
    s_lshl_b32 s26, s57, 2
    v_xor_b32 v71, s26, v71
    v_lshlrev_b32 v71, 5, v71
    v_add_u32 v71, v71, v72
    v_and_b32 v73, 3, v68
    v_lshlrev_b32 v73, 3, v73
    v_add_u32 v71, v71, v73
    v_add_u32 v158, 65536, v71
    v_xor_b32 v159, 32, v158
    v_xor_b32 v160, 64, v158
    v_xor_b32 v161, 96, v158
    ds_read_b64_tr_b16 v[100:101], v158 offset:0
    ds_read_b64_tr_b16 v[102:103], v158 offset:2048
    ds_read_b128 v[68:71], v156 offset:0
    ds_read_b64_tr_b16 v[104:105], v159 offset:0
    ds_read_b64_tr_b16 v[106:107], v159 offset:2048
    ds_read_b64_tr_b16 v[108:109], v160 offset:0
    ds_read_b64_tr_b16 v[110:111], v160 offset:2048
    ds_read_b64_tr_b16 v[112:113], v161 offset:0
    ds_read_b64_tr_b16 v[114:115], v161 offset:2048
    ds_read_b128 v[72:75], v156 offset:2048
    ds_read_b128 v[76:79], v156 offset:4096
    ds_read_b128 v[80:83], v156 offset:6144
    v_and_b32 v84, 15, v2
    v_lshrrev_b32 v85, 4, v2
    v_lshlrev_b32 v86, 12, v84
    v_and_b32 v87, 1, v85
    v_lshlrev_b32 v87, 5, v87
    v_lshrrev_b32 v88, 1, v85
    v_lshlrev_b32 v88, 4, v88
    v_add_u32 v86, v86, v87
    v_add_u32 v163, v86, v88
    v_add_u32 v164, 65536, v163
    v_add_u32 v165, 131072, v163
    v_add_u32 v166, 196608, v163
    s_lshl_b32 s26, s87, 7
    s_lshl_b32 s27, s56, 6
    s_add_u32 s26, s26, s27
    s_lshl_b32 s26, s26, 12
    s_lshl_b32 s27, s84, 11
    s_lshl_b32 s28, s88, 8
    s_add_u32 s27, s27, s28
    s_lshl_b32 s28, s57, 7
    s_add_u32 s27, s27, s28
    s_add_u32 s26, s26, s27
    s_sub_u32 s29, 8388608, s26
    s_add_u32 s20, s80, s26
    s_addc_u32 s21, s81, 0
    s_and_b32 s21, s21, 0xffff
    s_mov_b32 s22, s29
    s_mov_b32 s23, 0x20000
    s_waitcnt lgkmcnt(9)
    v_mfma_f32_16x16x32_bf16 v[4:7], v[100:103], v[68:71], 0
    ds_read_b64_tr_b16 v[116:117], v158 offset:8192
    s_waitcnt lgkmcnt(8)
    v_mfma_f32_16x16x32_bf16 v[8:11], v[104:107], v[68:71], 0
    ds_read_b64_tr_b16 v[118:119], v158 offset:10240
    s_waitcnt lgkmcnt(7)
    v_mfma_f32_16x16x32_bf16 v[12:15], v[108:111], v[68:71], 0
    ds_read_b128 v[84:87], v156 offset:1024
    s_waitcnt lgkmcnt(6)
    v_mfma_f32_16x16x32_bf16 v[16:19], v[112:115], v[68:71], 0
    ds_read_b64_tr_b16 v[120:121], v159 offset:8192
    s_waitcnt lgkmcnt(6)
    v_mfma_f32_16x16x32_bf16 v[20:23], v[100:103], v[72:75], 0
    ds_read_b64_tr_b16 v[122:123], v159 offset:10240
    v_mfma_f32_16x16x32_bf16 v[24:27], v[104:107], v[72:75], 0
    ds_read_b64_tr_b16 v[124:125], v160 offset:8192
    v_mfma_f32_16x16x32_bf16 v[28:31], v[108:111], v[72:75], 0
    ds_read_b64_tr_b16 v[126:127], v160 offset:10240
    v_mfma_f32_16x16x32_bf16 v[32:35], v[112:115], v[72:75], 0
    ds_read_b64_tr_b16 v[128:129], v161 offset:8192
    s_waitcnt lgkmcnt(9)
    v_mfma_f32_16x16x32_bf16 v[36:39], v[100:103], v[76:79], 0
    ds_read_b64_tr_b16 v[130:131], v161 offset:10240
    v_mfma_f32_16x16x32_bf16 v[40:43], v[104:107], v[76:79], 0
    ds_read_b128 v[88:91], v156 offset:3072
    v_mfma_f32_16x16x32_bf16 v[44:47], v[108:111], v[76:79], 0
    ds_read_b128 v[92:95], v156 offset:5120
    v_mfma_f32_16x16x32_bf16 v[48:51], v[112:115], v[76:79], 0
    ds_read_b128 v[96:99], v156 offset:7168
    s_waitcnt lgkmcnt(12)
    v_mfma_f32_16x16x32_bf16 v[52:55], v[100:103], v[80:83], 0
    v_mfma_f32_16x16x32_bf16 v[56:59], v[104:107], v[80:83], 0
    v_mfma_f32_16x16x32_bf16 v[60:63], v[108:111], v[80:83], 0
    v_mfma_f32_16x16x32_bf16 v[64:67], v[112:115], v[80:83], 0
    s_mov_b32 s58, 0
.p2align 6
L_loop_G2:
    s_waitcnt lgkmcnt(9)
    v_mfma_f32_16x16x32_bf16 v[4:7], v[116:119], v[84:87], v[4:7]
    s_waitcnt lgkmcnt(7)
    v_mfma_f32_16x16x32_bf16 v[8:11], v[120:123], v[84:87], v[8:11]
    s_waitcnt lgkmcnt(5)
    v_mfma_f32_16x16x32_bf16 v[12:15], v[124:127], v[84:87], v[12:15]
    s_waitcnt lgkmcnt(3)
    v_mfma_f32_16x16x32_bf16 v[16:19], v[128:131], v[84:87], v[16:19]
    s_waitcnt lgkmcnt(0)
    s_waitcnt vmcnt(0)
    s_barrier
    ds_read_b64_tr_b16 v[100:101], v158 offset:16384
    v_mfma_f32_16x16x32_bf16 v[20:23], v[116:119], v[88:91], v[20:23]
    ds_read_b64_tr_b16 v[102:103], v158 offset:18432
    v_mfma_f32_16x16x32_bf16 v[24:27], v[120:123], v[88:91], v[24:27]
    ds_read_b128 v[68:71], v156 offset:16384
    v_mfma_f32_16x16x32_bf16 v[28:31], v[124:127], v[88:91], v[28:31]
    ds_read_b64_tr_b16 v[104:105], v159 offset:16384
    v_mfma_f32_16x16x32_bf16 v[32:35], v[128:131], v[88:91], v[32:35]
    ds_read_b64_tr_b16 v[106:107], v159 offset:18432
    v_mfma_f32_16x16x32_bf16 v[36:39], v[116:119], v[92:95], v[36:39]
    ds_read_b64_tr_b16 v[108:109], v160 offset:16384
    v_mfma_f32_16x16x32_bf16 v[40:43], v[120:123], v[92:95], v[40:43]
    ds_read_b64_tr_b16 v[110:111], v160 offset:18432
    v_mfma_f32_16x16x32_bf16 v[44:47], v[124:127], v[92:95], v[44:47]
    ds_read_b64_tr_b16 v[112:113], v161 offset:16384
    v_mfma_f32_16x16x32_bf16 v[48:51], v[128:131], v[92:95], v[48:51]
    ds_read_b64_tr_b16 v[114:115], v161 offset:18432
    v_mfma_f32_16x16x32_bf16 v[52:55], v[116:119], v[96:99], v[52:55]
    ds_read_b128 v[72:75], v156 offset:18432
    v_mfma_f32_16x16x32_bf16 v[56:59], v[120:123], v[96:99], v[56:59]
    ds_read_b128 v[76:79], v156 offset:20480
    v_mfma_f32_16x16x32_bf16 v[60:63], v[124:127], v[96:99], v[60:63]
    ds_read_b128 v[80:83], v156 offset:22528
    v_mfma_f32_16x16x32_bf16 v[64:67], v[128:131], v[96:99], v[64:67]
    s_waitcnt lgkmcnt(9)
    v_mfma_f32_16x16x32_bf16 v[4:7], v[100:103], v[68:71], v[4:7]
    ds_read_b64_tr_b16 v[116:117], v158 offset:24576
    s_waitcnt lgkmcnt(8)
    v_mfma_f32_16x16x32_bf16 v[8:11], v[104:107], v[68:71], v[8:11]
    ds_read_b64_tr_b16 v[118:119], v158 offset:26624
    s_waitcnt lgkmcnt(7)
    v_mfma_f32_16x16x32_bf16 v[12:15], v[108:111], v[68:71], v[12:15]
    ds_read_b128 v[84:87], v156 offset:17408
    s_waitcnt lgkmcnt(6)
    v_mfma_f32_16x16x32_bf16 v[16:19], v[112:115], v[68:71], v[16:19]
    ds_read_b64_tr_b16 v[120:121], v159 offset:24576
    s_waitcnt lgkmcnt(6)
    v_mfma_f32_16x16x32_bf16 v[20:23], v[100:103], v[72:75], v[20:23]
    ds_read_b64_tr_b16 v[122:123], v159 offset:26624
    v_mfma_f32_16x16x32_bf16 v[24:27], v[104:107], v[72:75], v[24:27]
    ds_read_b64_tr_b16 v[124:125], v160 offset:24576
    v_mfma_f32_16x16x32_bf16 v[28:31], v[108:111], v[72:75], v[28:31]
    ds_read_b64_tr_b16 v[126:127], v160 offset:26624
    v_mfma_f32_16x16x32_bf16 v[32:35], v[112:115], v[72:75], v[32:35]
    ds_read_b64_tr_b16 v[128:129], v161 offset:24576
    s_waitcnt lgkmcnt(9)
    v_mfma_f32_16x16x32_bf16 v[36:39], v[100:103], v[76:79], v[36:39]
    ds_read_b64_tr_b16 v[130:131], v161 offset:26624
    v_mfma_f32_16x16x32_bf16 v[40:43], v[104:107], v[76:79], v[40:43]
    ds_read_b128 v[88:91], v156 offset:19456
    v_mfma_f32_16x16x32_bf16 v[44:47], v[108:111], v[76:79], v[44:47]
    ds_read_b128 v[92:95], v156 offset:21504
    v_mfma_f32_16x16x32_bf16 v[48:51], v[112:115], v[76:79], v[48:51]
    ds_read_b128 v[96:99], v156 offset:23552
    s_waitcnt lgkmcnt(12)
    v_mfma_f32_16x16x32_bf16 v[52:55], v[100:103], v[80:83], v[52:55]
    v_mfma_f32_16x16x32_bf16 v[56:59], v[104:107], v[80:83], v[56:59]
    v_mfma_f32_16x16x32_bf16 v[60:63], v[108:111], v[80:83], v[60:63]
    v_mfma_f32_16x16x32_bf16 v[64:67], v[112:115], v[80:83], v[64:67]
    s_waitcnt lgkmcnt(9)
    v_mfma_f32_16x16x32_bf16 v[4:7], v[116:119], v[84:87], v[4:7]
    s_waitcnt lgkmcnt(7)
    v_mfma_f32_16x16x32_bf16 v[8:11], v[120:123], v[84:87], v[8:11]
    s_waitcnt lgkmcnt(5)
    v_mfma_f32_16x16x32_bf16 v[12:15], v[124:127], v[84:87], v[12:15]
    s_waitcnt lgkmcnt(3)
    v_mfma_f32_16x16x32_bf16 v[16:19], v[128:131], v[84:87], v[16:19]
    s_waitcnt lgkmcnt(0)
    s_barrier
    ds_read_b64_tr_b16 v[100:101], v158 offset:32768
    v_mfma_f32_16x16x32_bf16 v[20:23], v[116:119], v[88:91], v[20:23]
    ds_read_b64_tr_b16 v[102:103], v158 offset:34816
    v_mfma_f32_16x16x32_bf16 v[24:27], v[120:123], v[88:91], v[24:27]
    ds_read_b128 v[68:71], v156 offset:32768
    v_mfma_f32_16x16x32_bf16 v[28:31], v[124:127], v[88:91], v[28:31]
    ds_read_b64_tr_b16 v[104:105], v159 offset:32768
    v_mfma_f32_16x16x32_bf16 v[32:35], v[128:131], v[88:91], v[32:35]
    ds_read_b64_tr_b16 v[106:107], v159 offset:34816
    v_mfma_f32_16x16x32_bf16 v[36:39], v[116:119], v[92:95], v[36:39]
    ds_read_b64_tr_b16 v[108:109], v160 offset:32768
    v_mfma_f32_16x16x32_bf16 v[40:43], v[120:123], v[92:95], v[40:43]
    ds_read_b64_tr_b16 v[110:111], v160 offset:34816
    v_mfma_f32_16x16x32_bf16 v[44:47], v[124:127], v[92:95], v[44:47]
    ds_read_b64_tr_b16 v[112:113], v161 offset:32768
    v_mfma_f32_16x16x32_bf16 v[48:51], v[128:131], v[92:95], v[48:51]
    ds_read_b64_tr_b16 v[114:115], v161 offset:34816
    v_mfma_f32_16x16x32_bf16 v[52:55], v[116:119], v[96:99], v[52:55]
    ds_read_b128 v[72:75], v156 offset:34816
    v_mfma_f32_16x16x32_bf16 v[56:59], v[120:123], v[96:99], v[56:59]
    ds_read_b128 v[76:79], v156 offset:36864
    v_mfma_f32_16x16x32_bf16 v[60:63], v[124:127], v[96:99], v[60:63]
    ds_read_b128 v[80:83], v156 offset:38912
    v_mfma_f32_16x16x32_bf16 v[64:67], v[128:131], v[96:99], v[64:67]
    s_waitcnt lgkmcnt(9)
    v_mfma_f32_16x16x32_bf16 v[4:7], v[100:103], v[68:71], v[4:7]
    ds_read_b64_tr_b16 v[116:117], v158 offset:40960
    s_waitcnt lgkmcnt(8)
    v_mfma_f32_16x16x32_bf16 v[8:11], v[104:107], v[68:71], v[8:11]
    ds_read_b64_tr_b16 v[118:119], v158 offset:43008
    s_waitcnt lgkmcnt(7)
    v_mfma_f32_16x16x32_bf16 v[12:15], v[108:111], v[68:71], v[12:15]
    ds_read_b128 v[84:87], v156 offset:33792
    s_waitcnt lgkmcnt(6)
    v_mfma_f32_16x16x32_bf16 v[16:19], v[112:115], v[68:71], v[16:19]
    ds_read_b64_tr_b16 v[120:121], v159 offset:40960
    s_waitcnt lgkmcnt(6)
    v_mfma_f32_16x16x32_bf16 v[20:23], v[100:103], v[72:75], v[20:23]
    ds_read_b64_tr_b16 v[122:123], v159 offset:43008
    v_mfma_f32_16x16x32_bf16 v[24:27], v[104:107], v[72:75], v[24:27]
    ds_read_b64_tr_b16 v[124:125], v160 offset:40960
    v_mfma_f32_16x16x32_bf16 v[28:31], v[108:111], v[72:75], v[28:31]
    ds_read_b64_tr_b16 v[126:127], v160 offset:43008
    v_mfma_f32_16x16x32_bf16 v[32:35], v[112:115], v[72:75], v[32:35]
    ds_read_b64_tr_b16 v[128:129], v161 offset:40960
    s_waitcnt lgkmcnt(9)
    v_mfma_f32_16x16x32_bf16 v[36:39], v[100:103], v[76:79], v[36:39]
    ds_read_b64_tr_b16 v[130:131], v161 offset:43008
    v_mfma_f32_16x16x32_bf16 v[40:43], v[104:107], v[76:79], v[40:43]
    ds_read_b128 v[88:91], v156 offset:35840
    v_mfma_f32_16x16x32_bf16 v[44:47], v[108:111], v[76:79], v[44:47]
    ds_read_b128 v[92:95], v156 offset:37888
    v_mfma_f32_16x16x32_bf16 v[48:51], v[112:115], v[76:79], v[48:51]
    ds_read_b128 v[96:99], v156 offset:39936
    s_waitcnt lgkmcnt(12)
    v_mfma_f32_16x16x32_bf16 v[52:55], v[100:103], v[80:83], v[52:55]
    v_mfma_f32_16x16x32_bf16 v[56:59], v[104:107], v[80:83], v[56:59]
    v_mfma_f32_16x16x32_bf16 v[60:63], v[108:111], v[80:83], v[60:63]
    v_mfma_f32_16x16x32_bf16 v[64:67], v[112:115], v[80:83], v[64:67]
    s_waitcnt lgkmcnt(9)
    v_mfma_f32_16x16x32_bf16 v[4:7], v[116:119], v[84:87], v[4:7]
    s_waitcnt lgkmcnt(7)
    v_mfma_f32_16x16x32_bf16 v[8:11], v[120:123], v[84:87], v[8:11]
    s_waitcnt lgkmcnt(5)
    v_mfma_f32_16x16x32_bf16 v[12:15], v[124:127], v[84:87], v[12:15]
    s_waitcnt lgkmcnt(3)
    v_mfma_f32_16x16x32_bf16 v[16:19], v[128:131], v[84:87], v[16:19]
    s_waitcnt lgkmcnt(0)
    s_barrier
    ds_read_b64_tr_b16 v[100:101], v158 offset:49152
    v_mfma_f32_16x16x32_bf16 v[20:23], v[116:119], v[88:91], v[20:23]
    ds_read_b64_tr_b16 v[102:103], v158 offset:51200
    v_mfma_f32_16x16x32_bf16 v[24:27], v[120:123], v[88:91], v[24:27]
    ds_read_b128 v[68:71], v156 offset:49152
    v_mfma_f32_16x16x32_bf16 v[28:31], v[124:127], v[88:91], v[28:31]
    ds_read_b64_tr_b16 v[104:105], v159 offset:49152
    v_mfma_f32_16x16x32_bf16 v[32:35], v[128:131], v[88:91], v[32:35]
    ds_read_b64_tr_b16 v[106:107], v159 offset:51200
    v_mfma_f32_16x16x32_bf16 v[36:39], v[116:119], v[92:95], v[36:39]
    ds_read_b64_tr_b16 v[108:109], v160 offset:49152
    v_mfma_f32_16x16x32_bf16 v[40:43], v[120:123], v[92:95], v[40:43]
    ds_read_b64_tr_b16 v[110:111], v160 offset:51200
    v_mfma_f32_16x16x32_bf16 v[44:47], v[124:127], v[92:95], v[44:47]
    ds_read_b64_tr_b16 v[112:113], v161 offset:49152
    v_mfma_f32_16x16x32_bf16 v[48:51], v[128:131], v[92:95], v[48:51]
    ds_read_b64_tr_b16 v[114:115], v161 offset:51200
    v_mfma_f32_16x16x32_bf16 v[52:55], v[116:119], v[96:99], v[52:55]
    ds_read_b128 v[72:75], v156 offset:51200
    v_mfma_f32_16x16x32_bf16 v[56:59], v[120:123], v[96:99], v[56:59]
    ds_read_b128 v[76:79], v156 offset:53248
    v_mfma_f32_16x16x32_bf16 v[60:63], v[124:127], v[96:99], v[60:63]
    ds_read_b128 v[80:83], v156 offset:55296
    v_mfma_f32_16x16x32_bf16 v[64:67], v[128:131], v[96:99], v[64:67]
    s_waitcnt lgkmcnt(9)
    v_mfma_f32_16x16x32_bf16 v[4:7], v[100:103], v[68:71], v[4:7]
    ds_read_b64_tr_b16 v[116:117], v158 offset:57344
    s_waitcnt lgkmcnt(8)
    v_mfma_f32_16x16x32_bf16 v[8:11], v[104:107], v[68:71], v[8:11]
    ds_read_b64_tr_b16 v[118:119], v158 offset:59392
    s_waitcnt lgkmcnt(7)
    v_mfma_f32_16x16x32_bf16 v[12:15], v[108:111], v[68:71], v[12:15]
    ds_read_b128 v[84:87], v156 offset:50176
    s_waitcnt lgkmcnt(6)
    v_mfma_f32_16x16x32_bf16 v[16:19], v[112:115], v[68:71], v[16:19]
    ds_read_b64_tr_b16 v[120:121], v159 offset:57344
    s_waitcnt lgkmcnt(6)
    v_mfma_f32_16x16x32_bf16 v[20:23], v[100:103], v[72:75], v[20:23]
    ds_read_b64_tr_b16 v[122:123], v159 offset:59392
    v_mfma_f32_16x16x32_bf16 v[24:27], v[104:107], v[72:75], v[24:27]
    ds_read_b64_tr_b16 v[124:125], v160 offset:57344
    v_mfma_f32_16x16x32_bf16 v[28:31], v[108:111], v[72:75], v[28:31]
    ds_read_b64_tr_b16 v[126:127], v160 offset:59392
    v_mfma_f32_16x16x32_bf16 v[32:35], v[112:115], v[72:75], v[32:35]
    ds_read_b64_tr_b16 v[128:129], v161 offset:57344
    s_waitcnt lgkmcnt(9)
    v_mfma_f32_16x16x32_bf16 v[36:39], v[100:103], v[76:79], v[36:39]
    ds_read_b64_tr_b16 v[130:131], v161 offset:59392
    v_mfma_f32_16x16x32_bf16 v[40:43], v[104:107], v[76:79], v[40:43]
    ds_read_b128 v[88:91], v156 offset:52224
    v_mfma_f32_16x16x32_bf16 v[44:47], v[108:111], v[76:79], v[44:47]
    ds_read_b128 v[92:95], v156 offset:54272
    v_mfma_f32_16x16x32_bf16 v[48:51], v[112:115], v[76:79], v[48:51]
    ds_read_b128 v[96:99], v156 offset:56320
    s_waitcnt lgkmcnt(12)
    v_mfma_f32_16x16x32_bf16 v[52:55], v[100:103], v[80:83], v[52:55]
    v_mfma_f32_16x16x32_bf16 v[56:59], v[104:107], v[80:83], v[56:59]
    v_mfma_f32_16x16x32_bf16 v[60:63], v[108:111], v[80:83], v[60:63]
    v_mfma_f32_16x16x32_bf16 v[64:67], v[112:115], v[80:83], v[64:67]
    s_waitcnt lgkmcnt(9)
    v_mfma_f32_16x16x32_bf16 v[4:7], v[116:119], v[84:87], v[4:7]
    s_waitcnt lgkmcnt(7)
    v_mfma_f32_16x16x32_bf16 v[8:11], v[120:123], v[84:87], v[8:11]
    s_waitcnt lgkmcnt(5)
    v_mfma_f32_16x16x32_bf16 v[12:15], v[124:127], v[84:87], v[12:15]
    s_waitcnt lgkmcnt(3)
    v_mfma_f32_16x16x32_bf16 v[16:19], v[128:131], v[84:87], v[16:19]
    s_waitcnt lgkmcnt(0)
    s_barrier
    ds_read_b64_tr_b16 v[100:101], v158 offset:0
    v_mfma_f32_16x16x32_bf16 v[20:23], v[116:119], v[88:91], v[20:23]
    ds_read_b64_tr_b16 v[102:103], v158 offset:2048
    v_mfma_f32_16x16x32_bf16 v[24:27], v[120:123], v[88:91], v[24:27]
    ds_read_b128 v[68:71], v156 offset:0
    v_mfma_f32_16x16x32_bf16 v[28:31], v[124:127], v[88:91], v[28:31]
    ds_read_b64_tr_b16 v[104:105], v159 offset:0
    v_mfma_f32_16x16x32_bf16 v[32:35], v[128:131], v[88:91], v[32:35]
    ds_read_b64_tr_b16 v[106:107], v159 offset:2048
    v_mfma_f32_16x16x32_bf16 v[36:39], v[116:119], v[92:95], v[36:39]
    ds_read_b64_tr_b16 v[108:109], v160 offset:0
    v_mfma_f32_16x16x32_bf16 v[40:43], v[120:123], v[92:95], v[40:43]
    ds_read_b64_tr_b16 v[110:111], v160 offset:2048
    v_mfma_f32_16x16x32_bf16 v[44:47], v[124:127], v[92:95], v[44:47]
    ds_read_b64_tr_b16 v[112:113], v161 offset:0
    v_mfma_f32_16x16x32_bf16 v[48:51], v[128:131], v[92:95], v[48:51]
    ds_read_b64_tr_b16 v[114:115], v161 offset:2048
    v_mfma_f32_16x16x32_bf16 v[52:55], v[116:119], v[96:99], v[52:55]
    ds_read_b128 v[72:75], v156 offset:2048
    v_mfma_f32_16x16x32_bf16 v[56:59], v[120:123], v[96:99], v[56:59]
    ds_read_b128 v[76:79], v156 offset:4096
    v_mfma_f32_16x16x32_bf16 v[60:63], v[124:127], v[96:99], v[60:63]
    ds_read_b128 v[80:83], v156 offset:6144
    v_mfma_f32_16x16x32_bf16 v[64:67], v[128:131], v[96:99], v[64:67]
    s_waitcnt lgkmcnt(9)
    v_mfma_f32_16x16x32_bf16 v[4:7], v[100:103], v[68:71], v[4:7]
    ds_read_b64_tr_b16 v[116:117], v158 offset:8192
    s_waitcnt lgkmcnt(8)
    v_mfma_f32_16x16x32_bf16 v[8:11], v[104:107], v[68:71], v[8:11]
    ds_read_b64_tr_b16 v[118:119], v158 offset:10240
    s_waitcnt lgkmcnt(7)
    v_mfma_f32_16x16x32_bf16 v[12:15], v[108:111], v[68:71], v[12:15]
    ds_read_b128 v[84:87], v156 offset:1024
    s_waitcnt lgkmcnt(6)
    v_mfma_f32_16x16x32_bf16 v[16:19], v[112:115], v[68:71], v[16:19]
    ds_read_b64_tr_b16 v[120:121], v159 offset:8192
    s_waitcnt lgkmcnt(6)
    v_mfma_f32_16x16x32_bf16 v[20:23], v[100:103], v[72:75], v[20:23]
    ds_read_b64_tr_b16 v[122:123], v159 offset:10240
    v_mfma_f32_16x16x32_bf16 v[24:27], v[104:107], v[72:75], v[24:27]
    ds_read_b64_tr_b16 v[124:125], v160 offset:8192
    v_mfma_f32_16x16x32_bf16 v[28:31], v[108:111], v[72:75], v[28:31]
    ds_read_b64_tr_b16 v[126:127], v160 offset:10240
    v_mfma_f32_16x16x32_bf16 v[32:35], v[112:115], v[72:75], v[32:35]
    ds_read_b64_tr_b16 v[128:129], v161 offset:8192
    s_waitcnt lgkmcnt(9)
    v_mfma_f32_16x16x32_bf16 v[36:39], v[100:103], v[76:79], v[36:39]
    ds_read_b64_tr_b16 v[130:131], v161 offset:10240
    v_mfma_f32_16x16x32_bf16 v[40:43], v[104:107], v[76:79], v[40:43]
    ds_read_b128 v[88:91], v156 offset:3072
    v_mfma_f32_16x16x32_bf16 v[44:47], v[108:111], v[76:79], v[44:47]
    ds_read_b128 v[92:95], v156 offset:5120
    v_mfma_f32_16x16x32_bf16 v[48:51], v[112:115], v[76:79], v[48:51]
    ds_read_b128 v[96:99], v156 offset:7168
    s_waitcnt lgkmcnt(12)
    v_mfma_f32_16x16x32_bf16 v[52:55], v[100:103], v[80:83], v[52:55]
    v_mfma_f32_16x16x32_bf16 v[56:59], v[104:107], v[80:83], v[56:59]
    v_mfma_f32_16x16x32_bf16 v[60:63], v[108:111], v[80:83], v[60:63]
    v_mfma_f32_16x16x32_bf16 v[64:67], v[112:115], v[80:83], v[64:67]
    s_add_u32 s58, s58, 1
    s_cmp_lt_u32 s58, 3
    s_cbranch_scc1 L_loop_G2
    s_waitcnt lgkmcnt(9)
    v_mfma_f32_16x16x32_bf16 v[4:7], v[116:119], v[84:87], v[4:7]
    s_waitcnt lgkmcnt(7)
    v_mfma_f32_16x16x32_bf16 v[8:11], v[120:123], v[84:87], v[8:11]
    s_waitcnt lgkmcnt(5)
    v_mfma_f32_16x16x32_bf16 v[12:15], v[124:127], v[84:87], v[12:15]
    s_waitcnt lgkmcnt(3)
    v_mfma_f32_16x16x32_bf16 v[16:19], v[128:131], v[84:87], v[16:19]
    s_waitcnt lgkmcnt(0)
    s_waitcnt vmcnt(0)
    s_barrier
    ds_read_b64_tr_b16 v[100:101], v158 offset:16384
    v_mfma_f32_16x16x32_bf16 v[20:23], v[116:119], v[88:91], v[20:23]
    ds_read_b64_tr_b16 v[102:103], v158 offset:18432
    v_mfma_f32_16x16x32_bf16 v[24:27], v[120:123], v[88:91], v[24:27]
    ds_read_b128 v[68:71], v156 offset:16384
    v_mfma_f32_16x16x32_bf16 v[28:31], v[124:127], v[88:91], v[28:31]
    ds_read_b64_tr_b16 v[104:105], v159 offset:16384
    v_mfma_f32_16x16x32_bf16 v[32:35], v[128:131], v[88:91], v[32:35]
    ds_read_b64_tr_b16 v[106:107], v159 offset:18432
    v_mfma_f32_16x16x32_bf16 v[36:39], v[116:119], v[92:95], v[36:39]
    ds_read_b64_tr_b16 v[108:109], v160 offset:16384
    v_mfma_f32_16x16x32_bf16 v[40:43], v[120:123], v[92:95], v[40:43]
    ds_read_b64_tr_b16 v[110:111], v160 offset:18432
    v_mfma_f32_16x16x32_bf16 v[44:47], v[124:127], v[92:95], v[44:47]
    ds_read_b64_tr_b16 v[112:113], v161 offset:16384
    v_mfma_f32_16x16x32_bf16 v[48:51], v[128:131], v[92:95], v[48:51]
    ds_read_b64_tr_b16 v[114:115], v161 offset:18432
    v_mfma_f32_16x16x32_bf16 v[52:55], v[116:119], v[96:99], v[52:55]
    ds_read_b128 v[72:75], v156 offset:18432
    v_mfma_f32_16x16x32_bf16 v[56:59], v[120:123], v[96:99], v[56:59]
    ds_read_b128 v[76:79], v156 offset:20480
    v_mfma_f32_16x16x32_bf16 v[60:63], v[124:127], v[96:99], v[60:63]
    ds_read_b128 v[80:83], v156 offset:22528
    v_mfma_f32_16x16x32_bf16 v[64:67], v[128:131], v[96:99], v[64:67]
    s_waitcnt lgkmcnt(9)
    v_mfma_f32_16x16x32_bf16 v[4:7], v[100:103], v[68:71], v[4:7]
    ds_read_b64_tr_b16 v[116:117], v158 offset:24576
    s_waitcnt lgkmcnt(8)
    v_mfma_f32_16x16x32_bf16 v[8:11], v[104:107], v[68:71], v[8:11]
    ds_read_b64_tr_b16 v[118:119], v158 offset:26624
    s_waitcnt lgkmcnt(7)
    v_mfma_f32_16x16x32_bf16 v[12:15], v[108:111], v[68:71], v[12:15]
    ds_read_b128 v[84:87], v156 offset:17408
    s_waitcnt lgkmcnt(6)
    v_mfma_f32_16x16x32_bf16 v[16:19], v[112:115], v[68:71], v[16:19]
    ds_read_b64_tr_b16 v[120:121], v159 offset:24576
    s_waitcnt lgkmcnt(6)
    v_mfma_f32_16x16x32_bf16 v[20:23], v[100:103], v[72:75], v[20:23]
    ds_read_b64_tr_b16 v[122:123], v159 offset:26624
    v_mfma_f32_16x16x32_bf16 v[24:27], v[104:107], v[72:75], v[24:27]
    ds_read_b64_tr_b16 v[124:125], v160 offset:24576
    v_mfma_f32_16x16x32_bf16 v[28:31], v[108:111], v[72:75], v[28:31]
    ds_read_b64_tr_b16 v[126:127], v160 offset:26624
    v_mfma_f32_16x16x32_bf16 v[32:35], v[112:115], v[72:75], v[32:35]
    ds_read_b64_tr_b16 v[128:129], v161 offset:24576
    s_waitcnt lgkmcnt(9)
    v_mfma_f32_16x16x32_bf16 v[36:39], v[100:103], v[76:79], v[36:39]
    ds_read_b64_tr_b16 v[130:131], v161 offset:26624
    v_mfma_f32_16x16x32_bf16 v[40:43], v[104:107], v[76:79], v[40:43]
    ds_read_b128 v[88:91], v156 offset:19456
    v_mfma_f32_16x16x32_bf16 v[44:47], v[108:111], v[76:79], v[44:47]
    ds_read_b128 v[92:95], v156 offset:21504
    v_mfma_f32_16x16x32_bf16 v[48:51], v[112:115], v[76:79], v[48:51]
    ds_read_b128 v[96:99], v156 offset:23552
    s_waitcnt lgkmcnt(12)
    v_mfma_f32_16x16x32_bf16 v[52:55], v[100:103], v[80:83], v[52:55]
    v_mfma_f32_16x16x32_bf16 v[56:59], v[104:107], v[80:83], v[56:59]
    v_mfma_f32_16x16x32_bf16 v[60:63], v[108:111], v[80:83], v[60:63]
    v_mfma_f32_16x16x32_bf16 v[64:67], v[112:115], v[80:83], v[64:67]
    s_waitcnt lgkmcnt(9)
    v_mfma_f32_16x16x32_bf16 v[4:7], v[116:119], v[84:87], v[4:7]
    s_waitcnt lgkmcnt(7)
    v_mfma_f32_16x16x32_bf16 v[8:11], v[120:123], v[84:87], v[8:11]
    s_waitcnt lgkmcnt(5)
    v_mfma_f32_16x16x32_bf16 v[12:15], v[124:127], v[84:87], v[12:15]
    s_waitcnt lgkmcnt(3)
    v_mfma_f32_16x16x32_bf16 v[16:19], v[128:131], v[84:87], v[16:19]
    s_waitcnt lgkmcnt(0)
    s_barrier
    ds_read_b64_tr_b16 v[100:101], v158 offset:32768
    v_mfma_f32_16x16x32_bf16 v[20:23], v[116:119], v[88:91], v[20:23]
    ds_read_b64_tr_b16 v[102:103], v158 offset:34816
    v_mfma_f32_16x16x32_bf16 v[24:27], v[120:123], v[88:91], v[24:27]
    ds_read_b128 v[68:71], v156 offset:32768
    v_mfma_f32_16x16x32_bf16 v[28:31], v[124:127], v[88:91], v[28:31]
    ds_read_b64_tr_b16 v[104:105], v159 offset:32768
    v_mfma_f32_16x16x32_bf16 v[32:35], v[128:131], v[88:91], v[32:35]
    ds_read_b64_tr_b16 v[106:107], v159 offset:34816
    v_mfma_f32_16x16x32_bf16 v[36:39], v[116:119], v[92:95], v[36:39]
    ds_read_b64_tr_b16 v[108:109], v160 offset:32768
    v_mfma_f32_16x16x32_bf16 v[40:43], v[120:123], v[92:95], v[40:43]
    ds_read_b64_tr_b16 v[110:111], v160 offset:34816
    v_mfma_f32_16x16x32_bf16 v[44:47], v[124:127], v[92:95], v[44:47]
    ds_read_b64_tr_b16 v[112:113], v161 offset:32768
    v_mfma_f32_16x16x32_bf16 v[48:51], v[128:131], v[92:95], v[48:51]
    ds_read_b64_tr_b16 v[114:115], v161 offset:34816
    v_mfma_f32_16x16x32_bf16 v[52:55], v[116:119], v[96:99], v[52:55]
    ds_read_b128 v[72:75], v156 offset:34816
    v_mfma_f32_16x16x32_bf16 v[56:59], v[120:123], v[96:99], v[56:59]
    ds_read_b128 v[76:79], v156 offset:36864
    v_mfma_f32_16x16x32_bf16 v[60:63], v[124:127], v[96:99], v[60:63]
    ds_read_b128 v[80:83], v156 offset:38912
    v_mfma_f32_16x16x32_bf16 v[64:67], v[128:131], v[96:99], v[64:67]
    s_waitcnt lgkmcnt(9)
    v_mfma_f32_16x16x32_bf16 v[4:7], v[100:103], v[68:71], v[4:7]
    ds_read_b64_tr_b16 v[116:117], v158 offset:40960
    s_waitcnt lgkmcnt(8)
    v_mfma_f32_16x16x32_bf16 v[8:11], v[104:107], v[68:71], v[8:11]
    ds_read_b64_tr_b16 v[118:119], v158 offset:43008
    s_waitcnt lgkmcnt(7)
    v_mfma_f32_16x16x32_bf16 v[12:15], v[108:111], v[68:71], v[12:15]
    ds_read_b128 v[84:87], v156 offset:33792
    s_waitcnt lgkmcnt(6)
    v_mfma_f32_16x16x32_bf16 v[16:19], v[112:115], v[68:71], v[16:19]
    ds_read_b64_tr_b16 v[120:121], v159 offset:40960
    s_waitcnt lgkmcnt(6)
    v_mfma_f32_16x16x32_bf16 v[20:23], v[100:103], v[72:75], v[20:23]
    ds_read_b64_tr_b16 v[122:123], v159 offset:43008
    v_mfma_f32_16x16x32_bf16 v[24:27], v[104:107], v[72:75], v[24:27]
    ds_read_b64_tr_b16 v[124:125], v160 offset:40960
    v_mfma_f32_16x16x32_bf16 v[28:31], v[108:111], v[72:75], v[28:31]
    ds_read_b64_tr_b16 v[126:127], v160 offset:43008
    v_mfma_f32_16x16x32_bf16 v[32:35], v[112:115], v[72:75], v[32:35]
    ds_read_b64_tr_b16 v[128:129], v161 offset:40960
    s_waitcnt lgkmcnt(9)
    v_mfma_f32_16x16x32_bf16 v[36:39], v[100:103], v[76:79], v[36:39]
    ds_read_b64_tr_b16 v[130:131], v161 offset:43008
    v_mfma_f32_16x16x32_bf16 v[40:43], v[104:107], v[76:79], v[40:43]
    ds_read_b128 v[88:91], v156 offset:35840
    v_mfma_f32_16x16x32_bf16 v[44:47], v[108:111], v[76:79], v[44:47]
    ds_read_b128 v[92:95], v156 offset:37888
    v_mfma_f32_16x16x32_bf16 v[48:51], v[112:115], v[76:79], v[48:51]
    ds_read_b128 v[96:99], v156 offset:39936
    s_waitcnt lgkmcnt(12)
    v_mfma_f32_16x16x32_bf16 v[52:55], v[100:103], v[80:83], v[52:55]
    v_mfma_f32_16x16x32_bf16 v[56:59], v[104:107], v[80:83], v[56:59]
    v_mfma_f32_16x16x32_bf16 v[60:63], v[108:111], v[80:83], v[60:63]
    v_mfma_f32_16x16x32_bf16 v[64:67], v[112:115], v[80:83], v[64:67]
    s_waitcnt lgkmcnt(9)
    v_mfma_f32_16x16x32_bf16 v[4:7], v[116:119], v[84:87], v[4:7]
    s_waitcnt lgkmcnt(7)
    v_mfma_f32_16x16x32_bf16 v[8:11], v[120:123], v[84:87], v[8:11]
    s_waitcnt lgkmcnt(5)
    v_mfma_f32_16x16x32_bf16 v[12:15], v[124:127], v[84:87], v[12:15]
    s_waitcnt lgkmcnt(3)
    v_mfma_f32_16x16x32_bf16 v[16:19], v[128:131], v[84:87], v[16:19]
    s_waitcnt lgkmcnt(0)
    s_barrier
    ds_read_b64_tr_b16 v[100:101], v158 offset:49152
    v_mfma_f32_16x16x32_bf16 v[20:23], v[116:119], v[88:91], v[20:23]
    ds_read_b64_tr_b16 v[102:103], v158 offset:51200
    v_mfma_f32_16x16x32_bf16 v[24:27], v[120:123], v[88:91], v[24:27]
    ds_read_b128 v[68:71], v156 offset:49152
    v_mfma_f32_16x16x32_bf16 v[28:31], v[124:127], v[88:91], v[28:31]
    ds_read_b64_tr_b16 v[104:105], v159 offset:49152
    v_mfma_f32_16x16x32_bf16 v[32:35], v[128:131], v[88:91], v[32:35]
    ds_read_b64_tr_b16 v[106:107], v159 offset:51200
    v_mfma_f32_16x16x32_bf16 v[36:39], v[116:119], v[92:95], v[36:39]
    ds_read_b64_tr_b16 v[108:109], v160 offset:49152
    v_mfma_f32_16x16x32_bf16 v[40:43], v[120:123], v[92:95], v[40:43]
    ds_read_b64_tr_b16 v[110:111], v160 offset:51200
    v_mfma_f32_16x16x32_bf16 v[44:47], v[124:127], v[92:95], v[44:47]
    ds_read_b64_tr_b16 v[112:113], v161 offset:49152
    v_mfma_f32_16x16x32_bf16 v[48:51], v[128:131], v[92:95], v[48:51]
    ds_read_b64_tr_b16 v[114:115], v161 offset:51200
    v_mfma_f32_16x16x32_bf16 v[52:55], v[116:119], v[96:99], v[52:55]
    ds_read_b128 v[72:75], v156 offset:51200
    v_mfma_f32_16x16x32_bf16 v[56:59], v[120:123], v[96:99], v[56:59]
    ds_read_b128 v[76:79], v156 offset:53248
    v_mfma_f32_16x16x32_bf16 v[60:63], v[124:127], v[96:99], v[60:63]
    ds_read_b128 v[80:83], v156 offset:55296
    v_mfma_f32_16x16x32_bf16 v[64:67], v[128:131], v[96:99], v[64:67]
    s_waitcnt lgkmcnt(9)
    v_mfma_f32_16x16x32_bf16 v[4:7], v[100:103], v[68:71], v[4:7]
    ds_read_b64_tr_b16 v[116:117], v158 offset:57344
    s_waitcnt lgkmcnt(8)
    v_mfma_f32_16x16x32_bf16 v[8:11], v[104:107], v[68:71], v[8:11]
    ds_read_b64_tr_b16 v[118:119], v158 offset:59392
    s_waitcnt lgkmcnt(7)
    v_mfma_f32_16x16x32_bf16 v[12:15], v[108:111], v[68:71], v[12:15]
    ds_read_b128 v[84:87], v156 offset:50176
    s_waitcnt lgkmcnt(6)
    v_mfma_f32_16x16x32_bf16 v[16:19], v[112:115], v[68:71], v[16:19]
    ds_read_b64_tr_b16 v[120:121], v159 offset:57344
    s_waitcnt lgkmcnt(6)
    v_mfma_f32_16x16x32_bf16 v[20:23], v[100:103], v[72:75], v[20:23]
    ds_read_b64_tr_b16 v[122:123], v159 offset:59392
    v_mfma_f32_16x16x32_bf16 v[24:27], v[104:107], v[72:75], v[24:27]
    ds_read_b64_tr_b16 v[124:125], v160 offset:57344
    v_mfma_f32_16x16x32_bf16 v[28:31], v[108:111], v[72:75], v[28:31]
    ds_read_b64_tr_b16 v[126:127], v160 offset:59392
    v_mfma_f32_16x16x32_bf16 v[32:35], v[112:115], v[72:75], v[32:35]
    ds_read_b64_tr_b16 v[128:129], v161 offset:57344
    s_waitcnt lgkmcnt(9)
    v_mfma_f32_16x16x32_bf16 v[36:39], v[100:103], v[76:79], v[36:39]
    ds_read_b64_tr_b16 v[130:131], v161 offset:59392
    v_mfma_f32_16x16x32_bf16 v[40:43], v[104:107], v[76:79], v[40:43]
    ds_read_b128 v[88:91], v156 offset:52224
    v_mfma_f32_16x16x32_bf16 v[44:47], v[108:111], v[76:79], v[44:47]
    ds_read_b128 v[92:95], v156 offset:54272
    v_mfma_f32_16x16x32_bf16 v[48:51], v[112:115], v[76:79], v[48:51]
    ds_read_b128 v[96:99], v156 offset:56320
    s_waitcnt lgkmcnt(12)
    v_mfma_f32_16x16x32_bf16 v[52:55], v[100:103], v[80:83], v[52:55]
    v_mfma_f32_16x16x32_bf16 v[56:59], v[104:107], v[80:83], v[56:59]
    v_mfma_f32_16x16x32_bf16 v[60:63], v[108:111], v[80:83], v[60:63]
    v_mfma_f32_16x16x32_bf16 v[64:67], v[112:115], v[80:83], v[64:67]
    s_waitcnt lgkmcnt(9)
    v_mfma_f32_16x16x32_bf16 v[4:7], v[116:119], v[84:87], v[4:7]
    s_waitcnt lgkmcnt(7)
    v_mfma_f32_16x16x32_bf16 v[8:11], v[120:123], v[84:87], v[8:11]
    s_waitcnt lgkmcnt(5)
    v_mfma_f32_16x16x32_bf16 v[12:15], v[124:127], v[84:87], v[12:15]
    s_waitcnt lgkmcnt(3)
    v_mfma_f32_16x16x32_bf16 v[16:19], v[128:131], v[84:87], v[16:19]
    s_waitcnt lgkmcnt(2)
    v_mfma_f32_16x16x32_bf16 v[20:23], v[116:119], v[88:91], v[20:23]
    v_mfma_f32_16x16x32_bf16 v[24:27], v[120:123], v[88:91], v[24:27]
    v_mfma_f32_16x16x32_bf16 v[28:31], v[124:127], v[88:91], v[28:31]
    v_mfma_f32_16x16x32_bf16 v[32:35], v[128:131], v[88:91], v[32:35]
    s_waitcnt lgkmcnt(1)
    v_mfma_f32_16x16x32_bf16 v[36:39], v[116:119], v[92:95], v[36:39]
    v_cvt_pk_bf16_f32 v148, v4, v5
    v_cvt_pk_bf16_f32 v149, v6, v7
    v_cvt_pk_bf16_f32 v150, v8, v9
    v_cvt_pk_bf16_f32 v151, v10, v11
    v_mfma_f32_16x16x32_bf16 v[40:43], v[120:123], v[92:95], v[40:43]
    s_nop 1
    v_permlane16_swap_b32 v148, v150
    v_permlane16_swap_b32 v149, v151
    buffer_store_dwordx4 v[148:151], v163, s[20:23], 0 offen offset:0 sc1
    v_mfma_f32_16x16x32_bf16 v[44:47], v[124:127], v[92:95], v[44:47]
    v_cvt_pk_bf16_f32 v152, v12, v13
    v_cvt_pk_bf16_f32 v153, v14, v15
    v_cvt_pk_bf16_f32 v154, v16, v17
    v_cvt_pk_bf16_f32 v155, v18, v19
    v_mfma_f32_16x16x32_bf16 v[48:51], v[128:131], v[92:95], v[48:51]
    s_nop 1
    v_permlane16_swap_b32 v152, v154
    v_permlane16_swap_b32 v153, v155
    buffer_store_dwordx4 v[152:155], v163, s[20:23], 0 offen offset:64 sc1
    s_waitcnt lgkmcnt(0)
    v_mfma_f32_16x16x32_bf16 v[52:55], v[116:119], v[96:99], v[52:55]
    v_cvt_pk_bf16_f32 v148, v20, v21
    v_cvt_pk_bf16_f32 v149, v22, v23
    v_cvt_pk_bf16_f32 v150, v24, v25
    v_cvt_pk_bf16_f32 v151, v26, v27
    v_mfma_f32_16x16x32_bf16 v[56:59], v[120:123], v[96:99], v[56:59]
    s_nop 1
    v_permlane16_swap_b32 v148, v150
    v_permlane16_swap_b32 v149, v151
    buffer_store_dwordx4 v[148:151], v164, s[20:23], 0 offen offset:0 sc1
    v_mfma_f32_16x16x32_bf16 v[60:63], v[124:127], v[96:99], v[60:63]
    v_cvt_pk_bf16_f32 v152, v28, v29
    v_cvt_pk_bf16_f32 v153, v30, v31
    v_cvt_pk_bf16_f32 v154, v32, v33
    v_cvt_pk_bf16_f32 v155, v34, v35
    v_mfma_f32_16x16x32_bf16 v[64:67], v[128:131], v[96:99], v[64:67]
    s_nop 1
    v_permlane16_swap_b32 v152, v154
    v_permlane16_swap_b32 v153, v155
    buffer_store_dwordx4 v[152:155], v164, s[20:23], 0 offen offset:64 sc1
    v_cvt_pk_bf16_f32 v148, v36, v37
    v_cvt_pk_bf16_f32 v149, v38, v39
    v_cvt_pk_bf16_f32 v150, v40, v41
    v_cvt_pk_bf16_f32 v151, v42, v43
    s_nop 1
    v_permlane16_swap_b32 v148, v150
    v_permlane16_swap_b32 v149, v151
    buffer_store_dwordx4 v[148:151], v165, s[20:23], 0 offen offset:0 sc1
    v_cvt_pk_bf16_f32 v152, v44, v45
    v_cvt_pk_bf16_f32 v153, v46, v47
    v_cvt_pk_bf16_f32 v154, v48, v49
    v_cvt_pk_bf16_f32 v155, v50, v51
    s_nop 1
    v_permlane16_swap_b32 v152, v154
    v_permlane16_swap_b32 v153, v155
    buffer_store_dwordx4 v[152:155], v165, s[20:23], 0 offen offset:64 sc1
    s_nop 3
    v_cvt_pk_bf16_f32 v148, v52, v53
    v_cvt_pk_bf16_f32 v149, v54, v55
    v_cvt_pk_bf16_f32 v150, v56, v57
    v_cvt_pk_bf16_f32 v151, v58, v59
    s_nop 1
    v_permlane16_swap_b32 v148, v150
    v_permlane16_swap_b32 v149, v151
    buffer_store_dwordx4 v[148:151], v166, s[20:23], 0 offen offset:0 sc1
    v_cvt_pk_bf16_f32 v152, v60, v61
    v_cvt_pk_bf16_f32 v153, v62, v63
    v_cvt_pk_bf16_f32 v154, v64, v65
    v_cvt_pk_bf16_f32 v155, v66, v67
    s_nop 1
    v_permlane16_swap_b32 v152, v154
    v_permlane16_swap_b32 v153, v155
    buffer_store_dwordx4 v[152:155], v166, s[20:23], 0 offen offset:64 sc1
    s_endpgm
L_att_slow:
    s_lshl_b32 s29, s33, 4
    s_add_u32 s29, s29, s85
    s_lshl_b32 s26, s29, 18
    s_add_u32 s26, s26, 8388608
    s_cmp_eq_u32 s84, 0
    s_cselect_b32 s26, 16777216, s26
    s_add_u32 s8, s4, s26
    s_addc_u32 s9, s5, 0
    s_and_b32 s9, s9, 0xffff
    s_mov_b32 s10, 262144
    s_mov_b32 s11, 0x20000
    v_mov_b32 v36, 0
    v_mov_b32 v37, 0
    v_mov_b32 v38, 0
    v_mov_b32 v39, 0
    v_mov_b32 v40, 0
    v_mov_b32 v41, 0
    v_mov_b32 v42, 0
    v_mov_b32 v43, 0
    v_mov_b32 v44, 0
    v_mov_b32 v45, 0
    v_mov_b32 v46, 0
    v_mov_b32 v47, 0
    v_mov_b32 v48, 0
    v_mov_b32 v49, 0
    v_mov_b32 v50, 0
    v_mov_b32 v51, 0
    v_mov_b32 v163, 0xff800000
    v_mov_b32 v166, 0
    s_mov_b32 s30, 0
L_att_slow0:
    buffer_load_dwordx4 v[68:71], v167, s[8:11], s30 offen
    buffer_load_dwordx4 v[72:75], v167, s[8:11], s30 offen offset:1024
    buffer_load_dwordx4 v[84:87], v167, s[8:11], s30 offen offset:2048
    buffer_load_dwordx4 v[88:91], v167, s[8:11], s30 offen offset:3072
    s_waitcnt vmcnt(2)
    v_mfma_f32_32x32x16_bf16 v[4:19], v[68:71], v[132:135], 0
    v_mfma_f32_32x32x16_bf16 v[4:19], v[72:75], v[136:139], v[4:19]
    s_nop 7
    s_nop 3
    v_max3_f32 v164, v4, v5, v163
    v_max3_f32 v164, v6, v7, v164
    v_max3_f32 v164, v8, v9, v164
    v_max3_f32 v164, v10, v11, v164
    v_max3_f32 v164, v12, v13, v164
    v_max3_f32 v164, v14, v15, v164
    v_max3_f32 v164, v16, v17, v164
    v_max3_f32 v164, v18, v19, v164
    v_mov_b32 v165, v164
    s_nop 1
    v_permlane32_swap_b32 v165, v164
    s_nop 1
    v_max_f32 v164, v165, v164
    v_sub_f32 v165, v163, v164
    v_exp_f32 v165, v165
    v_mov_b32 v163, v164
    v_sub_f32 v4, v4, v164
    v_sub_f32 v5, v5, v164
    v_sub_f32 v6, v6, v164
    v_sub_f32 v7, v7, v164
    v_sub_f32 v8, v8, v164
    v_sub_f32 v9, v9, v164
    v_sub_f32 v10, v10, v164
    v_sub_f32 v11, v11, v164
    v_sub_f32 v12, v12, v164
    v_sub_f32 v13, v13, v164
    v_sub_f32 v14, v14, v164
    v_sub_f32 v15, v15, v164
    v_sub_f32 v16, v16, v164
    v_sub_f32 v17, v17, v164
    v_sub_f32 v18, v18, v164
    v_sub_f32 v19, v19, v164
    v_exp_f32 v4, v4
    v_exp_f32 v5, v5
    v_exp_f32 v6, v6
    v_exp_f32 v7, v7
    v_exp_f32 v8, v8
    v_exp_f32 v9, v9
    v_exp_f32 v10, v10
    v_exp_f32 v11, v11
    v_exp_f32 v12, v12
    v_exp_f32 v13, v13
    v_exp_f32 v14, v14
    v_exp_f32 v15, v15
    v_exp_f32 v16, v16
    v_exp_f32 v17, v17
    v_exp_f32 v18, v18
    v_exp_f32 v19, v19
    v_mul_f32 v166, v166, v165
    v_mul_f32 v36, v36, v165
    v_mul_f32 v37, v37, v165
    v_mul_f32 v38, v38, v165
    v_mul_f32 v39, v39, v165
    v_mul_f32 v40, v40, v165
    v_mul_f32 v41, v41, v165
    v_mul_f32 v42, v42, v165
    v_mul_f32 v43, v43, v165
    v_mul_f32 v44, v44, v165
    v_mul_f32 v45, v45, v165
    v_mul_f32 v46, v46, v165
    v_mul_f32 v47, v47, v165
    v_mul_f32 v48, v48, v165
    v_mul_f32 v49, v49, v165
    v_mul_f32 v50, v50, v165
    v_mul_f32 v51, v51, v165
    v_cvt_pk_bf16_f32 v100, v4, v5
    v_cvt_pk_bf16_f32 v101, v6, v7
    v_cvt_pk_bf16_f32 v102, v8, v9
    v_cvt_pk_bf16_f32 v103, v10, v11
    v_cvt_pk_bf16_f32 v104, v12, v13
    v_cvt_pk_bf16_f32 v105, v14, v15
    v_cvt_pk_bf16_f32 v106, v16, v17
    v_cvt_pk_bf16_f32 v107, v18, v19
    v_lshlrev_b32 v4, 16, v100
    v_and_b32 v5, 0xffff0000, v100
    v_lshlrev_b32 v6, 16, v101
    v_and_b32 v7, 0xffff0000, v101
    v_lshlrev_b32 v8, 16, v102
    v_and_b32 v9, 0xffff0000, v102
    v_lshlrev_b32 v10, 16, v103
    v_and_b32 v11, 0xffff0000, v103
    v_lshlrev_b32 v12, 16, v104
    v_and_b32 v13, 0xffff0000, v104
    v_lshlrev_b32 v14, 16, v105
    v_and_b32 v15, 0xffff0000, v105
    v_lshlrev_b32 v16, 16, v106
    v_and_b32 v17, 0xffff0000, v106
    v_lshlrev_b32 v18, 16, v107
    v_and_b32 v19, 0xffff0000, v107
    v_add_f32 v166, v166, v4
    v_add_f32 v166, v166, v5
    v_add_f32 v166, v166, v6
    v_add_f32 v166, v166, v7
    v_add_f32 v166, v166, v8
    v_add_f32 v166, v166, v9
    v_add_f32 v166, v166, v10
    v_add_f32 v166, v166, v11
    v_add_f32 v166, v166, v12
    v_add_f32 v166, v166, v13
    v_add_f32 v166, v166, v14
    v_add_f32 v166, v166, v15
    v_add_f32 v166, v166, v16
    v_add_f32 v166, v166, v17
    v_add_f32 v166, v166, v18
    v_add_f32 v166, v166, v19
    s_waitcnt vmcnt(0)
    v_mfma_f32_32x32x16_bf16 v[36:51], v[84:87], v[100:103], v[36:51]
    v_mfma_f32_32x32x16_bf16 v[36:51], v[88:91], v[104:107], v[36:51]
    s_add_u32 s30, s30, 4096
    s_cmp_lt_u32 s30, 0x40000
    s_nop 7
    s_nop 3
    s_cbranch_scc1 L_att_slow0
    v_mov_b32 v165, v166
    s_nop 1
    v_permlane32_swap_b32 v165, v166
    s_nop 1
    v_add_f32 v148, v165, v166
    v_mov_b32 v52, 0
    v_mov_b32 v53, 0
    v_mov_b32 v54, 0
    v_mov_b32 v55, 0
    v_mov_b32 v56, 0
    v_mov_b32 v57, 0
    v_mov_b32 v58, 0
    v_mov_b32 v59, 0
    v_mov_b32 v60, 0
    v_mov_b32 v61, 0
    v_mov_b32 v62, 0
    v_mov_b32 v63, 0
    v_mov_b32 v64, 0
    v_mov_b32 v65, 0
    v_mov_b32 v66, 0
    v_mov_b32 v67, 0
    v_mov_b32 v163, 0xff800000
    v_mov_b32 v166, 0
    s_mov_b32 s30, 0
L_att_slow1:
    buffer_load_dwordx4 v[68:71], v167, s[8:11], s30 offen
    buffer_load_dwordx4 v[72:75], v167, s[8:11], s30 offen offset:1024
    buffer_load_dwordx4 v[84:87], v167, s[8:11], s30 offen offset:2048
    buffer_load_dwordx4 v[88:91], v167, s[8:11], s30 offen offset:3072
    s_waitcnt vmcnt(2)
    v_mfma_f32_32x32x16_bf16 v[4:19], v[68:71], v[140:143], 0
    v_mfma_f32_32x32x16_bf16 v[4:19], v[72:75], v[144:147], v[4:19]
    s_nop 7
    s_nop 3
    v_max3_f32 v164, v4, v5, v163
    v_max3_f32 v164, v6, v7, v164
    v_max3_f32 v164, v8, v9, v164
    v_max3_f32 v164, v10, v11, v164
    v_max3_f32 v164, v12, v13, v164
    v_max3_f32 v164, v14, v15, v164
    v_max3_f32 v164, v16, v17, v164
    v_max3_f32 v164, v18, v19, v164
    v_mov_b32 v165, v164
    s_nop 1
    v_permlane32_swap_b32 v165, v164
    s_nop 1
    v_max_f32 v164, v165, v164
    v_sub_f32 v165, v163, v164
    v_exp_f32 v165, v165
    v_mov_b32 v163, v164
    v_sub_f32 v4, v4, v164
    v_sub_f32 v5, v5, v164
    v_sub_f32 v6, v6, v164
    v_sub_f32 v7, v7, v164
    v_sub_f32 v8, v8, v164
    v_sub_f32 v9, v9, v164
    v_sub_f32 v10, v10, v164
    v_sub_f32 v11, v11, v164
    v_sub_f32 v12, v12, v164
    v_sub_f32 v13, v13, v164
    v_sub_f32 v14, v14, v164
    v_sub_f32 v15, v15, v164
    v_sub_f32 v16, v16, v164
    v_sub_f32 v17, v17, v164
    v_sub_f32 v18, v18, v164
    v_sub_f32 v19, v19, v164
    v_exp_f32 v4, v4
    v_exp_f32 v5, v5
    v_exp_f32 v6, v6
    v_exp_f32 v7, v7
    v_exp_f32 v8, v8
    v_exp_f32 v9, v9
    v_exp_f32 v10, v10
    v_exp_f32 v11, v11
    v_exp_f32 v12, v12
    v_exp_f32 v13, v13
    v_exp_f32 v14, v14
    v_exp_f32 v15, v15
    v_exp_f32 v16, v16
    v_exp_f32 v17, v17
    v_exp_f32 v18, v18
    v_exp_f32 v19, v19
    v_mul_f32 v166, v166, v165
    v_mul_f32 v52, v52, v165
    v_mul_f32 v53, v53, v165
    v_mul_f32 v54, v54, v165
    v_mul_f32 v55, v55, v165
    v_mul_f32 v56, v56, v165
    v_mul_f32 v57, v57, v165
    v_mul_f32 v58, v58, v165
    v_mul_f32 v59, v59, v165
    v_mul_f32 v60, v60, v165
    v_mul_f32 v61, v61, v165
    v_mul_f32 v62, v62, v165
    v_mul_f32 v63, v63, v165
    v_mul_f32 v64, v64, v165
    v_mul_f32 v65, v65, v165
    v_mul_f32 v66, v66, v165
    v_mul_f32 v67, v67, v165
    v_cvt_pk_bf16_f32 v100, v4, v5
    v_cvt_pk_bf16_f32 v101, v6, v7
    v_cvt_pk_bf16_f32 v102, v8, v9
    v_cvt_pk_bf16_f32 v103, v10, v11
    v_cvt_pk_bf16_f32 v104, v12, v13
    v_cvt_pk_bf16_f32 v105, v14, v15
    v_cvt_pk_bf16_f32 v106, v16, v17
    v_cvt_pk_bf16_f32 v107, v18, v19
    v_lshlrev_b32 v4, 16, v100
    v_and_b32 v5, 0xffff0000, v100
    v_lshlrev_b32 v6, 16, v101
    v_and_b32 v7, 0xffff0000, v101
    v_lshlrev_b32 v8, 16, v102
    v_and_b32 v9, 0xffff0000, v102
    v_lshlrev_b32 v10, 16, v103
    v_and_b32 v11, 0xffff0000, v103
    v_lshlrev_b32 v12, 16, v104
    v_and_b32 v13, 0xffff0000, v104
    v_lshlrev_b32 v14, 16, v105
    v_and_b32 v15, 0xffff0000, v105
    v_lshlrev_b32 v16, 16, v106
    v_and_b32 v17, 0xffff0000, v106
    v_lshlrev_b32 v18, 16, v107
    v_and_b32 v19, 0xffff0000, v107
    v_add_f32 v166, v166, v4
    v_add_f32 v166, v166, v5
    v_add_f32 v166, v166, v6
    v_add_f32 v166, v166, v7
    v_add_f32 v166, v166, v8
    v_add_f32 v166, v166, v9
    v_add_f32 v166, v166, v10
    v_add_f32 v166, v166, v11
    v_add_f32 v166, v166, v12
    v_add_f32 v166, v166, v13
    v_add_f32 v166, v166, v14
    v_add_f32 v166, v166, v15
    v_add_f32 v166, v166, v16
    v_add_f32 v166, v166, v17
    v_add_f32 v166, v166, v18
    v_add_f32 v166, v166, v19
    s_waitcnt vmcnt(0)
    v_mfma_f32_32x32x16_bf16 v[52:67], v[84:87], v[100:103], v[52:67]
    v_mfma_f32_32x32x16_bf16 v[52:67], v[88:91], v[104:107], v[52:67]
    s_add_u32 s30, s30, 4096
    s_cmp_lt_u32 s30, 0x40000
    s_nop 7
    s_nop 3
    s_cbranch_scc1 L_att_slow1
    v_mov_b32 v165, v166
    s_nop 1
    v_permlane32_swap_b32 v165, v166
    s_nop 1
    v_add_f32 v152, v165, v166
    v_rcp_f32 v148, v148
    v_rcp_f32 v152, v152
    s_nop 7
    s_nop 7
    s_waitcnt vmcnt(0)
    v_pk_mul_f32 v[36:37], v[36:37], v[148:149] op_sel_hi:[1,0]
    v_pk_mul_f32 v[38:39], v[38:39], v[148:149] op_sel_hi:[1,0]
    v_pk_mul_f32 v[40:41], v[40:41], v[148:149] op_sel_hi:[1,0]
    v_pk_mul_f32 v[42:43], v[42:43], v[148:149] op_sel_hi:[1,0]
    v_pk_mul_f32 v[44:45], v[44:45], v[148:149] op_sel_hi:[1,0]
    v_pk_mul_f32 v[46:47], v[46:47], v[148:149] op_sel_hi:[1,0]
    v_pk_mul_f32 v[48:49], v[48:49], v[148:149] op_sel_hi:[1,0]
    v_pk_mul_f32 v[50:51], v[50:51], v[148:149] op_sel_hi:[1,0]
    v_cvt_pk_bf16_f32 v36, v36, v37
    v_cvt_pk_bf16_f32 v37, v38, v39
    v_cvt_pk_bf16_f32 v38, v40, v41
    v_cvt_pk_bf16_f32 v39, v42, v43
    v_cvt_pk_bf16_f32 v40, v44, v45
    v_cvt_pk_bf16_f32 v41, v46, v47
    v_cvt_pk_bf16_f32 v42, v48, v49
    v_cvt_pk_bf16_f32 v43, v50, v51
    buffer_store_dwordx4 v[36:39], v162, s[12:15], 0 offen sc1
    buffer_store_dwordx4 v[40:43], v162, s[12:15], 0 offen offset:512 sc1
    ds_read_b128 v[68:71], v167 offset:0
    ds_read_b128 v[72:75], v167 offset:1024
    ds_read_b128 v[76:79], v167 offset:4096
    ds_read_b128 v[80:83], v167 offset:5120
    ds_read_b128 v[84:87], v167 offset:2048
    s_waitcnt lgkmcnt(0)
    v_add_u32 v163, 0x10000, v162
    s_branch L_att_store
L_end:
    s_endpgm

.section .rodata,"a"
.p2align 6
.amdhsa_kernel fused_kernel
  .amdhsa_next_free_vgpr 168
  .amdhsa_next_free_sgpr 100
  .amdhsa_accum_offset 168
  .amdhsa_group_segment_fixed_size 0
  .amdhsa_kernarg_size 88
  .amdhsa_user_sgpr_count 2
  .amdhsa_user_sgpr_kernarg_segment_ptr 1
  .amdhsa_system_sgpr_workgroup_id_x 1
.end_amdhsa_kernel
.text
```
